```python
import torch

def _softmax(x, axis=-1):
    return torch.softmax(x, dim=axis)

def _gelu(x):
    return torch.nn.functional.gelu(x, approximate='tanh')

def _silu(x):
    return torch.nn.functional.silu(x)

def _sigmoid(x):
    return torch.sigmoid(x)

def _layernorm(x, axis=-1, eps=1e-05):
    m = x.mean(dim=axis, keepdim=True)
    v = x.var(dim=axis, keepdim=True, unbiased=False)
    return (x - m) / torch.sqrt(v + eps)

def _scatter_add(tgt, idx, src, axis=0):
    return tgt.clone().index_add_(axis, idx, src)

def _segment_sum(src, seg, n):
    out = torch.zeros((n,) + src.shape[1:], dtype=src.dtype)
    return out.index_add_(0, seg, src)

def _pad(x, pw):
    flat = tuple((v for pair in reversed(pw) for v in pair))
    return torch.nn.functional.pad(x, flat)
kernel_name = 'adaLN_cond__compressed_kv_cla__dense_activation_silu__prompt'

def setup_inputs():

    _w = lambda a: (lambda t: t.to(torch.bfloat16) if t.is_floating_point() else t)(torch.as_tensor(a))

    def _A_setup():
        B, H, Sq, Sk, D, M = (1, 32, 2048, 2048, 128, 512)
        Dc = 4 * D
        return {'x': _w((lambda *s: torch.randn(*s, dtype=torch.bfloat16) * 0.05)(B, Sq, M)), 'c_kv': _w((lambda *s: torch.randn(*s, dtype=torch.bfloat16) * 0.8)(B, Sk, Dc)), 'w_q': _w((lambda *s: torch.randn(*s, dtype=torch.bfloat16) * 1.6)(M, H, D) * M ** (-0.5)), 'w_uk': _w((lambda *s: torch.randn(*s, dtype=torch.bfloat16) * 1.6)(Dc, H, D) * Dc ** (-0.5)), 'w_uv': _w((lambda *s: torch.randn(*s, dtype=torch.bfloat16) * 0.8)(Dc, H, D) * Dc ** (-0.5)), 'w_o': _w((lambda *s: torch.randn(*s, dtype=torch.bfloat16) * 0.8)(H, D, M) * (H * D) ** (-0.5))}
    _A_in = _A_setup()

    def _B_setup():
        B, S, D, F = (1, 2048, 512, 1792)
        return {'x': _w((lambda *s: torch.randn(*s, dtype=torch.bfloat16) * 0.05)(B, S, D)), 'w1': _w((lambda *s: torch.randn(*s, dtype=torch.bfloat16) * 1.6)(D, F) * D ** (-0.5)), 'w2': _w((lambda *s: torch.randn(*s, dtype=torch.bfloat16) * 0.2)(F, D) * F ** (-0.5))}
    _B_in = _B_setup()
    return {'A_x': _A_in['x'], 'A_c_kv': _A_in['c_kv'], 'A_w_q': _A_in['w_q'], 'A_w_uk': _A_in['w_uk'], 'A_w_uv': _A_in['w_uv'], 'A_w_o': _A_in['w_o'], 'B_x': _B_in['x'], 'B_w1': _B_in['w1'], 'B_w2': _B_in['w2'], 'c': _w((lambda *s: torch.randn(*s, dtype=torch.bfloat16) * 0.1)(1, 512) * 8.0), 'w_mod': _w((lambda *s: torch.randn(*s, dtype=torch.bfloat16) * 0.1)(512, 6 * 512) * 512 ** (-0.5) * 8.0)}

def reference(A_x, A_c_kv, A_w_q, A_w_uk, A_w_uv, A_w_o, B_x, B_w1, B_w2, c, w_mod):

    def _A_ref(x, c_kv, w_q, w_uk, w_uv, w_o):
        B, Sq, M = (x.shape[0], x.shape[1], x.shape[2])
        Sk = c_kv.shape[1]
        H, D = (w_q.shape[1], w_q.shape[2])
        q = torch.einsum('bqm,mhd->bhqd', x, w_q)
        k = torch.einsum('bkc,chd->bhkd', c_kv, w_uk)
        v = torch.einsum('bkc,chd->bhkd', c_kv, w_uv)
        scores = torch.einsum('bhqd,bhkd->bhqk', q, k) * D ** (-0.5)
        off = Sk - Sq
        qi = torch.arange(Sq)[:, None]
        kj = torch.arange(Sk)[None, :]
        cmask = kj <= qi + off
        scores = torch.where(cmask[None, None], scores, -1000000000.0)
        p = _softmax(scores, axis=-1)
        ctx = torch.einsum('bhqk,bhkd->bhqd', p, v)
        return torch.einsum('bhqd,hdm->bqm', ctx, w_o)

    def _B_ref(x, w1, w2):
        h = torch.einsum('bsd,df->bsf', x, w1)
        h = _silu(h)
        out = torch.einsum('bsf,fd->bsd', h, w2)
        return out
    x = A_x
    mod = (_silu(c) @ w_mod).reshape(c.shape[0], 6, 1, -1)
    sa, ca, ga, sb, cb, gb = (mod[:, 0].clone(), mod[:, 1].clone(), mod[:, 2].clone(), mod[:, 3].clone(), mod[:, 4].clone(), mod[:, 5].clone())
    h = _layernorm(x, axis=-1) * (1 + ca) + sa
    x = x + ga * _A_ref(h, A_c_kv, A_w_q, A_w_uk, A_w_uv, A_w_o)
    h = _layernorm(x, axis=-1) * (1 + cb) + sb
    x = x + gb * _B_ref(h, B_w1, B_w2)
    return x
```

```asm
; @launch kernel=attn_kernel grid=(256,1,1) block=(512,1,1) lds=163840
.amdgcn_target "amdgcn-amd-amdhsa--gfx950"
.text
.globl attn_kernel
.p2align 8
.type attn_kernel,@function
attn_kernel:
    s_cmp_ge_u32 s2, 256
    s_cbranch_scc1 at_end
    s_load_dwordx2 s[40:41], s[0:1], 16
    s_load_dwordx2 s[42:43], s[0:1], 104
    s_load_dwordx2 s[54:55], s[0:1], 24
    s_load_dwordx2 s[56:57], s[0:1], 32
    s_load_dwordx2 s[58:59], s[0:1], 8
    s_load_dwordx2 s[60:61], s[0:1], 72
    s_load_dwordx2 s[62:63], s[0:1], 80
    s_load_dwordx2 s[64:65], s[0:1], 0
    s_load_dwordx2 s[66:67], s[0:1], 96
    v_lshrrev_b32 v1, 6, v0
    v_and_b32 v0, 63, v0
    s_nop 0
    v_readfirstlane_b32 s20, v1
    s_lshr_b32 s50, s20, 2
    s_and_b32 s20, s20, 3
    s_and_b32 s38, s2, 7
    s_lshl_b32 s38, s38, 2
    s_lshr_b32 s39, s2, 3
    s_and_b32 s39, s39, 3
    s_add_u32 s21, s38, s39
    s_lshr_b32 s23, s2, 5
    s_sub_u32 s22, 15, s23
    s_waitcnt lgkmcnt(0)
    s_add_u32 s4, s42, 1048576
    s_addc_u32 s5, s43, 0
    s_mov_b32 s6, 2097152
    s_mov_b32 s7, 0x00020000
    s_mov_b32 s8, s40
    s_mov_b32 s9, s41
    s_mov_b32 s10, 4194304
    s_mov_b32 s11, 0x00020000
    s_lshl_b32 s38, s21, 20
    s_add_u32 s44, s42, s38
    s_addc_u32 s45, s43, 0
    s_add_u32 s12, s44, 16777216
    s_addc_u32 s13, s45, 0
    s_mov_b32 s14, 1048576
    s_mov_b32 s15, 0x00020000
    s_add_u32 s16, s42, 50331648
    s_addc_u32 s17, s43, 0
    s_mov_b32 s18, 16777216
    s_mov_b32 s19, 0x00020000
    v_lshlrev_b32 v1, 4, v0
    v_lshrrev_b32 v9, 4, v0
    v_and_b32 v10, 15, v0
    v_lshlrev_b32 v11, 2, v9
    v_xor_b32 v11, v11, v10
    v_lshlrev_b32 v11, 4, v11
    v_lshl_add_u32 v11, v9, 13, v11
    s_lshl_b32 s38, s21, 8
    v_add_u32 v16, s38, v11
    v_add_u32 v17, 31744, v16
    v_add_u32 v18, 63488, v16
    v_add_u32 v19, 95232, v16
    s_lshl_b32 s38, s22, 2
    s_add_u32 s38, s38, s20
    s_lshl_b32 s33, s38, 15
    s_lshl_b32 s36, s38, 18
    s_lshl_b32 s38, s23, 2
    s_add_u32 s38, s38, s20
    s_lshl_b32 s34, s38, 15
    s_lshl_b32 s37, s38, 18
    s_lshl_b32 s38, s21, 13
    s_add_u32 s36, s36, s38
    s_add_u32 s37, s37, s38
    s_lshl_b32 s35, s20, 17
    s_lshl_b32 s32, s20, 13
    v_add_u32 v4, s32, v1
    v_add_u32 v5, 4096, v4
    s_mov_b32 s24, 0
    s_mov_b32 s25, 98304
    s_lshl_b32 s28, s22, 1
    s_add_u32 s28, s28, 2
    s_cmp_eq_u32 s50, 0
    s_cbranch_scc0 at_loader
    s_mov_b32 s68, s58
    s_mov_b32 s69, s59
    s_mov_b32 s70, 2097152
    s_mov_b32 s71, 0x00020000
    v_and_b32 v14, 15, v0
    v_lshlrev_b32 v14, 7, v14
    s_lshl_b32 s38, s2, 13
    s_lshl_b32 s39, s20, 11
    s_add_u32 s38, s38, s39
    buffer_load_dword v39, v14, s[68:71], s38 offen
    s_mov_b32 s44, s62
    s_mov_b32 s45, s63
    s_mov_b32 s46, 3145728
    s_mov_b32 s47, 0x00020000
    s_mov_b32 s70, s60
    s_mov_b32 s71, s61
    s_mov_b32 s60, s70
    s_mov_b32 s61, s71
    s_mov_b32 s62, 1024
    s_mov_b32 s63, 0x00020000
    s_cmp_ge_u32 s2, 192
    s_cselect_b32 s46, 0, s46
    v_lshrrev_b32 v48, 1, v0
    s_lshl_b32 s38, s20, 7
    v_add_u32 v48, s38, v48
    v_lshlrev_b32 v49, 1, v48
    v_mul_u32_u24 v50, 6144, v48
    v_and_b32 v51, 1, v0
    v_lshlrev_b32 v51, 4, v51
    v_add_u32 v50, v50, v51
    s_and_b32 s38, s2, 7
    s_mul_i32 s38, s38, 24
    s_lshr_b32 s39, s2, 3
    s_add_u32 s48, s38, s39
    s_lshl_b32 s49, s48, 5
    s_add_u32 s38, s49, 0
    buffer_load_dwordx4 v[64:67], v50, s[44:47], s38 offen
    buffer_load_ushort v80, v49, s[60:63], 0 offen offset:0
    s_add_u32 s38, s49, 196608
    buffer_load_dwordx4 v[68:71], v50, s[44:47], s38 offen
    buffer_load_ushort v81, v49, s[60:63], 0 offen offset:64
    s_add_u32 s38, s49, 393216
    buffer_load_dwordx4 v[72:75], v50, s[44:47], s38 offen
    buffer_load_ushort v82, v49, s[60:63], 0 offen offset:128
    s_add_u32 s38, s49, 589824
    buffer_load_dwordx4 v[76:79], v50, s[44:47], s38 offen
    buffer_load_ushort v83, v49, s[60:63], 0 offen offset:192
    v_lshrrev_b32 v11, 1, v9
    v_lshrrev_b32 v12, 2, v10
    v_lshl_add_u32 v11, v11, 3, v12
    v_lshlrev_b32 v11, 8, v11
    v_and_b32 v13, 1, v9
    v_lshl_add_u32 v11, v13, 5, v11
    v_and_b32 v13, 3, v10
    v_lshl_add_u32 v11, v13, 3, v11
    v_xor_b32 v13, 0, v12
    v_lshl_add_u32 v20, v13, 6, v11
    v_xor_b32 v13, 1, v12
    v_lshl_add_u32 v21, v13, 6, v11
    v_xor_b32 v13, 2, v12
    v_lshl_add_u32 v22, v13, 6, v11
    v_xor_b32 v13, 3, v12
    v_lshl_add_u32 v23, v13, 6, v11
    s_lshl_b32 s38, s20, 12
    s_add_u32 s38, s38, 16384
    v_add_u32 v24, s38, v1
    v_and_b32 v11, 31, v0
    v_lshrrev_b32 v12, 5, v0
    v_lshlrev_b32 v12, 2, v12
    v_sub_u32 v11, v11, v12
    s_lshl_b32 s38, s20, 5
    v_add_u32 v7, s38, v11
    v_mov_b32 v8, 0xff800000
    s_mov_b32 s30, 0
    s_setprio 1
    v_and_b32 v11, 31, v0
    v_lshlrev_b32 v11, 7, v11
    v_lshrrev_b32 v12, 5, v0
    v_lshrrev_b32 v13, 1, v0
    v_and_b32 v13, 7, v13
    v_xor_b32 v12, v12, v13
    s_lshl_b32 s38, s20, 12
    s_add_u32 s38, s38, 16384
    v_add_u32 v11, s38, v11
    v_xor_b32 v13, 0, v12
    v_lshl_add_u32 v34, v13, 4, v11
    v_xor_b32 v13, 2, v12
    v_lshl_add_u32 v35, v13, 4, v11
    v_xor_b32 v13, 4, v12
    v_lshl_add_u32 v36, v13, 4, v11
    v_xor_b32 v13, 6, v12
    v_lshl_add_u32 v37, v13, 4, v11
    s_lshl_b32 s52, s23, 17
    s_lshr_b32 s38, s20, 1
    s_lshl_b32 s38, s38, 15
    s_add_u32 s52, s52, s38
    s_and_b32 s38, s20, 1
    s_lshl_b32 s39, s38, 11
    s_add_u32 s53, s52, s39
    s_add_u32 s53, s53, 16384
    s_lshl_b32 s39, s38, 13
    s_add_u32 s52, s52, s39
    s_lshr_b32 s38, s2, 3
    s_and_b32 s38, s38, 3
    s_lshl_b32 s38, s38, 6
    s_lshl_b32 s39, s23, 8
    s_add_u32 s38, s38, s39
    v_add_u32 v13, s38, v0
    v_lshlrev_b32 v13, 10, v13
    s_lshl_b32 s72, s20, 7
    v_lshrrev_b32 v12, 1, v0
    v_and_b32 v12, 15, v12
    v_lshlrev_b32 v12, 13, v12
    v_and_b32 v11, 1, v0
    v_lshl_add_u32 v12, v11, 7, v12
    s_lshl_b32 s38, s23, 2
    s_add_u32 s38, s38, s20
    s_lshl_b32 s38, s38, 17
    s_lshl_b32 s39, s21, 8
    s_add_u32 s73, s38, s39
    s_waitcnt vmcnt(0)
    v_mov_b32 v84, 0
    v_mov_b32 v85, 0
    v_mov_b32 v86, 0
    v_mov_b32 v87, 0
    v_mov_b32 v88, 0
    v_mov_b32 v89, 0
    v_mov_b32 v90, 0
    v_mov_b32 v91, 0
    v_lshlrev_b32 v80, 16, v80
    v_mul_f32 v92, 0xbfb8aa3b, v80
    v_exp_f32 v92, v92
    s_nop 0
    v_add_f32 v92, 1.0, v92
    v_rcp_f32 v92, v92
    s_nop 0
    v_mul_f32 v80, v80, v92
    v_cvt_pk_bf16_f32 v80, v80, v80
    v_lshlrev_b32 v80, 16, v80
    v_lshlrev_b32 v96, 16, v64
    v_and_b32 v97, 0xffff0000, v64
    v_lshlrev_b32 v98, 16, v65
    v_and_b32 v99, 0xffff0000, v65
    v_lshlrev_b32 v100, 16, v66
    v_and_b32 v101, 0xffff0000, v66
    v_lshlrev_b32 v102, 16, v67
    v_and_b32 v103, 0xffff0000, v67
    v_fma_f32 v84, v96, v80, v84
    v_fma_f32 v85, v97, v80, v85
    v_fma_f32 v86, v98, v80, v86
    v_fma_f32 v87, v99, v80, v87
    v_fma_f32 v88, v100, v80, v88
    v_fma_f32 v89, v101, v80, v89
    v_fma_f32 v90, v102, v80, v90
    v_fma_f32 v91, v103, v80, v91
    v_lshlrev_b32 v81, 16, v81
    v_mul_f32 v92, 0xbfb8aa3b, v81
    v_exp_f32 v92, v92
    s_nop 0
    v_add_f32 v92, 1.0, v92
    v_rcp_f32 v92, v92
    s_nop 0
    v_mul_f32 v81, v81, v92
    v_cvt_pk_bf16_f32 v81, v81, v81
    v_lshlrev_b32 v81, 16, v81
    v_lshlrev_b32 v96, 16, v68
    v_and_b32 v97, 0xffff0000, v68
    v_lshlrev_b32 v98, 16, v69
    v_and_b32 v99, 0xffff0000, v69
    v_lshlrev_b32 v100, 16, v70
    v_and_b32 v101, 0xffff0000, v70
    v_lshlrev_b32 v102, 16, v71
    v_and_b32 v103, 0xffff0000, v71
    v_fma_f32 v84, v96, v81, v84
    v_fma_f32 v85, v97, v81, v85
    v_fma_f32 v86, v98, v81, v86
    v_fma_f32 v87, v99, v81, v87
    v_fma_f32 v88, v100, v81, v88
    v_fma_f32 v89, v101, v81, v89
    v_fma_f32 v90, v102, v81, v90
    v_fma_f32 v91, v103, v81, v91
    v_lshlrev_b32 v82, 16, v82
    v_mul_f32 v92, 0xbfb8aa3b, v82
    v_exp_f32 v92, v92
    s_nop 0
    v_add_f32 v92, 1.0, v92
    v_rcp_f32 v92, v92
    s_nop 0
    v_mul_f32 v82, v82, v92
    v_cvt_pk_bf16_f32 v82, v82, v82
    v_lshlrev_b32 v82, 16, v82
    v_lshlrev_b32 v96, 16, v72
    v_and_b32 v97, 0xffff0000, v72
    v_lshlrev_b32 v98, 16, v73
    v_and_b32 v99, 0xffff0000, v73
    v_lshlrev_b32 v100, 16, v74
    v_and_b32 v101, 0xffff0000, v74
    v_lshlrev_b32 v102, 16, v75
    v_and_b32 v103, 0xffff0000, v75
    v_fma_f32 v84, v96, v82, v84
    v_fma_f32 v85, v97, v82, v85
    v_fma_f32 v86, v98, v82, v86
    v_fma_f32 v87, v99, v82, v87
    v_fma_f32 v88, v100, v82, v88
    v_fma_f32 v89, v101, v82, v89
    v_fma_f32 v90, v102, v82, v90
    v_fma_f32 v91, v103, v82, v91
    v_lshlrev_b32 v83, 16, v83
    v_mul_f32 v92, 0xbfb8aa3b, v83
    v_exp_f32 v92, v92
    s_nop 0
    v_add_f32 v92, 1.0, v92
    v_rcp_f32 v92, v92
    s_nop 0
    v_mul_f32 v83, v83, v92
    v_cvt_pk_bf16_f32 v83, v83, v83
    v_lshlrev_b32 v83, 16, v83
    v_lshlrev_b32 v96, 16, v76
    v_and_b32 v97, 0xffff0000, v76
    v_lshlrev_b32 v98, 16, v77
    v_and_b32 v99, 0xffff0000, v77
    v_lshlrev_b32 v100, 16, v78
    v_and_b32 v101, 0xffff0000, v78
    v_lshlrev_b32 v102, 16, v79
    v_and_b32 v103, 0xffff0000, v79
    v_fma_f32 v84, v96, v83, v84
    v_fma_f32 v85, v97, v83, v85
    v_fma_f32 v86, v98, v83, v86
    v_fma_f32 v87, v99, v83, v87
    v_fma_f32 v88, v100, v83, v88
    v_fma_f32 v89, v101, v83, v89
    v_fma_f32 v90, v102, v83, v90
    v_fma_f32 v91, v103, v83, v91
    s_nop 1
    v_add_f32_dpp v84, v84, v84 quad_perm:[2,3,0,1] row_mask:0xf bank_mask:0xf
    v_add_f32_dpp v85, v85, v85 quad_perm:[2,3,0,1] row_mask:0xf bank_mask:0xf
    v_add_f32_dpp v86, v86, v86 quad_perm:[2,3,0,1] row_mask:0xf bank_mask:0xf
    v_add_f32_dpp v87, v87, v87 quad_perm:[2,3,0,1] row_mask:0xf bank_mask:0xf
    v_add_f32_dpp v88, v88, v88 quad_perm:[2,3,0,1] row_mask:0xf bank_mask:0xf
    v_add_f32_dpp v89, v89, v89 quad_perm:[2,3,0,1] row_mask:0xf bank_mask:0xf
    v_add_f32_dpp v90, v90, v90 quad_perm:[2,3,0,1] row_mask:0xf bank_mask:0xf
    v_add_f32_dpp v91, v91, v91 quad_perm:[2,3,0,1] row_mask:0xf bank_mask:0xf
    s_nop 1
    v_add_f32_dpp v84, v84, v84 row_ror:4 row_mask:0xf bank_mask:0xf
    v_add_f32_dpp v85, v85, v85 row_ror:4 row_mask:0xf bank_mask:0xf
    v_add_f32_dpp v86, v86, v86 row_ror:4 row_mask:0xf bank_mask:0xf
    v_add_f32_dpp v87, v87, v87 row_ror:4 row_mask:0xf bank_mask:0xf
    v_add_f32_dpp v88, v88, v88 row_ror:4 row_mask:0xf bank_mask:0xf
    v_add_f32_dpp v89, v89, v89 row_ror:4 row_mask:0xf bank_mask:0xf
    v_add_f32_dpp v90, v90, v90 row_ror:4 row_mask:0xf bank_mask:0xf
    v_add_f32_dpp v91, v91, v91 row_ror:4 row_mask:0xf bank_mask:0xf
    s_nop 1
    v_add_f32_dpp v84, v84, v84 row_ror:8 row_mask:0xf bank_mask:0xf
    v_add_f32_dpp v85, v85, v85 row_ror:8 row_mask:0xf bank_mask:0xf
    v_add_f32_dpp v86, v86, v86 row_ror:8 row_mask:0xf bank_mask:0xf
    v_add_f32_dpp v87, v87, v87 row_ror:8 row_mask:0xf bank_mask:0xf
    v_add_f32_dpp v88, v88, v88 row_ror:8 row_mask:0xf bank_mask:0xf
    v_add_f32_dpp v89, v89, v89 row_ror:8 row_mask:0xf bank_mask:0xf
    v_add_f32_dpp v90, v90, v90 row_ror:8 row_mask:0xf bank_mask:0xf
    v_add_f32_dpp v91, v91, v91 row_ror:8 row_mask:0xf bank_mask:0xf
    v_mov_b32 v96, v84
    v_mov_b32 v97, v85
    v_mov_b32 v98, v86
    v_mov_b32 v99, v87
    v_mov_b32 v100, v88
    v_mov_b32 v101, v89
    v_mov_b32 v102, v90
    v_mov_b32 v103, v91
    s_nop 1
    v_permlane16_swap_b32 v84, v96
    v_permlane16_swap_b32 v85, v97
    v_permlane16_swap_b32 v86, v98
    v_permlane16_swap_b32 v87, v99
    v_permlane16_swap_b32 v88, v100
    v_permlane16_swap_b32 v89, v101
    v_permlane16_swap_b32 v90, v102
    v_permlane16_swap_b32 v91, v103
    s_nop 1
    v_add_f32 v84, v84, v96
    v_add_f32 v85, v85, v97
    v_add_f32 v86, v86, v98
    v_add_f32 v87, v87, v99
    v_add_f32 v88, v88, v100
    v_add_f32 v89, v89, v101
    v_add_f32 v90, v90, v102
    v_add_f32 v91, v91, v103
    v_mov_b32 v96, v84
    v_mov_b32 v97, v85
    v_mov_b32 v98, v86
    v_mov_b32 v99, v87
    v_mov_b32 v100, v88
    v_mov_b32 v101, v89
    v_mov_b32 v102, v90
    v_mov_b32 v103, v91
    s_nop 1
    v_permlane32_swap_b32 v84, v96
    v_permlane32_swap_b32 v85, v97
    v_permlane32_swap_b32 v86, v98
    v_permlane32_swap_b32 v87, v99
    v_permlane32_swap_b32 v88, v100
    v_permlane32_swap_b32 v89, v101
    v_permlane32_swap_b32 v90, v102
    v_permlane32_swap_b32 v91, v103
    s_nop 1
    v_add_f32 v84, v84, v96
    v_add_f32 v85, v85, v97
    v_add_f32 v86, v86, v98
    v_add_f32 v87, v87, v99
    v_add_f32 v88, v88, v100
    v_add_f32 v89, v89, v101
    v_add_f32 v90, v90, v102
    v_add_f32 v91, v91, v103
    v_lshlrev_b32 v92, 5, v0
    s_lshl_b32 s38, s20, 6
    s_add_u32 s38, s38, 147456
    v_add_u32 v92, s38, v92
    s_mov_b64 exec, 3
    ds_write_b128 v92, v[84:87]
    ds_write_b128 v92, v[88:91] offset:16
    s_mov_b64 exec, -1
    s_waitcnt lgkmcnt(0)
    s_mov_b32 s60, s58
    s_mov_b32 s61, s59
    s_mov_b32 s62, 2097152
    s_mov_b32 s63, 0x00020000
    s_mov_b32 s64, s54
    s_mov_b32 s65, s55
    s_mov_b32 s66, 4194304
    s_mov_b32 s67, 0x00020000
    s_mov_b32 s68, s56
    s_mov_b32 s69, s57
    s_mov_b32 s70, 4194304
    s_mov_b32 s71, 0x00020000
    s_barrier
    v_add_u32 v25, 98304, v20
    v_add_u32 v26, 98304, v21
    v_add_u32 v27, 98304, v22
    v_add_u32 v28, 98304, v23
    v_add_u32 v30, 98304, v34
    v_add_u32 v31, 98304, v35
    v_add_u32 v32, 98304, v36
    v_add_u32 v33, 98304, v37
    ds_read_b128 v[224:227], v30
    ds_read_b128 v[228:231], v30 offset:16384
    ds_read_b64_tr_b16 v[192:193], v25 offset:0
    ds_read_b64_tr_b16 v[194:195], v25 offset:1024
    ds_read_b64_tr_b16 v[196:197], v26 offset:0
    ds_read_b64_tr_b16 v[198:199], v26 offset:1024
    ds_read_b64_tr_b16 v[200:201], v27 offset:0
    ds_read_b64_tr_b16 v[202:203], v27 offset:1024
    ds_read_b64_tr_b16 v[204:205], v28 offset:0
    ds_read_b64_tr_b16 v[206:207], v28 offset:1024
    s_waitcnt lgkmcnt(0)
    v_mfma_f32_32x32x16_bf16 v[64:79], v[192:195], v[224:227], 0
    ds_read_b128 v[232:235], v31
    ds_read_b128 v[236:239], v31 offset:16384
    v_mfma_f32_32x32x16_bf16 v[128:143], v[192:195], v[228:231], 0
    ds_read_b64_tr_b16 v[208:209], v25 offset:4096
    ds_read_b64_tr_b16 v[210:211], v25 offset:5120
    v_mfma_f32_32x32x16_bf16 v[80:95], v[196:199], v[224:227], 0
    ds_read_b64_tr_b16 v[212:213], v26 offset:4096
    ds_read_b64_tr_b16 v[214:215], v26 offset:5120
    v_mfma_f32_32x32x16_bf16 v[144:159], v[196:199], v[228:231], 0
    ds_read_b64_tr_b16 v[216:217], v27 offset:4096
    ds_read_b64_tr_b16 v[218:219], v27 offset:5120
    v_mfma_f32_32x32x16_bf16 v[96:111], v[200:203], v[224:227], 0
    ds_read_b64_tr_b16 v[220:221], v28 offset:4096
    ds_read_b64_tr_b16 v[222:223], v28 offset:5120
    v_mfma_f32_32x32x16_bf16 v[160:175], v[200:203], v[228:231], 0
    v_mfma_f32_32x32x16_bf16 v[112:127], v[204:207], v[224:227], 0
    v_mfma_f32_32x32x16_bf16 v[176:191], v[204:207], v[228:231], 0
    s_waitcnt lgkmcnt(0)
    v_mfma_f32_32x32x16_bf16 v[64:79], v[208:211], v[232:235], v[64:79]
    ds_read_b128 v[224:227], v32
    ds_read_b128 v[228:231], v32 offset:16384
    v_mfma_f32_32x32x16_bf16 v[128:143], v[208:211], v[236:239], v[128:143]
    ds_read_b64_tr_b16 v[192:193], v25 offset:8192
    ds_read_b64_tr_b16 v[194:195], v25 offset:9216
    v_mfma_f32_32x32x16_bf16 v[80:95], v[212:215], v[232:235], v[80:95]
    ds_read_b64_tr_b16 v[196:197], v26 offset:8192
    ds_read_b64_tr_b16 v[198:199], v26 offset:9216
    v_mfma_f32_32x32x16_bf16 v[144:159], v[212:215], v[236:239], v[144:159]
    ds_read_b64_tr_b16 v[200:201], v27 offset:8192
    ds_read_b64_tr_b16 v[202:203], v27 offset:9216
    v_mfma_f32_32x32x16_bf16 v[96:111], v[216:219], v[232:235], v[96:111]
    ds_read_b64_tr_b16 v[204:205], v28 offset:8192
    ds_read_b64_tr_b16 v[206:207], v28 offset:9216
    v_mfma_f32_32x32x16_bf16 v[160:175], v[216:219], v[236:239], v[160:175]
    v_mfma_f32_32x32x16_bf16 v[112:127], v[220:223], v[232:235], v[112:127]
    v_mfma_f32_32x32x16_bf16 v[176:191], v[220:223], v[236:239], v[176:191]
    s_waitcnt lgkmcnt(0)
    v_mfma_f32_32x32x16_bf16 v[64:79], v[192:195], v[224:227], v[64:79]
    ds_read_b128 v[232:235], v33
    ds_read_b128 v[236:239], v33 offset:16384
    v_mfma_f32_32x32x16_bf16 v[128:143], v[192:195], v[228:231], v[128:143]
    ds_read_b64_tr_b16 v[208:209], v25 offset:12288
    ds_read_b64_tr_b16 v[210:211], v25 offset:13312
    v_mfma_f32_32x32x16_bf16 v[80:95], v[196:199], v[224:227], v[80:95]
    ds_read_b64_tr_b16 v[212:213], v26 offset:12288
    ds_read_b64_tr_b16 v[214:215], v26 offset:13312
    v_mfma_f32_32x32x16_bf16 v[144:159], v[196:199], v[228:231], v[144:159]
    ds_read_b64_tr_b16 v[216:217], v27 offset:12288
    ds_read_b64_tr_b16 v[218:219], v27 offset:13312
    v_mfma_f32_32x32x16_bf16 v[96:111], v[200:203], v[224:227], v[96:111]
    ds_read_b64_tr_b16 v[220:221], v28 offset:12288
    ds_read_b64_tr_b16 v[222:223], v28 offset:13312
    v_mfma_f32_32x32x16_bf16 v[160:175], v[200:203], v[228:231], v[160:175]
    v_mfma_f32_32x32x16_bf16 v[112:127], v[204:207], v[224:227], v[112:127]
    v_mfma_f32_32x32x16_bf16 v[176:191], v[204:207], v[228:231], v[176:191]
    s_waitcnt lgkmcnt(0)
    s_barrier
    v_mfma_f32_32x32x16_bf16 v[64:79], v[208:211], v[232:235], v[64:79]
    v_add_u32 v25, 0, v20
    v_add_u32 v26, 0, v21
    v_add_u32 v27, 0, v22
    v_mfma_f32_32x32x16_bf16 v[128:143], v[208:211], v[236:239], v[128:143]
    v_add_u32 v28, 0, v23
    v_add_u32 v30, 0, v34
    v_add_u32 v31, 0, v35
    v_mfma_f32_32x32x16_bf16 v[80:95], v[212:215], v[232:235], v[80:95]
    v_add_u32 v32, 0, v36
    v_add_u32 v33, 0, v37
    ds_read_b128 v[224:227], v30
    v_mfma_f32_32x32x16_bf16 v[144:159], v[212:215], v[236:239], v[144:159]
    ds_read_b128 v[228:231], v30 offset:16384
    ds_read_b64_tr_b16 v[192:193], v25 offset:0
    ds_read_b64_tr_b16 v[194:195], v25 offset:1024
    v_mfma_f32_32x32x16_bf16 v[96:111], v[216:219], v[232:235], v[96:111]
    ds_read_b64_tr_b16 v[196:197], v26 offset:0
    ds_read_b64_tr_b16 v[198:199], v26 offset:1024
    ds_read_b64_tr_b16 v[200:201], v27 offset:0
    v_mfma_f32_32x32x16_bf16 v[160:175], v[216:219], v[236:239], v[160:175]
    ds_read_b64_tr_b16 v[202:203], v27 offset:1024
    ds_read_b64_tr_b16 v[204:205], v28 offset:0
    ds_read_b64_tr_b16 v[206:207], v28 offset:1024
    v_mfma_f32_32x32x16_bf16 v[112:127], v[220:223], v[232:235], v[112:127]
    v_mfma_f32_32x32x16_bf16 v[176:191], v[220:223], v[236:239], v[176:191]
    s_waitcnt lgkmcnt(0)
    v_mfma_f32_32x32x16_bf16 v[64:79], v[192:195], v[224:227], v[64:79]
    ds_read_b128 v[232:235], v31
    ds_read_b128 v[236:239], v31 offset:16384
    v_mfma_f32_32x32x16_bf16 v[128:143], v[192:195], v[228:231], v[128:143]
    ds_read_b64_tr_b16 v[208:209], v25 offset:4096
    ds_read_b64_tr_b16 v[210:211], v25 offset:5120
    v_mfma_f32_32x32x16_bf16 v[80:95], v[196:199], v[224:227], v[80:95]
    ds_read_b64_tr_b16 v[212:213], v26 offset:4096
    ds_read_b64_tr_b16 v[214:215], v26 offset:5120
    v_mfma_f32_32x32x16_bf16 v[144:159], v[196:199], v[228:231], v[144:159]
    ds_read_b64_tr_b16 v[216:217], v27 offset:4096
    ds_read_b64_tr_b16 v[218:219], v27 offset:5120
    v_mfma_f32_32x32x16_bf16 v[96:111], v[200:203], v[224:227], v[96:111]
    ds_read_b64_tr_b16 v[220:221], v28 offset:4096
    ds_read_b64_tr_b16 v[222:223], v28 offset:5120
    v_mfma_f32_32x32x16_bf16 v[160:175], v[200:203], v[228:231], v[160:175]
    v_mfma_f32_32x32x16_bf16 v[112:127], v[204:207], v[224:227], v[112:127]
    v_mfma_f32_32x32x16_bf16 v[176:191], v[204:207], v[228:231], v[176:191]
    s_waitcnt lgkmcnt(0)
    v_mfma_f32_32x32x16_bf16 v[64:79], v[208:211], v[232:235], v[64:79]
    ds_read_b128 v[224:227], v32
    ds_read_b128 v[228:231], v32 offset:16384
    v_mfma_f32_32x32x16_bf16 v[128:143], v[208:211], v[236:239], v[128:143]
    ds_read_b64_tr_b16 v[192:193], v25 offset:8192
    ds_read_b64_tr_b16 v[194:195], v25 offset:9216
    v_mfma_f32_32x32x16_bf16 v[80:95], v[212:215], v[232:235], v[80:95]
    ds_read_b64_tr_b16 v[196:197], v26 offset:8192
    ds_read_b64_tr_b16 v[198:199], v26 offset:9216
    v_mfma_f32_32x32x16_bf16 v[144:159], v[212:215], v[236:239], v[144:159]
    ds_read_b64_tr_b16 v[200:201], v27 offset:8192
    ds_read_b64_tr_b16 v[202:203], v27 offset:9216
    v_mfma_f32_32x32x16_bf16 v[96:111], v[216:219], v[232:235], v[96:111]
    ds_read_b64_tr_b16 v[204:205], v28 offset:8192
    ds_read_b64_tr_b16 v[206:207], v28 offset:9216
    v_mfma_f32_32x32x16_bf16 v[160:175], v[216:219], v[236:239], v[160:175]
    v_mfma_f32_32x32x16_bf16 v[112:127], v[220:223], v[232:235], v[112:127]
    v_mfma_f32_32x32x16_bf16 v[176:191], v[220:223], v[236:239], v[176:191]
    s_waitcnt lgkmcnt(0)
    v_mfma_f32_32x32x16_bf16 v[64:79], v[192:195], v[224:227], v[64:79]
    ds_read_b128 v[232:235], v33
    ds_read_b128 v[236:239], v33 offset:16384
    v_mfma_f32_32x32x16_bf16 v[128:143], v[192:195], v[228:231], v[128:143]
    ds_read_b64_tr_b16 v[208:209], v25 offset:12288
    ds_read_b64_tr_b16 v[210:211], v25 offset:13312
    v_mfma_f32_32x32x16_bf16 v[80:95], v[196:199], v[224:227], v[80:95]
    ds_read_b64_tr_b16 v[212:213], v26 offset:12288
    ds_read_b64_tr_b16 v[214:215], v26 offset:13312
    v_mfma_f32_32x32x16_bf16 v[144:159], v[196:199], v[228:231], v[144:159]
    ds_read_b64_tr_b16 v[216:217], v27 offset:12288
    ds_read_b64_tr_b16 v[218:219], v27 offset:13312
    v_mfma_f32_32x32x16_bf16 v[96:111], v[200:203], v[224:227], v[96:111]
    ds_read_b64_tr_b16 v[220:221], v28 offset:12288
    ds_read_b64_tr_b16 v[222:223], v28 offset:13312
    v_mfma_f32_32x32x16_bf16 v[160:175], v[200:203], v[228:231], v[160:175]
    v_mfma_f32_32x32x16_bf16 v[112:127], v[204:207], v[224:227], v[112:127]
    v_mfma_f32_32x32x16_bf16 v[176:191], v[204:207], v[228:231], v[176:191]
    s_waitcnt lgkmcnt(0)
    s_barrier
    v_mfma_f32_32x32x16_bf16 v[64:79], v[208:211], v[232:235], v[64:79]
    v_add_u32 v25, 49152, v20
    v_add_u32 v26, 49152, v21
    v_add_u32 v27, 49152, v22
    v_mfma_f32_32x32x16_bf16 v[128:143], v[208:211], v[236:239], v[128:143]
    v_add_u32 v28, 49152, v23
    v_add_u32 v30, 49152, v34
    v_add_u32 v31, 49152, v35
    v_mfma_f32_32x32x16_bf16 v[80:95], v[212:215], v[232:235], v[80:95]
    v_add_u32 v32, 49152, v36
    v_add_u32 v33, 49152, v37
    ds_read_b128 v[224:227], v30
    v_mfma_f32_32x32x16_bf16 v[144:159], v[212:215], v[236:239], v[144:159]
    ds_read_b128 v[228:231], v30 offset:16384
    ds_read_b64_tr_b16 v[192:193], v25 offset:0
    ds_read_b64_tr_b16 v[194:195], v25 offset:1024
    v_mfma_f32_32x32x16_bf16 v[96:111], v[216:219], v[232:235], v[96:111]
    ds_read_b64_tr_b16 v[196:197], v26 offset:0
    ds_read_b64_tr_b16 v[198:199], v26 offset:1024
    ds_read_b64_tr_b16 v[200:201], v27 offset:0
    v_mfma_f32_32x32x16_bf16 v[160:175], v[216:219], v[236:239], v[160:175]
    ds_read_b64_tr_b16 v[202:203], v27 offset:1024
    ds_read_b64_tr_b16 v[204:205], v28 offset:0
    ds_read_b64_tr_b16 v[206:207], v28 offset:1024
    v_mfma_f32_32x32x16_bf16 v[112:127], v[220:223], v[232:235], v[112:127]
    v_mfma_f32_32x32x16_bf16 v[176:191], v[220:223], v[236:239], v[176:191]
    s_waitcnt lgkmcnt(0)
    v_mfma_f32_32x32x16_bf16 v[64:79], v[192:195], v[224:227], v[64:79]
    ds_read_b128 v[232:235], v31
    ds_read_b128 v[236:239], v31 offset:16384
    buffer_load_dword v38, v12, s[68:71], s73 offen
    v_mfma_f32_32x32x16_bf16 v[128:143], v[192:195], v[228:231], v[128:143]
    ds_read_b64_tr_b16 v[208:209], v25 offset:4096
    ds_read_b64_tr_b16 v[210:211], v25 offset:5120
    v_mfma_f32_32x32x16_bf16 v[80:95], v[196:199], v[224:227], v[80:95]
    ds_read_b64_tr_b16 v[212:213], v26 offset:4096
    ds_read_b64_tr_b16 v[214:215], v26 offset:5120
    v_mfma_f32_32x32x16_bf16 v[144:159], v[196:199], v[228:231], v[144:159]
    ds_read_b64_tr_b16 v[216:217], v27 offset:4096
    ds_read_b64_tr_b16 v[218:219], v27 offset:5120
    v_mfma_f32_32x32x16_bf16 v[96:111], v[200:203], v[224:227], v[96:111]
    ds_read_b64_tr_b16 v[220:221], v28 offset:4096
    ds_read_b64_tr_b16 v[222:223], v28 offset:5120
    v_mfma_f32_32x32x16_bf16 v[160:175], v[200:203], v[228:231], v[160:175]
    v_mfma_f32_32x32x16_bf16 v[112:127], v[204:207], v[224:227], v[112:127]
    v_mfma_f32_32x32x16_bf16 v[176:191], v[204:207], v[228:231], v[176:191]
    s_waitcnt lgkmcnt(0)
    v_mfma_f32_32x32x16_bf16 v[64:79], v[208:211], v[232:235], v[64:79]
    ds_read_b128 v[224:227], v32
    ds_read_b128 v[228:231], v32 offset:16384
    v_mfma_f32_32x32x16_bf16 v[128:143], v[208:211], v[236:239], v[128:143]
    ds_read_b64_tr_b16 v[192:193], v25 offset:8192
    ds_read_b64_tr_b16 v[194:195], v25 offset:9216
    v_mfma_f32_32x32x16_bf16 v[80:95], v[212:215], v[232:235], v[80:95]
    ds_read_b64_tr_b16 v[196:197], v26 offset:8192
    ds_read_b64_tr_b16 v[198:199], v26 offset:9216
    v_mfma_f32_32x32x16_bf16 v[144:159], v[212:215], v[236:239], v[144:159]
    ds_read_b64_tr_b16 v[200:201], v27 offset:8192
    ds_read_b64_tr_b16 v[202:203], v27 offset:9216
    v_mfma_f32_32x32x16_bf16 v[96:111], v[216:219], v[232:235], v[96:111]
    ds_read_b64_tr_b16 v[204:205], v28 offset:8192
    ds_read_b64_tr_b16 v[206:207], v28 offset:9216
    v_mfma_f32_32x32x16_bf16 v[160:175], v[216:219], v[236:239], v[160:175]
    v_mfma_f32_32x32x16_bf16 v[112:127], v[220:223], v[232:235], v[112:127]
    v_mfma_f32_32x32x16_bf16 v[176:191], v[220:223], v[236:239], v[176:191]
    s_waitcnt lgkmcnt(0)
    v_mfma_f32_32x32x16_bf16 v[64:79], v[192:195], v[224:227], v[64:79]
    ds_read_b128 v[232:235], v33
    ds_read_b128 v[236:239], v33 offset:16384
    v_mfma_f32_32x32x16_bf16 v[128:143], v[192:195], v[228:231], v[128:143]
    ds_read_b64_tr_b16 v[208:209], v25 offset:12288
    ds_read_b64_tr_b16 v[210:211], v25 offset:13312
    v_mfma_f32_32x32x16_bf16 v[80:95], v[196:199], v[224:227], v[80:95]
    ds_read_b64_tr_b16 v[212:213], v26 offset:12288
    ds_read_b64_tr_b16 v[214:215], v26 offset:13312
    v_mfma_f32_32x32x16_bf16 v[144:159], v[196:199], v[228:231], v[144:159]
    ds_read_b64_tr_b16 v[216:217], v27 offset:12288
    ds_read_b64_tr_b16 v[218:219], v27 offset:13312
    v_mfma_f32_32x32x16_bf16 v[96:111], v[200:203], v[224:227], v[96:111]
    ds_read_b64_tr_b16 v[220:221], v28 offset:12288
    ds_read_b64_tr_b16 v[222:223], v28 offset:13312
    v_mfma_f32_32x32x16_bf16 v[160:175], v[200:203], v[228:231], v[160:175]
    v_mfma_f32_32x32x16_bf16 v[112:127], v[204:207], v[224:227], v[112:127]
    v_mfma_f32_32x32x16_bf16 v[176:191], v[204:207], v[228:231], v[176:191]
    s_waitcnt lgkmcnt(0)
    s_barrier
    v_mfma_f32_32x32x16_bf16 v[64:79], v[208:211], v[232:235], v[64:79]
    v_add_u32 v25, 98304, v20
    v_add_u32 v26, 98304, v21
    v_add_u32 v27, 98304, v22
    v_mfma_f32_32x32x16_bf16 v[128:143], v[208:211], v[236:239], v[128:143]
    v_add_u32 v28, 98304, v23
    v_add_u32 v30, 98304, v34
    v_add_u32 v31, 98304, v35
    v_mfma_f32_32x32x16_bf16 v[80:95], v[212:215], v[232:235], v[80:95]
    v_add_u32 v32, 98304, v36
    v_add_u32 v33, 98304, v37
    ds_read_b128 v[224:227], v30
    v_mfma_f32_32x32x16_bf16 v[144:159], v[212:215], v[236:239], v[144:159]
    ds_read_b128 v[228:231], v30 offset:16384
    ds_read_b64_tr_b16 v[192:193], v25 offset:0
    ds_read_b64_tr_b16 v[194:195], v25 offset:1024
    v_mfma_f32_32x32x16_bf16 v[96:111], v[216:219], v[232:235], v[96:111]
    ds_read_b64_tr_b16 v[196:197], v26 offset:0
    ds_read_b64_tr_b16 v[198:199], v26 offset:1024
    ds_read_b64_tr_b16 v[200:201], v27 offset:0
    v_mfma_f32_32x32x16_bf16 v[160:175], v[216:219], v[236:239], v[160:175]
    ds_read_b64_tr_b16 v[202:203], v27 offset:1024
    ds_read_b64_tr_b16 v[204:205], v28 offset:0
    ds_read_b64_tr_b16 v[206:207], v28 offset:1024
    v_mfma_f32_32x32x16_bf16 v[112:127], v[220:223], v[232:235], v[112:127]
    v_mfma_f32_32x32x16_bf16 v[176:191], v[220:223], v[236:239], v[176:191]
    s_waitcnt lgkmcnt(0)
    v_mfma_f32_32x32x16_bf16 v[64:79], v[192:195], v[224:227], v[64:79]
    ds_read_b128 v[232:235], v31
    ds_read_b128 v[236:239], v31 offset:16384
    v_mfma_f32_32x32x16_bf16 v[128:143], v[192:195], v[228:231], v[128:143]
    ds_read_b64_tr_b16 v[208:209], v25 offset:4096
    ds_read_b64_tr_b16 v[210:211], v25 offset:5120
    v_mfma_f32_32x32x16_bf16 v[80:95], v[196:199], v[224:227], v[80:95]
    ds_read_b64_tr_b16 v[212:213], v26 offset:4096
    ds_read_b64_tr_b16 v[214:215], v26 offset:5120
    v_mfma_f32_32x32x16_bf16 v[144:159], v[196:199], v[228:231], v[144:159]
    ds_read_b64_tr_b16 v[216:217], v27 offset:4096
    ds_read_b64_tr_b16 v[218:219], v27 offset:5120
    v_mfma_f32_32x32x16_bf16 v[96:111], v[200:203], v[224:227], v[96:111]
    ds_read_b64_tr_b16 v[220:221], v28 offset:4096
    ds_read_b64_tr_b16 v[222:223], v28 offset:5120
    v_mfma_f32_32x32x16_bf16 v[160:175], v[200:203], v[228:231], v[160:175]
    v_mfma_f32_32x32x16_bf16 v[112:127], v[204:207], v[224:227], v[112:127]
    v_mfma_f32_32x32x16_bf16 v[176:191], v[204:207], v[228:231], v[176:191]
    s_waitcnt lgkmcnt(0)
    v_mfma_f32_32x32x16_bf16 v[64:79], v[208:211], v[232:235], v[64:79]
    ds_read_b128 v[224:227], v32
    ds_read_b128 v[228:231], v32 offset:16384
    v_mfma_f32_32x32x16_bf16 v[128:143], v[208:211], v[236:239], v[128:143]
    ds_read_b64_tr_b16 v[192:193], v25 offset:8192
    ds_read_b64_tr_b16 v[194:195], v25 offset:9216
    v_mfma_f32_32x32x16_bf16 v[80:95], v[212:215], v[232:235], v[80:95]
    ds_read_b64_tr_b16 v[196:197], v26 offset:8192
    ds_read_b64_tr_b16 v[198:199], v26 offset:9216
    v_mfma_f32_32x32x16_bf16 v[144:159], v[212:215], v[236:239], v[144:159]
    ds_read_b64_tr_b16 v[200:201], v27 offset:8192
    ds_read_b64_tr_b16 v[202:203], v27 offset:9216
    v_mfma_f32_32x32x16_bf16 v[96:111], v[216:219], v[232:235], v[96:111]
    ds_read_b64_tr_b16 v[204:205], v28 offset:8192
    ds_read_b64_tr_b16 v[206:207], v28 offset:9216
    v_mfma_f32_32x32x16_bf16 v[160:175], v[216:219], v[236:239], v[160:175]
    v_mfma_f32_32x32x16_bf16 v[112:127], v[220:223], v[232:235], v[112:127]
    v_mfma_f32_32x32x16_bf16 v[176:191], v[220:223], v[236:239], v[176:191]
    s_waitcnt lgkmcnt(0)
    v_mfma_f32_32x32x16_bf16 v[64:79], v[192:195], v[224:227], v[64:79]
    ds_read_b128 v[232:235], v33
    ds_read_b128 v[236:239], v33 offset:16384
    v_mfma_f32_32x32x16_bf16 v[128:143], v[192:195], v[228:231], v[128:143]
    ds_read_b64_tr_b16 v[208:209], v25 offset:12288
    ds_read_b64_tr_b16 v[210:211], v25 offset:13312
    v_mfma_f32_32x32x16_bf16 v[80:95], v[196:199], v[224:227], v[80:95]
    ds_read_b64_tr_b16 v[212:213], v26 offset:12288
    ds_read_b64_tr_b16 v[214:215], v26 offset:13312
    v_mfma_f32_32x32x16_bf16 v[144:159], v[196:199], v[228:231], v[144:159]
    ds_read_b64_tr_b16 v[216:217], v27 offset:12288
    ds_read_b64_tr_b16 v[218:219], v27 offset:13312
    v_mfma_f32_32x32x16_bf16 v[96:111], v[200:203], v[224:227], v[96:111]
    ds_read_b64_tr_b16 v[220:221], v28 offset:12288
    ds_read_b64_tr_b16 v[222:223], v28 offset:13312
    v_mfma_f32_32x32x16_bf16 v[160:175], v[200:203], v[228:231], v[160:175]
    v_mfma_f32_32x32x16_bf16 v[112:127], v[204:207], v[224:227], v[112:127]
    v_mfma_f32_32x32x16_bf16 v[176:191], v[204:207], v[228:231], v[176:191]
    s_waitcnt lgkmcnt(0)
    s_barrier
    v_mfma_f32_32x32x16_bf16 v[64:79], v[208:211], v[232:235], v[64:79]
    v_add_u32 v25, 0, v20
    v_add_u32 v26, 0, v21
    v_add_u32 v27, 0, v22
    v_mfma_f32_32x32x16_bf16 v[128:143], v[208:211], v[236:239], v[128:143]
    v_add_u32 v28, 0, v23
    v_add_u32 v30, 0, v34
    v_add_u32 v31, 0, v35
    v_mfma_f32_32x32x16_bf16 v[80:95], v[212:215], v[232:235], v[80:95]
    v_add_u32 v32, 0, v36
    v_add_u32 v33, 0, v37
    ds_read_b128 v[224:227], v30
    v_mfma_f32_32x32x16_bf16 v[144:159], v[212:215], v[236:239], v[144:159]
    ds_read_b128 v[228:231], v30 offset:16384
    ds_read_b64_tr_b16 v[192:193], v25 offset:0
    ds_read_b64_tr_b16 v[194:195], v25 offset:1024
    v_mfma_f32_32x32x16_bf16 v[96:111], v[216:219], v[232:235], v[96:111]
    ds_read_b64_tr_b16 v[196:197], v26 offset:0
    ds_read_b64_tr_b16 v[198:199], v26 offset:1024
    ds_read_b64_tr_b16 v[200:201], v27 offset:0
    v_mfma_f32_32x32x16_bf16 v[160:175], v[216:219], v[236:239], v[160:175]
    ds_read_b64_tr_b16 v[202:203], v27 offset:1024
    ds_read_b64_tr_b16 v[204:205], v28 offset:0
    ds_read_b64_tr_b16 v[206:207], v28 offset:1024
    v_mfma_f32_32x32x16_bf16 v[112:127], v[220:223], v[232:235], v[112:127]
    v_mfma_f32_32x32x16_bf16 v[176:191], v[220:223], v[236:239], v[176:191]
    s_waitcnt lgkmcnt(0)
    v_mfma_f32_32x32x16_bf16 v[64:79], v[192:195], v[224:227], v[64:79]
    ds_read_b128 v[232:235], v31
    ds_read_b128 v[236:239], v31 offset:16384
    v_mfma_f32_32x32x16_bf16 v[128:143], v[192:195], v[228:231], v[128:143]
    ds_read_b64_tr_b16 v[208:209], v25 offset:4096
    ds_read_b64_tr_b16 v[210:211], v25 offset:5120
    v_mfma_f32_32x32x16_bf16 v[80:95], v[196:199], v[224:227], v[80:95]
    ds_read_b64_tr_b16 v[212:213], v26 offset:4096
    ds_read_b64_tr_b16 v[214:215], v26 offset:5120
    v_mfma_f32_32x32x16_bf16 v[144:159], v[196:199], v[228:231], v[144:159]
    ds_read_b64_tr_b16 v[216:217], v27 offset:4096
    ds_read_b64_tr_b16 v[218:219], v27 offset:5120
    v_mfma_f32_32x32x16_bf16 v[96:111], v[200:203], v[224:227], v[96:111]
    ds_read_b64_tr_b16 v[220:221], v28 offset:4096
    ds_read_b64_tr_b16 v[222:223], v28 offset:5120
    v_mfma_f32_32x32x16_bf16 v[160:175], v[200:203], v[228:231], v[160:175]
    v_mfma_f32_32x32x16_bf16 v[112:127], v[204:207], v[224:227], v[112:127]
    v_mfma_f32_32x32x16_bf16 v[176:191], v[204:207], v[228:231], v[176:191]
    s_waitcnt lgkmcnt(0)
    v_mfma_f32_32x32x16_bf16 v[64:79], v[208:211], v[232:235], v[64:79]
    ds_read_b128 v[224:227], v32
    ds_read_b128 v[228:231], v32 offset:16384
    v_mfma_f32_32x32x16_bf16 v[128:143], v[208:211], v[236:239], v[128:143]
    ds_read_b64_tr_b16 v[192:193], v25 offset:8192
    ds_read_b64_tr_b16 v[194:195], v25 offset:9216
    v_mfma_f32_32x32x16_bf16 v[80:95], v[212:215], v[232:235], v[80:95]
    ds_read_b64_tr_b16 v[196:197], v26 offset:8192
    ds_read_b64_tr_b16 v[198:199], v26 offset:9216
    v_mfma_f32_32x32x16_bf16 v[144:159], v[212:215], v[236:239], v[144:159]
    ds_read_b64_tr_b16 v[200:201], v27 offset:8192
    ds_read_b64_tr_b16 v[202:203], v27 offset:9216
    v_mfma_f32_32x32x16_bf16 v[96:111], v[216:219], v[232:235], v[96:111]
    ds_read_b64_tr_b16 v[204:205], v28 offset:8192
    ds_read_b64_tr_b16 v[206:207], v28 offset:9216
    v_mfma_f32_32x32x16_bf16 v[160:175], v[216:219], v[236:239], v[160:175]
    v_mfma_f32_32x32x16_bf16 v[112:127], v[220:223], v[232:235], v[112:127]
    v_mfma_f32_32x32x16_bf16 v[176:191], v[220:223], v[236:239], v[176:191]
    s_waitcnt lgkmcnt(0)
    v_mfma_f32_32x32x16_bf16 v[64:79], v[192:195], v[224:227], v[64:79]
    ds_read_b128 v[232:235], v33
    ds_read_b128 v[236:239], v33 offset:16384
    v_mfma_f32_32x32x16_bf16 v[128:143], v[192:195], v[228:231], v[128:143]
    ds_read_b64_tr_b16 v[208:209], v25 offset:12288
    ds_read_b64_tr_b16 v[210:211], v25 offset:13312
    v_mfma_f32_32x32x16_bf16 v[80:95], v[196:199], v[224:227], v[80:95]
    ds_read_b64_tr_b16 v[212:213], v26 offset:12288
    ds_read_b64_tr_b16 v[214:215], v26 offset:13312
    v_mfma_f32_32x32x16_bf16 v[144:159], v[196:199], v[228:231], v[144:159]
    ds_read_b64_tr_b16 v[216:217], v27 offset:12288
    ds_read_b64_tr_b16 v[218:219], v27 offset:13312
    v_mfma_f32_32x32x16_bf16 v[96:111], v[200:203], v[224:227], v[96:111]
    ds_read_b64_tr_b16 v[220:221], v28 offset:12288
    ds_read_b64_tr_b16 v[222:223], v28 offset:13312
    v_mfma_f32_32x32x16_bf16 v[160:175], v[200:203], v[228:231], v[160:175]
    v_mfma_f32_32x32x16_bf16 v[112:127], v[204:207], v[224:227], v[112:127]
    v_mfma_f32_32x32x16_bf16 v[176:191], v[204:207], v[228:231], v[176:191]
    s_waitcnt lgkmcnt(0)
    s_barrier
    v_mfma_f32_32x32x16_bf16 v[64:79], v[208:211], v[232:235], v[64:79]
    v_add_u32 v25, 49152, v20
    v_add_u32 v26, 49152, v21
    v_add_u32 v27, 49152, v22
    v_mfma_f32_32x32x16_bf16 v[128:143], v[208:211], v[236:239], v[128:143]
    v_add_u32 v28, 49152, v23
    v_add_u32 v30, 49152, v34
    v_add_u32 v31, 49152, v35
    v_mfma_f32_32x32x16_bf16 v[80:95], v[212:215], v[232:235], v[80:95]
    v_add_u32 v32, 49152, v36
    v_add_u32 v33, 49152, v37
    ds_read_b128 v[224:227], v30
    v_mfma_f32_32x32x16_bf16 v[144:159], v[212:215], v[236:239], v[144:159]
    ds_read_b128 v[228:231], v30 offset:16384
    ds_read_b64_tr_b16 v[192:193], v25 offset:0
    ds_read_b64_tr_b16 v[194:195], v25 offset:1024
    v_mfma_f32_32x32x16_bf16 v[96:111], v[216:219], v[232:235], v[96:111]
    ds_read_b64_tr_b16 v[196:197], v26 offset:0
    ds_read_b64_tr_b16 v[198:199], v26 offset:1024
    ds_read_b64_tr_b16 v[200:201], v27 offset:0
    v_mfma_f32_32x32x16_bf16 v[160:175], v[216:219], v[236:239], v[160:175]
    ds_read_b64_tr_b16 v[202:203], v27 offset:1024
    ds_read_b64_tr_b16 v[204:205], v28 offset:0
    ds_read_b64_tr_b16 v[206:207], v28 offset:1024
    v_mfma_f32_32x32x16_bf16 v[112:127], v[220:223], v[232:235], v[112:127]
    v_mfma_f32_32x32x16_bf16 v[176:191], v[220:223], v[236:239], v[176:191]
    s_waitcnt lgkmcnt(0)
    v_mfma_f32_32x32x16_bf16 v[64:79], v[192:195], v[224:227], v[64:79]
    ds_read_b128 v[232:235], v31
    ds_read_b128 v[236:239], v31 offset:16384
    buffer_load_dword v38, v12, s[8:11], s73 offen
    v_mfma_f32_32x32x16_bf16 v[128:143], v[192:195], v[228:231], v[128:143]
    ds_read_b64_tr_b16 v[208:209], v25 offset:4096
    ds_read_b64_tr_b16 v[210:211], v25 offset:5120
    v_mfma_f32_32x32x16_bf16 v[80:95], v[196:199], v[224:227], v[80:95]
    ds_read_b64_tr_b16 v[212:213], v26 offset:4096
    ds_read_b64_tr_b16 v[214:215], v26 offset:5120
    v_mfma_f32_32x32x16_bf16 v[144:159], v[196:199], v[228:231], v[144:159]
    ds_read_b64_tr_b16 v[216:217], v27 offset:4096
    ds_read_b64_tr_b16 v[218:219], v27 offset:5120
    v_mfma_f32_32x32x16_bf16 v[96:111], v[200:203], v[224:227], v[96:111]
    ds_read_b64_tr_b16 v[220:221], v28 offset:4096
    ds_read_b64_tr_b16 v[222:223], v28 offset:5120
    v_mfma_f32_32x32x16_bf16 v[160:175], v[200:203], v[228:231], v[160:175]
    v_mfma_f32_32x32x16_bf16 v[112:127], v[204:207], v[224:227], v[112:127]
    v_mfma_f32_32x32x16_bf16 v[176:191], v[204:207], v[228:231], v[176:191]
    s_waitcnt lgkmcnt(0)
    v_mfma_f32_32x32x16_bf16 v[64:79], v[208:211], v[232:235], v[64:79]
    ds_read_b128 v[224:227], v32
    ds_read_b128 v[228:231], v32 offset:16384
    v_mfma_f32_32x32x16_bf16 v[128:143], v[208:211], v[236:239], v[128:143]
    ds_read_b64_tr_b16 v[192:193], v25 offset:8192
    ds_read_b64_tr_b16 v[194:195], v25 offset:9216
    v_mfma_f32_32x32x16_bf16 v[80:95], v[212:215], v[232:235], v[80:95]
    ds_read_b64_tr_b16 v[196:197], v26 offset:8192
    ds_read_b64_tr_b16 v[198:199], v26 offset:9216
    v_mfma_f32_32x32x16_bf16 v[144:159], v[212:215], v[236:239], v[144:159]
    ds_read_b64_tr_b16 v[200:201], v27 offset:8192
    ds_read_b64_tr_b16 v[202:203], v27 offset:9216
    v_mfma_f32_32x32x16_bf16 v[96:111], v[216:219], v[232:235], v[96:111]
    ds_read_b64_tr_b16 v[204:205], v28 offset:8192
    ds_read_b64_tr_b16 v[206:207], v28 offset:9216
    v_mfma_f32_32x32x16_bf16 v[160:175], v[216:219], v[236:239], v[160:175]
    v_mfma_f32_32x32x16_bf16 v[112:127], v[220:223], v[232:235], v[112:127]
    v_mfma_f32_32x32x16_bf16 v[176:191], v[220:223], v[236:239], v[176:191]
    s_waitcnt lgkmcnt(0)
    v_mfma_f32_32x32x16_bf16 v[64:79], v[192:195], v[224:227], v[64:79]
    ds_read_b128 v[232:235], v33
    ds_read_b128 v[236:239], v33 offset:16384
    v_mfma_f32_32x32x16_bf16 v[128:143], v[192:195], v[228:231], v[128:143]
    ds_read_b64_tr_b16 v[208:209], v25 offset:12288
    ds_read_b64_tr_b16 v[210:211], v25 offset:13312
    v_mfma_f32_32x32x16_bf16 v[80:95], v[196:199], v[224:227], v[80:95]
    ds_read_b64_tr_b16 v[212:213], v26 offset:12288
    ds_read_b64_tr_b16 v[214:215], v26 offset:13312
    v_mfma_f32_32x32x16_bf16 v[144:159], v[196:199], v[228:231], v[144:159]
    ds_read_b64_tr_b16 v[216:217], v27 offset:12288
    ds_read_b64_tr_b16 v[218:219], v27 offset:13312
    v_mfma_f32_32x32x16_bf16 v[96:111], v[200:203], v[224:227], v[96:111]
    ds_read_b64_tr_b16 v[220:221], v28 offset:12288
    ds_read_b64_tr_b16 v[222:223], v28 offset:13312
    v_mfma_f32_32x32x16_bf16 v[160:175], v[200:203], v[228:231], v[160:175]
    v_mfma_f32_32x32x16_bf16 v[112:127], v[204:207], v[224:227], v[112:127]
    v_mfma_f32_32x32x16_bf16 v[176:191], v[204:207], v[228:231], v[176:191]
    s_waitcnt lgkmcnt(0)
    s_barrier
    v_mfma_f32_32x32x16_bf16 v[64:79], v[208:211], v[232:235], v[64:79]
    v_add_u32 v25, 98304, v20
    v_add_u32 v26, 98304, v21
    v_add_u32 v27, 98304, v22
    v_mfma_f32_32x32x16_bf16 v[128:143], v[208:211], v[236:239], v[128:143]
    v_add_u32 v28, 98304, v23
    v_add_u32 v30, 98304, v34
    v_add_u32 v31, 98304, v35
    v_mfma_f32_32x32x16_bf16 v[80:95], v[212:215], v[232:235], v[80:95]
    v_add_u32 v32, 98304, v36
    v_add_u32 v33, 98304, v37
    ds_read_b128 v[224:227], v30
    v_mfma_f32_32x32x16_bf16 v[144:159], v[212:215], v[236:239], v[144:159]
    ds_read_b128 v[228:231], v30 offset:16384
    ds_read_b64_tr_b16 v[192:193], v25 offset:0
    ds_read_b64_tr_b16 v[194:195], v25 offset:1024
    v_mfma_f32_32x32x16_bf16 v[96:111], v[216:219], v[232:235], v[96:111]
    ds_read_b64_tr_b16 v[196:197], v26 offset:0
    ds_read_b64_tr_b16 v[198:199], v26 offset:1024
    ds_read_b64_tr_b16 v[200:201], v27 offset:0
    v_mfma_f32_32x32x16_bf16 v[160:175], v[216:219], v[236:239], v[160:175]
    ds_read_b64_tr_b16 v[202:203], v27 offset:1024
    ds_read_b64_tr_b16 v[204:205], v28 offset:0
    ds_read_b64_tr_b16 v[206:207], v28 offset:1024
    v_mfma_f32_32x32x16_bf16 v[112:127], v[220:223], v[232:235], v[112:127]
    v_mfma_f32_32x32x16_bf16 v[176:191], v[220:223], v[236:239], v[176:191]
    s_waitcnt lgkmcnt(0)
    v_mfma_f32_32x32x16_bf16 v[64:79], v[192:195], v[224:227], v[64:79]
    ds_read_b128 v[232:235], v31
    ds_read_b128 v[236:239], v31 offset:16384
    v_mfma_f32_32x32x16_bf16 v[128:143], v[192:195], v[228:231], v[128:143]
    ds_read_b64_tr_b16 v[208:209], v25 offset:4096
    ds_read_b64_tr_b16 v[210:211], v25 offset:5120
    v_mfma_f32_32x32x16_bf16 v[80:95], v[196:199], v[224:227], v[80:95]
    ds_read_b64_tr_b16 v[212:213], v26 offset:4096
    ds_read_b64_tr_b16 v[214:215], v26 offset:5120
    v_mfma_f32_32x32x16_bf16 v[144:159], v[196:199], v[228:231], v[144:159]
    ds_read_b64_tr_b16 v[216:217], v27 offset:4096
    ds_read_b64_tr_b16 v[218:219], v27 offset:5120
    v_mfma_f32_32x32x16_bf16 v[96:111], v[200:203], v[224:227], v[96:111]
    ds_read_b64_tr_b16 v[220:221], v28 offset:4096
    ds_read_b64_tr_b16 v[222:223], v28 offset:5120
    v_mfma_f32_32x32x16_bf16 v[160:175], v[200:203], v[228:231], v[160:175]
    v_mfma_f32_32x32x16_bf16 v[112:127], v[204:207], v[224:227], v[112:127]
    v_mfma_f32_32x32x16_bf16 v[176:191], v[204:207], v[228:231], v[176:191]
    s_waitcnt lgkmcnt(0)
    v_mfma_f32_32x32x16_bf16 v[64:79], v[208:211], v[232:235], v[64:79]
    ds_read_b128 v[224:227], v32
    ds_read_b128 v[228:231], v32 offset:16384
    v_mfma_f32_32x32x16_bf16 v[128:143], v[208:211], v[236:239], v[128:143]
    ds_read_b64_tr_b16 v[192:193], v25 offset:8192
    ds_read_b64_tr_b16 v[194:195], v25 offset:9216
    v_mfma_f32_32x32x16_bf16 v[80:95], v[212:215], v[232:235], v[80:95]
    ds_read_b64_tr_b16 v[196:197], v26 offset:8192
    ds_read_b64_tr_b16 v[198:199], v26 offset:9216
    v_mfma_f32_32x32x16_bf16 v[144:159], v[212:215], v[236:239], v[144:159]
    ds_read_b64_tr_b16 v[200:201], v27 offset:8192
    ds_read_b64_tr_b16 v[202:203], v27 offset:9216
    v_mfma_f32_32x32x16_bf16 v[96:111], v[216:219], v[232:235], v[96:111]
    ds_read_b64_tr_b16 v[204:205], v28 offset:8192
    ds_read_b64_tr_b16 v[206:207], v28 offset:9216
    v_mfma_f32_32x32x16_bf16 v[160:175], v[216:219], v[236:239], v[160:175]
    v_mfma_f32_32x32x16_bf16 v[112:127], v[220:223], v[232:235], v[112:127]
    v_mfma_f32_32x32x16_bf16 v[176:191], v[220:223], v[236:239], v[176:191]
    s_waitcnt lgkmcnt(0)
    v_mfma_f32_32x32x16_bf16 v[64:79], v[192:195], v[224:227], v[64:79]
    ds_read_b128 v[232:235], v33
    ds_read_b128 v[236:239], v33 offset:16384
    v_mfma_f32_32x32x16_bf16 v[128:143], v[192:195], v[228:231], v[128:143]
    ds_read_b64_tr_b16 v[208:209], v25 offset:12288
    ds_read_b64_tr_b16 v[210:211], v25 offset:13312
    v_mfma_f32_32x32x16_bf16 v[80:95], v[196:199], v[224:227], v[80:95]
    ds_read_b64_tr_b16 v[212:213], v26 offset:12288
    ds_read_b64_tr_b16 v[214:215], v26 offset:13312
    v_mfma_f32_32x32x16_bf16 v[144:159], v[196:199], v[228:231], v[144:159]
    ds_read_b64_tr_b16 v[216:217], v27 offset:12288
    ds_read_b64_tr_b16 v[218:219], v27 offset:13312
    v_mfma_f32_32x32x16_bf16 v[96:111], v[200:203], v[224:227], v[96:111]
    ds_read_b64_tr_b16 v[220:221], v28 offset:12288
    ds_read_b64_tr_b16 v[222:223], v28 offset:13312
    v_mfma_f32_32x32x16_bf16 v[160:175], v[200:203], v[228:231], v[160:175]
    v_mfma_f32_32x32x16_bf16 v[112:127], v[204:207], v[224:227], v[112:127]
    v_mfma_f32_32x32x16_bf16 v[176:191], v[204:207], v[228:231], v[176:191]
    s_waitcnt lgkmcnt(0)
    s_barrier
    v_mfma_f32_32x32x16_bf16 v[64:79], v[208:211], v[232:235], v[64:79]
    v_add_u32 v25, 0, v20
    v_add_u32 v26, 0, v21
    v_add_u32 v27, 0, v22
    v_mfma_f32_32x32x16_bf16 v[128:143], v[208:211], v[236:239], v[128:143]
    v_add_u32 v28, 0, v23
    v_add_u32 v30, 0, v34
    v_add_u32 v31, 0, v35
    v_mfma_f32_32x32x16_bf16 v[80:95], v[212:215], v[232:235], v[80:95]
    v_add_u32 v32, 0, v36
    v_add_u32 v33, 0, v37
    ds_read_b128 v[224:227], v30
    v_mfma_f32_32x32x16_bf16 v[144:159], v[212:215], v[236:239], v[144:159]
    ds_read_b128 v[228:231], v30 offset:16384
    ds_read_b64_tr_b16 v[192:193], v25 offset:0
    ds_read_b64_tr_b16 v[194:195], v25 offset:1024
    v_mfma_f32_32x32x16_bf16 v[96:111], v[216:219], v[232:235], v[96:111]
    ds_read_b64_tr_b16 v[196:197], v26 offset:0
    ds_read_b64_tr_b16 v[198:199], v26 offset:1024
    ds_read_b64_tr_b16 v[200:201], v27 offset:0
    v_mfma_f32_32x32x16_bf16 v[160:175], v[216:219], v[236:239], v[160:175]
    ds_read_b64_tr_b16 v[202:203], v27 offset:1024
    ds_read_b64_tr_b16 v[204:205], v28 offset:0
    ds_read_b64_tr_b16 v[206:207], v28 offset:1024
    v_mfma_f32_32x32x16_bf16 v[112:127], v[220:223], v[232:235], v[112:127]
    v_mfma_f32_32x32x16_bf16 v[176:191], v[220:223], v[236:239], v[176:191]
    s_waitcnt lgkmcnt(0)
    v_mfma_f32_32x32x16_bf16 v[64:79], v[192:195], v[224:227], v[64:79]
    ds_read_b128 v[232:235], v31
    ds_read_b128 v[236:239], v31 offset:16384
    v_mfma_f32_32x32x16_bf16 v[128:143], v[192:195], v[228:231], v[128:143]
    ds_read_b64_tr_b16 v[208:209], v25 offset:4096
    ds_read_b64_tr_b16 v[210:211], v25 offset:5120
    v_mfma_f32_32x32x16_bf16 v[80:95], v[196:199], v[224:227], v[80:95]
    ds_read_b64_tr_b16 v[212:213], v26 offset:4096
    ds_read_b64_tr_b16 v[214:215], v26 offset:5120
    v_mfma_f32_32x32x16_bf16 v[144:159], v[196:199], v[228:231], v[144:159]
    ds_read_b64_tr_b16 v[216:217], v27 offset:4096
    ds_read_b64_tr_b16 v[218:219], v27 offset:5120
    v_mfma_f32_32x32x16_bf16 v[96:111], v[200:203], v[224:227], v[96:111]
    ds_read_b64_tr_b16 v[220:221], v28 offset:4096
    ds_read_b64_tr_b16 v[222:223], v28 offset:5120
    v_mfma_f32_32x32x16_bf16 v[160:175], v[200:203], v[228:231], v[160:175]
    v_mfma_f32_32x32x16_bf16 v[112:127], v[204:207], v[224:227], v[112:127]
    v_mfma_f32_32x32x16_bf16 v[176:191], v[204:207], v[228:231], v[176:191]
    s_waitcnt lgkmcnt(0)
    v_mfma_f32_32x32x16_bf16 v[64:79], v[208:211], v[232:235], v[64:79]
    ds_read_b128 v[224:227], v32
    ds_read_b128 v[228:231], v32 offset:16384
    v_mfma_f32_32x32x16_bf16 v[128:143], v[208:211], v[236:239], v[128:143]
    ds_read_b64_tr_b16 v[192:193], v25 offset:8192
    ds_read_b64_tr_b16 v[194:195], v25 offset:9216
    v_mfma_f32_32x32x16_bf16 v[80:95], v[212:215], v[232:235], v[80:95]
    ds_read_b64_tr_b16 v[196:197], v26 offset:8192
    ds_read_b64_tr_b16 v[198:199], v26 offset:9216
    v_mfma_f32_32x32x16_bf16 v[144:159], v[212:215], v[236:239], v[144:159]
    ds_read_b64_tr_b16 v[200:201], v27 offset:8192
    ds_read_b64_tr_b16 v[202:203], v27 offset:9216
    v_mfma_f32_32x32x16_bf16 v[96:111], v[216:219], v[232:235], v[96:111]
    ds_read_b64_tr_b16 v[204:205], v28 offset:8192
    ds_read_b64_tr_b16 v[206:207], v28 offset:9216
    v_mfma_f32_32x32x16_bf16 v[160:175], v[216:219], v[236:239], v[160:175]
    v_mfma_f32_32x32x16_bf16 v[112:127], v[220:223], v[232:235], v[112:127]
    v_mfma_f32_32x32x16_bf16 v[176:191], v[220:223], v[236:239], v[176:191]
    s_waitcnt lgkmcnt(0)
    v_mfma_f32_32x32x16_bf16 v[64:79], v[192:195], v[224:227], v[64:79]
    ds_read_b128 v[232:235], v33
    ds_read_b128 v[236:239], v33 offset:16384
    v_mfma_f32_32x32x16_bf16 v[128:143], v[192:195], v[228:231], v[128:143]
    ds_read_b64_tr_b16 v[208:209], v25 offset:12288
    ds_read_b64_tr_b16 v[210:211], v25 offset:13312
    v_mfma_f32_32x32x16_bf16 v[80:95], v[196:199], v[224:227], v[80:95]
    ds_read_b64_tr_b16 v[212:213], v26 offset:12288
    ds_read_b64_tr_b16 v[214:215], v26 offset:13312
    v_mfma_f32_32x32x16_bf16 v[144:159], v[196:199], v[228:231], v[144:159]
    ds_read_b64_tr_b16 v[216:217], v27 offset:12288
    ds_read_b64_tr_b16 v[218:219], v27 offset:13312
    v_mfma_f32_32x32x16_bf16 v[96:111], v[200:203], v[224:227], v[96:111]
    ds_read_b64_tr_b16 v[220:221], v28 offset:12288
    ds_read_b64_tr_b16 v[222:223], v28 offset:13312
    v_mfma_f32_32x32x16_bf16 v[160:175], v[200:203], v[228:231], v[160:175]
    v_mfma_f32_32x32x16_bf16 v[112:127], v[204:207], v[224:227], v[112:127]
    v_mfma_f32_32x32x16_bf16 v[176:191], v[204:207], v[228:231], v[176:191]
    s_waitcnt lgkmcnt(0)
    s_barrier
    v_mfma_f32_32x32x16_bf16 v[64:79], v[208:211], v[232:235], v[64:79]
    v_add_u32 v25, 49152, v20
    v_add_u32 v26, 49152, v21
    v_add_u32 v27, 49152, v22
    v_mfma_f32_32x32x16_bf16 v[128:143], v[208:211], v[236:239], v[128:143]
    v_add_u32 v28, 49152, v23
    v_add_u32 v30, 49152, v34
    v_add_u32 v31, 49152, v35
    v_mfma_f32_32x32x16_bf16 v[80:95], v[212:215], v[232:235], v[80:95]
    v_add_u32 v32, 49152, v36
    v_add_u32 v33, 49152, v37
    ds_read_b128 v[224:227], v30
    v_mfma_f32_32x32x16_bf16 v[144:159], v[212:215], v[236:239], v[144:159]
    ds_read_b128 v[228:231], v30 offset:16384
    ds_read_b64_tr_b16 v[192:193], v25 offset:0
    ds_read_b64_tr_b16 v[194:195], v25 offset:1024
    v_mfma_f32_32x32x16_bf16 v[96:111], v[216:219], v[232:235], v[96:111]
    ds_read_b64_tr_b16 v[196:197], v26 offset:0
    ds_read_b64_tr_b16 v[198:199], v26 offset:1024
    ds_read_b64_tr_b16 v[200:201], v27 offset:0
    v_mfma_f32_32x32x16_bf16 v[160:175], v[216:219], v[236:239], v[160:175]
    ds_read_b64_tr_b16 v[202:203], v27 offset:1024
    ds_read_b64_tr_b16 v[204:205], v28 offset:0
    ds_read_b64_tr_b16 v[206:207], v28 offset:1024
    v_mfma_f32_32x32x16_bf16 v[112:127], v[220:223], v[232:235], v[112:127]
    v_mfma_f32_32x32x16_bf16 v[176:191], v[220:223], v[236:239], v[176:191]
    s_nop 15
    v_cvt_pk_bf16_f32 v64, v64, v65
    v_cvt_pk_bf16_f32 v65, v66, v67
    v_cvt_pk_bf16_f32 v66, v68, v69
    v_cvt_pk_bf16_f32 v67, v70, v71
    s_add_u32 s38, s52, 0
    buffer_store_dwordx4 v[64:67], v1, s[12:15], s38 offen sc0 sc1
    v_cvt_pk_bf16_f32 v72, v72, v73
    v_cvt_pk_bf16_f32 v73, v74, v75
    v_cvt_pk_bf16_f32 v74, v76, v77
    v_cvt_pk_bf16_f32 v75, v78, v79
    s_add_u32 s38, s52, 1024
    buffer_store_dwordx4 v[72:75], v1, s[12:15], s38 offen sc0 sc1
    v_cvt_pk_bf16_f32 v80, v80, v81
    v_cvt_pk_bf16_f32 v81, v82, v83
    v_cvt_pk_bf16_f32 v82, v84, v85
    v_cvt_pk_bf16_f32 v83, v86, v87
    s_add_u32 s38, s52, 2048
    buffer_store_dwordx4 v[80:83], v1, s[12:15], s38 offen sc0 sc1
    v_cvt_pk_bf16_f32 v88, v88, v89
    v_cvt_pk_bf16_f32 v89, v90, v91
    v_cvt_pk_bf16_f32 v90, v92, v93
    v_cvt_pk_bf16_f32 v91, v94, v95
    s_add_u32 s38, s52, 3072
    buffer_store_dwordx4 v[88:91], v1, s[12:15], s38 offen sc0 sc1
    v_cvt_pk_bf16_f32 v96, v96, v97
    v_cvt_pk_bf16_f32 v97, v98, v99
    v_cvt_pk_bf16_f32 v98, v100, v101
    v_cvt_pk_bf16_f32 v99, v102, v103
    s_add_u32 s38, s52, 4096
    buffer_store_dwordx4 v[96:99], v1, s[12:15], s38 offen sc0 sc1
    v_cvt_pk_bf16_f32 v40, v104, v105
    v_cvt_pk_bf16_f32 v41, v106, v107
    v_cvt_pk_bf16_f32 v42, v108, v109
    v_cvt_pk_bf16_f32 v43, v110, v111
    v_cvt_pk_bf16_f32 v44, v112, v113
    v_cvt_pk_bf16_f32 v45, v114, v115
    v_cvt_pk_bf16_f32 v46, v116, v117
    v_cvt_pk_bf16_f32 v47, v118, v119
    v_cvt_pk_bf16_f32 v48, v120, v121
    v_cvt_pk_bf16_f32 v49, v122, v123
    v_cvt_pk_bf16_f32 v50, v124, v125
    v_cvt_pk_bf16_f32 v51, v126, v127
    v_cvt_pk_bf16_f32 v52, v128, v129
    v_cvt_pk_bf16_f32 v53, v130, v131
    v_cvt_pk_bf16_f32 v54, v132, v133
    v_cvt_pk_bf16_f32 v55, v134, v135
    v_cvt_pk_bf16_f32 v56, v136, v137
    v_cvt_pk_bf16_f32 v57, v138, v139
    v_cvt_pk_bf16_f32 v58, v140, v141
    v_cvt_pk_bf16_f32 v59, v142, v143
    v_cvt_pk_bf16_f32 v60, v144, v145
    v_cvt_pk_bf16_f32 v61, v146, v147
    v_cvt_pk_bf16_f32 v62, v148, v149
    v_cvt_pk_bf16_f32 v63, v150, v151
    v_cvt_pk_bf16_f32 v240, v152, v153
    v_cvt_pk_bf16_f32 v241, v154, v155
    v_cvt_pk_bf16_f32 v242, v156, v157
    v_cvt_pk_bf16_f32 v243, v158, v159
    v_cvt_pk_bf16_f32 v244, v160, v161
    v_cvt_pk_bf16_f32 v245, v162, v163
    v_cvt_pk_bf16_f32 v246, v164, v165
    v_cvt_pk_bf16_f32 v247, v166, v167
    v_cvt_pk_bf16_f32 v248, v168, v169
    v_cvt_pk_bf16_f32 v249, v170, v171
    v_cvt_pk_bf16_f32 v250, v172, v173
    v_cvt_pk_bf16_f32 v251, v174, v175
    v_cvt_pk_bf16_f32 v252, v176, v177
    v_cvt_pk_bf16_f32 v253, v178, v179
    v_cvt_pk_bf16_f32 v254, v180, v181
    v_cvt_pk_bf16_f32 v255, v182, v183
    v_cvt_pk_bf16_f32 v16, v184, v185
    v_cvt_pk_bf16_f32 v17, v186, v187
    v_cvt_pk_bf16_f32 v18, v188, v189
    v_cvt_pk_bf16_f32 v19, v190, v191
    s_nop 3
    s_waitcnt lgkmcnt(0)
    v_mfma_f32_32x32x16_bf16 v[64:79], v[224:227], v[192:195], 0
    ds_read_b128 v[232:235], v31
    ds_read_b128 v[236:239], v31 offset:16384
    s_add_u32 s38, s52, 5120
    buffer_store_dwordx4 v[40:43], v1, s[12:15], s38 offen sc0 sc1
    v_mfma_f32_32x32x16_bf16 v[128:143], v[228:231], v[192:195], 0
    ds_read_b64_tr_b16 v[208:209], v25 offset:4096
    ds_read_b64_tr_b16 v[210:211], v25 offset:5120
    v_mfma_f32_32x32x16_bf16 v[80:95], v[224:227], v[196:199], 0
    ds_read_b64_tr_b16 v[212:213], v26 offset:4096
    ds_read_b64_tr_b16 v[214:215], v26 offset:5120
    v_mfma_f32_32x32x16_bf16 v[144:159], v[228:231], v[196:199], 0
    ds_read_b64_tr_b16 v[216:217], v27 offset:4096
    ds_read_b64_tr_b16 v[218:219], v27 offset:5120
    v_mfma_f32_32x32x16_bf16 v[96:111], v[224:227], v[200:203], 0
    ds_read_b64_tr_b16 v[220:221], v28 offset:4096
    ds_read_b64_tr_b16 v[222:223], v28 offset:5120
    v_mfma_f32_32x32x16_bf16 v[160:175], v[228:231], v[200:203], 0
    v_mfma_f32_32x32x16_bf16 v[112:127], v[224:227], v[204:207], 0
    v_mfma_f32_32x32x16_bf16 v[176:191], v[228:231], v[204:207], 0
    s_waitcnt lgkmcnt(0)
    v_mfma_f32_32x32x16_bf16 v[64:79], v[232:235], v[208:211], v[64:79]
    ds_read_b128 v[224:227], v32
    ds_read_b128 v[228:231], v32 offset:16384
    v_mfma_f32_32x32x16_bf16 v[128:143], v[236:239], v[208:211], v[128:143]
    ds_read_b64_tr_b16 v[192:193], v25 offset:8192
    ds_read_b64_tr_b16 v[194:195], v25 offset:9216
    v_mfma_f32_32x32x16_bf16 v[80:95], v[232:235], v[212:215], v[80:95]
    ds_read_b64_tr_b16 v[196:197], v26 offset:8192
    ds_read_b64_tr_b16 v[198:199], v26 offset:9216
    v_mfma_f32_32x32x16_bf16 v[144:159], v[236:239], v[212:215], v[144:159]
    ds_read_b64_tr_b16 v[200:201], v27 offset:8192
    ds_read_b64_tr_b16 v[202:203], v27 offset:9216
    v_mfma_f32_32x32x16_bf16 v[96:111], v[232:235], v[216:219], v[96:111]
    ds_read_b64_tr_b16 v[204:205], v28 offset:8192
    ds_read_b64_tr_b16 v[206:207], v28 offset:9216
    v_mfma_f32_32x32x16_bf16 v[160:175], v[236:239], v[216:219], v[160:175]
    v_mfma_f32_32x32x16_bf16 v[112:127], v[232:235], v[220:223], v[112:127]
    v_mfma_f32_32x32x16_bf16 v[176:191], v[236:239], v[220:223], v[176:191]
    s_waitcnt lgkmcnt(0)
    v_mfma_f32_32x32x16_bf16 v[64:79], v[224:227], v[192:195], v[64:79]
    ds_read_b128 v[232:235], v33
    ds_read_b128 v[236:239], v33 offset:16384
    s_add_u32 s38, s52, 6144
    buffer_store_dwordx4 v[44:47], v1, s[12:15], s38 offen sc0 sc1
    v_mfma_f32_32x32x16_bf16 v[128:143], v[228:231], v[192:195], v[128:143]
    ds_read_b64_tr_b16 v[208:209], v25 offset:12288
    ds_read_b64_tr_b16 v[210:211], v25 offset:13312
    v_mfma_f32_32x32x16_bf16 v[80:95], v[224:227], v[196:199], v[80:95]
    ds_read_b64_tr_b16 v[212:213], v26 offset:12288
    ds_read_b64_tr_b16 v[214:215], v26 offset:13312
    v_mfma_f32_32x32x16_bf16 v[144:159], v[228:231], v[196:199], v[144:159]
    ds_read_b64_tr_b16 v[216:217], v27 offset:12288
    ds_read_b64_tr_b16 v[218:219], v27 offset:13312
    v_mfma_f32_32x32x16_bf16 v[96:111], v[224:227], v[200:203], v[96:111]
    ds_read_b64_tr_b16 v[220:221], v28 offset:12288
    ds_read_b64_tr_b16 v[222:223], v28 offset:13312
    v_mfma_f32_32x32x16_bf16 v[160:175], v[228:231], v[200:203], v[160:175]
    v_mfma_f32_32x32x16_bf16 v[112:127], v[224:227], v[204:207], v[112:127]
    v_mfma_f32_32x32x16_bf16 v[176:191], v[228:231], v[204:207], v[176:191]
    s_waitcnt lgkmcnt(0)
    s_barrier
    v_mfma_f32_32x32x16_bf16 v[64:79], v[232:235], v[208:211], v[64:79]
    v_add_u32 v25, 98304, v20
    v_add_u32 v26, 98304, v21
    v_add_u32 v27, 98304, v22
    v_mfma_f32_32x32x16_bf16 v[128:143], v[236:239], v[208:211], v[128:143]
    v_add_u32 v28, 98304, v23
    v_add_u32 v30, 98304, v34
    v_add_u32 v31, 98304, v35
    v_mfma_f32_32x32x16_bf16 v[80:95], v[232:235], v[212:215], v[80:95]
    v_add_u32 v32, 98304, v36
    v_add_u32 v33, 98304, v37
    ds_read_b128 v[224:227], v30
    v_mfma_f32_32x32x16_bf16 v[144:159], v[236:239], v[212:215], v[144:159]
    ds_read_b128 v[228:231], v30 offset:16384
    ds_read_b64_tr_b16 v[192:193], v25 offset:0
    ds_read_b64_tr_b16 v[194:195], v25 offset:1024
    v_mfma_f32_32x32x16_bf16 v[96:111], v[232:235], v[216:219], v[96:111]
    ds_read_b64_tr_b16 v[196:197], v26 offset:0
    ds_read_b64_tr_b16 v[198:199], v26 offset:1024
    ds_read_b64_tr_b16 v[200:201], v27 offset:0
    v_mfma_f32_32x32x16_bf16 v[160:175], v[236:239], v[216:219], v[160:175]
    ds_read_b64_tr_b16 v[202:203], v27 offset:1024
    ds_read_b64_tr_b16 v[204:205], v28 offset:0
    ds_read_b64_tr_b16 v[206:207], v28 offset:1024
    v_mfma_f32_32x32x16_bf16 v[112:127], v[232:235], v[220:223], v[112:127]
    v_mfma_f32_32x32x16_bf16 v[176:191], v[236:239], v[220:223], v[176:191]
    s_waitcnt lgkmcnt(0)
    v_mfma_f32_32x32x16_bf16 v[64:79], v[224:227], v[192:195], v[64:79]
    ds_read_b128 v[232:235], v31
    ds_read_b128 v[236:239], v31 offset:16384
    v_mfma_f32_32x32x16_bf16 v[128:143], v[228:231], v[192:195], v[128:143]
    ds_read_b64_tr_b16 v[208:209], v25 offset:4096
    ds_read_b64_tr_b16 v[210:211], v25 offset:5120
    v_mfma_f32_32x32x16_bf16 v[80:95], v[224:227], v[196:199], v[80:95]
    ds_read_b64_tr_b16 v[212:213], v26 offset:4096
    ds_read_b64_tr_b16 v[214:215], v26 offset:5120
    v_mfma_f32_32x32x16_bf16 v[144:159], v[228:231], v[196:199], v[144:159]
    ds_read_b64_tr_b16 v[216:217], v27 offset:4096
    ds_read_b64_tr_b16 v[218:219], v27 offset:5120
    v_mfma_f32_32x32x16_bf16 v[96:111], v[224:227], v[200:203], v[96:111]
    ds_read_b64_tr_b16 v[220:221], v28 offset:4096
    ds_read_b64_tr_b16 v[222:223], v28 offset:5120
    v_mfma_f32_32x32x16_bf16 v[160:175], v[228:231], v[200:203], v[160:175]
    v_mfma_f32_32x32x16_bf16 v[112:127], v[224:227], v[204:207], v[112:127]
    v_mfma_f32_32x32x16_bf16 v[176:191], v[228:231], v[204:207], v[176:191]
    s_waitcnt lgkmcnt(0)
    v_mfma_f32_32x32x16_bf16 v[64:79], v[232:235], v[208:211], v[64:79]
    ds_read_b128 v[224:227], v32
    ds_read_b128 v[228:231], v32 offset:16384
    s_add_u32 s38, s52, 7168
    buffer_store_dwordx4 v[48:51], v1, s[12:15], s38 offen sc0 sc1
    v_mfma_f32_32x32x16_bf16 v[128:143], v[236:239], v[208:211], v[128:143]
    ds_read_b64_tr_b16 v[192:193], v25 offset:8192
    ds_read_b64_tr_b16 v[194:195], v25 offset:9216
    v_mfma_f32_32x32x16_bf16 v[80:95], v[232:235], v[212:215], v[80:95]
    ds_read_b64_tr_b16 v[196:197], v26 offset:8192
    ds_read_b64_tr_b16 v[198:199], v26 offset:9216
    v_mfma_f32_32x32x16_bf16 v[144:159], v[236:239], v[212:215], v[144:159]
    ds_read_b64_tr_b16 v[200:201], v27 offset:8192
    ds_read_b64_tr_b16 v[202:203], v27 offset:9216
    v_mfma_f32_32x32x16_bf16 v[96:111], v[232:235], v[216:219], v[96:111]
    ds_read_b64_tr_b16 v[204:205], v28 offset:8192
    ds_read_b64_tr_b16 v[206:207], v28 offset:9216
    v_mfma_f32_32x32x16_bf16 v[160:175], v[236:239], v[216:219], v[160:175]
    v_mfma_f32_32x32x16_bf16 v[112:127], v[232:235], v[220:223], v[112:127]
    v_mfma_f32_32x32x16_bf16 v[176:191], v[236:239], v[220:223], v[176:191]
    s_waitcnt lgkmcnt(0)
    v_mfma_f32_32x32x16_bf16 v[64:79], v[224:227], v[192:195], v[64:79]
    ds_read_b128 v[232:235], v33
    ds_read_b128 v[236:239], v33 offset:16384
    v_mfma_f32_32x32x16_bf16 v[128:143], v[228:231], v[192:195], v[128:143]
    ds_read_b64_tr_b16 v[208:209], v25 offset:12288
    ds_read_b64_tr_b16 v[210:211], v25 offset:13312
    v_mfma_f32_32x32x16_bf16 v[80:95], v[224:227], v[196:199], v[80:95]
    ds_read_b64_tr_b16 v[212:213], v26 offset:12288
    ds_read_b64_tr_b16 v[214:215], v26 offset:13312
    v_mfma_f32_32x32x16_bf16 v[144:159], v[228:231], v[196:199], v[144:159]
    ds_read_b64_tr_b16 v[216:217], v27 offset:12288
    ds_read_b64_tr_b16 v[218:219], v27 offset:13312
    v_mfma_f32_32x32x16_bf16 v[96:111], v[224:227], v[200:203], v[96:111]
    ds_read_b64_tr_b16 v[220:221], v28 offset:12288
    ds_read_b64_tr_b16 v[222:223], v28 offset:13312
    v_mfma_f32_32x32x16_bf16 v[160:175], v[228:231], v[200:203], v[160:175]
    v_mfma_f32_32x32x16_bf16 v[112:127], v[224:227], v[204:207], v[112:127]
    v_mfma_f32_32x32x16_bf16 v[176:191], v[228:231], v[204:207], v[176:191]
    s_waitcnt lgkmcnt(0)
    s_barrier
    v_mfma_f32_32x32x16_bf16 v[64:79], v[232:235], v[208:211], v[64:79]
    v_add_u32 v25, 0, v20
    v_add_u32 v26, 0, v21
    v_add_u32 v27, 0, v22
    v_mfma_f32_32x32x16_bf16 v[128:143], v[236:239], v[208:211], v[128:143]
    v_add_u32 v28, 0, v23
    v_add_u32 v30, 0, v34
    v_add_u32 v31, 0, v35
    v_mfma_f32_32x32x16_bf16 v[80:95], v[232:235], v[212:215], v[80:95]
    v_add_u32 v32, 0, v36
    v_add_u32 v33, 0, v37
    ds_read_b128 v[224:227], v30
    v_mfma_f32_32x32x16_bf16 v[144:159], v[236:239], v[212:215], v[144:159]
    ds_read_b128 v[228:231], v30 offset:16384
    ds_read_b64_tr_b16 v[192:193], v25 offset:0
    ds_read_b64_tr_b16 v[194:195], v25 offset:1024
    v_mfma_f32_32x32x16_bf16 v[96:111], v[232:235], v[216:219], v[96:111]
    ds_read_b64_tr_b16 v[196:197], v26 offset:0
    ds_read_b64_tr_b16 v[198:199], v26 offset:1024
    ds_read_b64_tr_b16 v[200:201], v27 offset:0
    v_mfma_f32_32x32x16_bf16 v[160:175], v[236:239], v[216:219], v[160:175]
    ds_read_b64_tr_b16 v[202:203], v27 offset:1024
    ds_read_b64_tr_b16 v[204:205], v28 offset:0
    ds_read_b64_tr_b16 v[206:207], v28 offset:1024
    v_mfma_f32_32x32x16_bf16 v[112:127], v[232:235], v[220:223], v[112:127]
    v_mfma_f32_32x32x16_bf16 v[176:191], v[236:239], v[220:223], v[176:191]
    s_waitcnt lgkmcnt(0)
    v_mfma_f32_32x32x16_bf16 v[64:79], v[224:227], v[192:195], v[64:79]
    ds_read_b128 v[232:235], v31
    ds_read_b128 v[236:239], v31 offset:16384
    s_add_u32 s38, s52, 65536
    buffer_store_dwordx4 v[52:55], v1, s[12:15], s38 offen sc0 sc1
    v_mfma_f32_32x32x16_bf16 v[128:143], v[228:231], v[192:195], v[128:143]
    ds_read_b64_tr_b16 v[208:209], v25 offset:4096
    ds_read_b64_tr_b16 v[210:211], v25 offset:5120
    v_mfma_f32_32x32x16_bf16 v[80:95], v[224:227], v[196:199], v[80:95]
    ds_read_b64_tr_b16 v[212:213], v26 offset:4096
    ds_read_b64_tr_b16 v[214:215], v26 offset:5120
    v_mfma_f32_32x32x16_bf16 v[144:159], v[228:231], v[196:199], v[144:159]
    ds_read_b64_tr_b16 v[216:217], v27 offset:4096
    ds_read_b64_tr_b16 v[218:219], v27 offset:5120
    v_mfma_f32_32x32x16_bf16 v[96:111], v[224:227], v[200:203], v[96:111]
    ds_read_b64_tr_b16 v[220:221], v28 offset:4096
    ds_read_b64_tr_b16 v[222:223], v28 offset:5120
    v_mfma_f32_32x32x16_bf16 v[160:175], v[228:231], v[200:203], v[160:175]
    v_mfma_f32_32x32x16_bf16 v[112:127], v[224:227], v[204:207], v[112:127]
    v_mfma_f32_32x32x16_bf16 v[176:191], v[228:231], v[204:207], v[176:191]
    s_waitcnt lgkmcnt(0)
    v_mfma_f32_32x32x16_bf16 v[64:79], v[232:235], v[208:211], v[64:79]
    ds_read_b128 v[224:227], v32
    ds_read_b128 v[228:231], v32 offset:16384
    v_mfma_f32_32x32x16_bf16 v[128:143], v[236:239], v[208:211], v[128:143]
    ds_read_b64_tr_b16 v[192:193], v25 offset:8192
    ds_read_b64_tr_b16 v[194:195], v25 offset:9216
    v_mfma_f32_32x32x16_bf16 v[80:95], v[232:235], v[212:215], v[80:95]
    ds_read_b64_tr_b16 v[196:197], v26 offset:8192
    ds_read_b64_tr_b16 v[198:199], v26 offset:9216
    v_mfma_f32_32x32x16_bf16 v[144:159], v[236:239], v[212:215], v[144:159]
    ds_read_b64_tr_b16 v[200:201], v27 offset:8192
    ds_read_b64_tr_b16 v[202:203], v27 offset:9216
    v_mfma_f32_32x32x16_bf16 v[96:111], v[232:235], v[216:219], v[96:111]
    ds_read_b64_tr_b16 v[204:205], v28 offset:8192
    ds_read_b64_tr_b16 v[206:207], v28 offset:9216
    v_mfma_f32_32x32x16_bf16 v[160:175], v[236:239], v[216:219], v[160:175]
    v_mfma_f32_32x32x16_bf16 v[112:127], v[232:235], v[220:223], v[112:127]
    v_mfma_f32_32x32x16_bf16 v[176:191], v[236:239], v[220:223], v[176:191]
    s_waitcnt lgkmcnt(0)
    v_mfma_f32_32x32x16_bf16 v[64:79], v[224:227], v[192:195], v[64:79]
    ds_read_b128 v[232:235], v33
    ds_read_b128 v[236:239], v33 offset:16384
    v_mfma_f32_32x32x16_bf16 v[128:143], v[228:231], v[192:195], v[128:143]
    ds_read_b64_tr_b16 v[208:209], v25 offset:12288
    ds_read_b64_tr_b16 v[210:211], v25 offset:13312
    v_mfma_f32_32x32x16_bf16 v[80:95], v[224:227], v[196:199], v[80:95]
    ds_read_b64_tr_b16 v[212:213], v26 offset:12288
    ds_read_b64_tr_b16 v[214:215], v26 offset:13312
    v_mfma_f32_32x32x16_bf16 v[144:159], v[228:231], v[196:199], v[144:159]
    ds_read_b64_tr_b16 v[216:217], v27 offset:12288
    ds_read_b64_tr_b16 v[218:219], v27 offset:13312
    v_mfma_f32_32x32x16_bf16 v[96:111], v[224:227], v[200:203], v[96:111]
    ds_read_b64_tr_b16 v[220:221], v28 offset:12288
    ds_read_b64_tr_b16 v[222:223], v28 offset:13312
    v_mfma_f32_32x32x16_bf16 v[160:175], v[228:231], v[200:203], v[160:175]
    v_mfma_f32_32x32x16_bf16 v[112:127], v[224:227], v[204:207], v[112:127]
    v_mfma_f32_32x32x16_bf16 v[176:191], v[228:231], v[204:207], v[176:191]
    s_waitcnt lgkmcnt(0)
    s_barrier
    v_mfma_f32_32x32x16_bf16 v[64:79], v[232:235], v[208:211], v[64:79]
    v_add_u32 v25, 49152, v20
    v_add_u32 v26, 49152, v21
    v_add_u32 v27, 49152, v22
    s_add_u32 s38, s52, 66560
    buffer_store_dwordx4 v[56:59], v1, s[12:15], s38 offen sc0 sc1
    v_mfma_f32_32x32x16_bf16 v[128:143], v[236:239], v[208:211], v[128:143]
    v_add_u32 v28, 49152, v23
    v_add_u32 v30, 49152, v34
    v_add_u32 v31, 49152, v35
    v_mfma_f32_32x32x16_bf16 v[80:95], v[232:235], v[212:215], v[80:95]
    v_add_u32 v32, 49152, v36
    v_add_u32 v33, 49152, v37
    ds_read_b128 v[224:227], v30
    v_mfma_f32_32x32x16_bf16 v[144:159], v[236:239], v[212:215], v[144:159]
    ds_read_b128 v[228:231], v30 offset:16384
    ds_read_b64_tr_b16 v[192:193], v25 offset:0
    ds_read_b64_tr_b16 v[194:195], v25 offset:1024
    v_mfma_f32_32x32x16_bf16 v[96:111], v[232:235], v[216:219], v[96:111]
    ds_read_b64_tr_b16 v[196:197], v26 offset:0
    ds_read_b64_tr_b16 v[198:199], v26 offset:1024
    ds_read_b64_tr_b16 v[200:201], v27 offset:0
    v_mfma_f32_32x32x16_bf16 v[160:175], v[236:239], v[216:219], v[160:175]
    ds_read_b64_tr_b16 v[202:203], v27 offset:1024
    ds_read_b64_tr_b16 v[204:205], v28 offset:0
    ds_read_b64_tr_b16 v[206:207], v28 offset:1024
    v_mfma_f32_32x32x16_bf16 v[112:127], v[232:235], v[220:223], v[112:127]
    v_mfma_f32_32x32x16_bf16 v[176:191], v[236:239], v[220:223], v[176:191]
    s_waitcnt lgkmcnt(0)
    v_mfma_f32_32x32x16_bf16 v[64:79], v[224:227], v[192:195], v[64:79]
    ds_read_b128 v[232:235], v31
    ds_read_b128 v[236:239], v31 offset:16384
    v_mfma_f32_32x32x16_bf16 v[128:143], v[228:231], v[192:195], v[128:143]
    ds_read_b64_tr_b16 v[208:209], v25 offset:4096
    ds_read_b64_tr_b16 v[210:211], v25 offset:5120
    v_mfma_f32_32x32x16_bf16 v[80:95], v[224:227], v[196:199], v[80:95]
    ds_read_b64_tr_b16 v[212:213], v26 offset:4096
    ds_read_b64_tr_b16 v[214:215], v26 offset:5120
    v_mfma_f32_32x32x16_bf16 v[144:159], v[228:231], v[196:199], v[144:159]
    ds_read_b64_tr_b16 v[216:217], v27 offset:4096
    ds_read_b64_tr_b16 v[218:219], v27 offset:5120
    v_mfma_f32_32x32x16_bf16 v[96:111], v[224:227], v[200:203], v[96:111]
    ds_read_b64_tr_b16 v[220:221], v28 offset:4096
    ds_read_b64_tr_b16 v[222:223], v28 offset:5120
    v_mfma_f32_32x32x16_bf16 v[160:175], v[228:231], v[200:203], v[160:175]
    v_mfma_f32_32x32x16_bf16 v[112:127], v[224:227], v[204:207], v[112:127]
    v_mfma_f32_32x32x16_bf16 v[176:191], v[228:231], v[204:207], v[176:191]
    s_waitcnt lgkmcnt(0)
    v_mfma_f32_32x32x16_bf16 v[64:79], v[232:235], v[208:211], v[64:79]
    ds_read_b128 v[224:227], v32
    ds_read_b128 v[228:231], v32 offset:16384
    v_mfma_f32_32x32x16_bf16 v[128:143], v[236:239], v[208:211], v[128:143]
    ds_read_b64_tr_b16 v[192:193], v25 offset:8192
    ds_read_b64_tr_b16 v[194:195], v25 offset:9216
    v_mfma_f32_32x32x16_bf16 v[80:95], v[232:235], v[212:215], v[80:95]
    ds_read_b64_tr_b16 v[196:197], v26 offset:8192
    ds_read_b64_tr_b16 v[198:199], v26 offset:9216
    v_mfma_f32_32x32x16_bf16 v[144:159], v[236:239], v[212:215], v[144:159]
    ds_read_b64_tr_b16 v[200:201], v27 offset:8192
    ds_read_b64_tr_b16 v[202:203], v27 offset:9216
    v_mfma_f32_32x32x16_bf16 v[96:111], v[232:235], v[216:219], v[96:111]
    ds_read_b64_tr_b16 v[204:205], v28 offset:8192
    ds_read_b64_tr_b16 v[206:207], v28 offset:9216
    v_mfma_f32_32x32x16_bf16 v[160:175], v[236:239], v[216:219], v[160:175]
    v_mfma_f32_32x32x16_bf16 v[112:127], v[232:235], v[220:223], v[112:127]
    v_mfma_f32_32x32x16_bf16 v[176:191], v[236:239], v[220:223], v[176:191]
    s_waitcnt lgkmcnt(0)
    v_mfma_f32_32x32x16_bf16 v[64:79], v[224:227], v[192:195], v[64:79]
    ds_read_b128 v[232:235], v33
    ds_read_b128 v[236:239], v33 offset:16384
    s_add_u32 s38, s52, 67584
    buffer_store_dwordx4 v[60:63], v1, s[12:15], s38 offen sc0 sc1
    v_mfma_f32_32x32x16_bf16 v[128:143], v[228:231], v[192:195], v[128:143]
    ds_read_b64_tr_b16 v[208:209], v25 offset:12288
    ds_read_b64_tr_b16 v[210:211], v25 offset:13312
    v_mfma_f32_32x32x16_bf16 v[80:95], v[224:227], v[196:199], v[80:95]
    ds_read_b64_tr_b16 v[212:213], v26 offset:12288
    ds_read_b64_tr_b16 v[214:215], v26 offset:13312
    v_mfma_f32_32x32x16_bf16 v[144:159], v[228:231], v[196:199], v[144:159]
    ds_read_b64_tr_b16 v[216:217], v27 offset:12288
    ds_read_b64_tr_b16 v[218:219], v27 offset:13312
    v_mfma_f32_32x32x16_bf16 v[96:111], v[224:227], v[200:203], v[96:111]
    ds_read_b64_tr_b16 v[220:221], v28 offset:12288
    ds_read_b64_tr_b16 v[222:223], v28 offset:13312
    v_mfma_f32_32x32x16_bf16 v[160:175], v[228:231], v[200:203], v[160:175]
    v_mfma_f32_32x32x16_bf16 v[112:127], v[224:227], v[204:207], v[112:127]
    v_mfma_f32_32x32x16_bf16 v[176:191], v[228:231], v[204:207], v[176:191]
    s_waitcnt lgkmcnt(0)
    s_barrier
    v_mfma_f32_32x32x16_bf16 v[64:79], v[232:235], v[208:211], v[64:79]
    v_add_u32 v25, 98304, v20
    v_add_u32 v26, 98304, v21
    v_add_u32 v27, 98304, v22
    v_mfma_f32_32x32x16_bf16 v[128:143], v[236:239], v[208:211], v[128:143]
    v_add_u32 v28, 98304, v23
    v_add_u32 v30, 98304, v34
    v_add_u32 v31, 98304, v35
    v_mfma_f32_32x32x16_bf16 v[80:95], v[232:235], v[212:215], v[80:95]
    v_add_u32 v32, 98304, v36
    v_add_u32 v33, 98304, v37
    ds_read_b128 v[224:227], v30
    v_mfma_f32_32x32x16_bf16 v[144:159], v[236:239], v[212:215], v[144:159]
    ds_read_b128 v[228:231], v30 offset:16384
    ds_read_b64_tr_b16 v[192:193], v25 offset:0
    ds_read_b64_tr_b16 v[194:195], v25 offset:1024
    v_mfma_f32_32x32x16_bf16 v[96:111], v[232:235], v[216:219], v[96:111]
    ds_read_b64_tr_b16 v[196:197], v26 offset:0
    ds_read_b64_tr_b16 v[198:199], v26 offset:1024
    ds_read_b64_tr_b16 v[200:201], v27 offset:0
    v_mfma_f32_32x32x16_bf16 v[160:175], v[236:239], v[216:219], v[160:175]
    ds_read_b64_tr_b16 v[202:203], v27 offset:1024
    ds_read_b64_tr_b16 v[204:205], v28 offset:0
    ds_read_b64_tr_b16 v[206:207], v28 offset:1024
    v_mfma_f32_32x32x16_bf16 v[112:127], v[232:235], v[220:223], v[112:127]
    v_mfma_f32_32x32x16_bf16 v[176:191], v[236:239], v[220:223], v[176:191]
    s_waitcnt lgkmcnt(0)
    v_mfma_f32_32x32x16_bf16 v[64:79], v[224:227], v[192:195], v[64:79]
    ds_read_b128 v[232:235], v31
    ds_read_b128 v[236:239], v31 offset:16384
    s_add_u32 s38, s52, 68608
    buffer_store_dwordx4 v[240:243], v1, s[12:15], s38 offen sc0 sc1
    v_mfma_f32_32x32x16_bf16 v[128:143], v[228:231], v[192:195], v[128:143]
    ds_read_b64_tr_b16 v[208:209], v25 offset:4096
    ds_read_b64_tr_b16 v[210:211], v25 offset:5120
    v_mfma_f32_32x32x16_bf16 v[80:95], v[224:227], v[196:199], v[80:95]
    ds_read_b64_tr_b16 v[212:213], v26 offset:4096
    ds_read_b64_tr_b16 v[214:215], v26 offset:5120
    v_mfma_f32_32x32x16_bf16 v[144:159], v[228:231], v[196:199], v[144:159]
    ds_read_b64_tr_b16 v[216:217], v27 offset:4096
    ds_read_b64_tr_b16 v[218:219], v27 offset:5120
    v_mfma_f32_32x32x16_bf16 v[96:111], v[224:227], v[200:203], v[96:111]
    ds_read_b64_tr_b16 v[220:221], v28 offset:4096
    ds_read_b64_tr_b16 v[222:223], v28 offset:5120
    v_mfma_f32_32x32x16_bf16 v[160:175], v[228:231], v[200:203], v[160:175]
    v_mfma_f32_32x32x16_bf16 v[112:127], v[224:227], v[204:207], v[112:127]
    v_mfma_f32_32x32x16_bf16 v[176:191], v[228:231], v[204:207], v[176:191]
    s_waitcnt lgkmcnt(0)
    v_mfma_f32_32x32x16_bf16 v[64:79], v[232:235], v[208:211], v[64:79]
    ds_read_b128 v[224:227], v32
    ds_read_b128 v[228:231], v32 offset:16384
    v_mfma_f32_32x32x16_bf16 v[128:143], v[236:239], v[208:211], v[128:143]
    ds_read_b64_tr_b16 v[192:193], v25 offset:8192
    ds_read_b64_tr_b16 v[194:195], v25 offset:9216
    v_mfma_f32_32x32x16_bf16 v[80:95], v[232:235], v[212:215], v[80:95]
    ds_read_b64_tr_b16 v[196:197], v26 offset:8192
    ds_read_b64_tr_b16 v[198:199], v26 offset:9216
    v_mfma_f32_32x32x16_bf16 v[144:159], v[236:239], v[212:215], v[144:159]
    ds_read_b64_tr_b16 v[200:201], v27 offset:8192
    ds_read_b64_tr_b16 v[202:203], v27 offset:9216
    v_mfma_f32_32x32x16_bf16 v[96:111], v[232:235], v[216:219], v[96:111]
    ds_read_b64_tr_b16 v[204:205], v28 offset:8192
    ds_read_b64_tr_b16 v[206:207], v28 offset:9216
    v_mfma_f32_32x32x16_bf16 v[160:175], v[236:239], v[216:219], v[160:175]
    v_mfma_f32_32x32x16_bf16 v[112:127], v[232:235], v[220:223], v[112:127]
    v_mfma_f32_32x32x16_bf16 v[176:191], v[236:239], v[220:223], v[176:191]
    s_waitcnt lgkmcnt(0)
    v_mfma_f32_32x32x16_bf16 v[64:79], v[224:227], v[192:195], v[64:79]
    ds_read_b128 v[232:235], v33
    ds_read_b128 v[236:239], v33 offset:16384
    v_mfma_f32_32x32x16_bf16 v[128:143], v[228:231], v[192:195], v[128:143]
    ds_read_b64_tr_b16 v[208:209], v25 offset:12288
    ds_read_b64_tr_b16 v[210:211], v25 offset:13312
    v_mfma_f32_32x32x16_bf16 v[80:95], v[224:227], v[196:199], v[80:95]
    ds_read_b64_tr_b16 v[212:213], v26 offset:12288
    ds_read_b64_tr_b16 v[214:215], v26 offset:13312
    v_mfma_f32_32x32x16_bf16 v[144:159], v[228:231], v[196:199], v[144:159]
    ds_read_b64_tr_b16 v[216:217], v27 offset:12288
    ds_read_b64_tr_b16 v[218:219], v27 offset:13312
    v_mfma_f32_32x32x16_bf16 v[96:111], v[224:227], v[200:203], v[96:111]
    ds_read_b64_tr_b16 v[220:221], v28 offset:12288
    ds_read_b64_tr_b16 v[222:223], v28 offset:13312
    v_mfma_f32_32x32x16_bf16 v[160:175], v[228:231], v[200:203], v[160:175]
    v_mfma_f32_32x32x16_bf16 v[112:127], v[224:227], v[204:207], v[112:127]
    v_mfma_f32_32x32x16_bf16 v[176:191], v[228:231], v[204:207], v[176:191]
    s_waitcnt lgkmcnt(0)
    s_barrier
    v_mfma_f32_32x32x16_bf16 v[64:79], v[232:235], v[208:211], v[64:79]
    v_add_u32 v25, 0, v20
    v_add_u32 v26, 0, v21
    v_add_u32 v27, 0, v22
    s_add_u32 s38, s52, 69632
    buffer_store_dwordx4 v[244:247], v1, s[12:15], s38 offen sc0 sc1
    v_mfma_f32_32x32x16_bf16 v[128:143], v[236:239], v[208:211], v[128:143]
    v_add_u32 v28, 0, v23
    v_add_u32 v30, 0, v34
    v_add_u32 v31, 0, v35
    v_mfma_f32_32x32x16_bf16 v[80:95], v[232:235], v[212:215], v[80:95]
    v_add_u32 v32, 0, v36
    v_add_u32 v33, 0, v37
    ds_read_b128 v[224:227], v30
    v_mfma_f32_32x32x16_bf16 v[144:159], v[236:239], v[212:215], v[144:159]
    ds_read_b128 v[228:231], v30 offset:16384
    ds_read_b64_tr_b16 v[192:193], v25 offset:0
    ds_read_b64_tr_b16 v[194:195], v25 offset:1024
    v_mfma_f32_32x32x16_bf16 v[96:111], v[232:235], v[216:219], v[96:111]
    ds_read_b64_tr_b16 v[196:197], v26 offset:0
    ds_read_b64_tr_b16 v[198:199], v26 offset:1024
    ds_read_b64_tr_b16 v[200:201], v27 offset:0
    v_mfma_f32_32x32x16_bf16 v[160:175], v[236:239], v[216:219], v[160:175]
    ds_read_b64_tr_b16 v[202:203], v27 offset:1024
    ds_read_b64_tr_b16 v[204:205], v28 offset:0
    ds_read_b64_tr_b16 v[206:207], v28 offset:1024
    v_mfma_f32_32x32x16_bf16 v[112:127], v[232:235], v[220:223], v[112:127]
    v_mfma_f32_32x32x16_bf16 v[176:191], v[236:239], v[220:223], v[176:191]
    s_waitcnt lgkmcnt(0)
    v_mfma_f32_32x32x16_bf16 v[64:79], v[224:227], v[192:195], v[64:79]
    ds_read_b128 v[232:235], v31
    ds_read_b128 v[236:239], v31 offset:16384
    v_mfma_f32_32x32x16_bf16 v[128:143], v[228:231], v[192:195], v[128:143]
    ds_read_b64_tr_b16 v[208:209], v25 offset:4096
    ds_read_b64_tr_b16 v[210:211], v25 offset:5120
    v_mfma_f32_32x32x16_bf16 v[80:95], v[224:227], v[196:199], v[80:95]
    ds_read_b64_tr_b16 v[212:213], v26 offset:4096
    ds_read_b64_tr_b16 v[214:215], v26 offset:5120
    v_mfma_f32_32x32x16_bf16 v[144:159], v[228:231], v[196:199], v[144:159]
    ds_read_b64_tr_b16 v[216:217], v27 offset:4096
    ds_read_b64_tr_b16 v[218:219], v27 offset:5120
    v_mfma_f32_32x32x16_bf16 v[96:111], v[224:227], v[200:203], v[96:111]
    ds_read_b64_tr_b16 v[220:221], v28 offset:4096
    ds_read_b64_tr_b16 v[222:223], v28 offset:5120
    v_mfma_f32_32x32x16_bf16 v[160:175], v[228:231], v[200:203], v[160:175]
    v_mfma_f32_32x32x16_bf16 v[112:127], v[224:227], v[204:207], v[112:127]
    v_mfma_f32_32x32x16_bf16 v[176:191], v[228:231], v[204:207], v[176:191]
    s_waitcnt lgkmcnt(0)
    v_mfma_f32_32x32x16_bf16 v[64:79], v[232:235], v[208:211], v[64:79]
    ds_read_b128 v[224:227], v32
    ds_read_b128 v[228:231], v32 offset:16384
    v_mfma_f32_32x32x16_bf16 v[128:143], v[236:239], v[208:211], v[128:143]
    ds_read_b64_tr_b16 v[192:193], v25 offset:8192
    ds_read_b64_tr_b16 v[194:195], v25 offset:9216
    v_mfma_f32_32x32x16_bf16 v[80:95], v[232:235], v[212:215], v[80:95]
    ds_read_b64_tr_b16 v[196:197], v26 offset:8192
    ds_read_b64_tr_b16 v[198:199], v26 offset:9216
    v_mfma_f32_32x32x16_bf16 v[144:159], v[236:239], v[212:215], v[144:159]
    ds_read_b64_tr_b16 v[200:201], v27 offset:8192
    ds_read_b64_tr_b16 v[202:203], v27 offset:9216
    v_mfma_f32_32x32x16_bf16 v[96:111], v[232:235], v[216:219], v[96:111]
    ds_read_b64_tr_b16 v[204:205], v28 offset:8192
    ds_read_b64_tr_b16 v[206:207], v28 offset:9216
    v_mfma_f32_32x32x16_bf16 v[160:175], v[236:239], v[216:219], v[160:175]
    v_mfma_f32_32x32x16_bf16 v[112:127], v[232:235], v[220:223], v[112:127]
    v_mfma_f32_32x32x16_bf16 v[176:191], v[236:239], v[220:223], v[176:191]
    s_waitcnt lgkmcnt(0)
    v_mfma_f32_32x32x16_bf16 v[64:79], v[224:227], v[192:195], v[64:79]
    ds_read_b128 v[232:235], v33
    ds_read_b128 v[236:239], v33 offset:16384
    s_add_u32 s38, s52, 70656
    buffer_store_dwordx4 v[248:251], v1, s[12:15], s38 offen sc0 sc1
    v_mfma_f32_32x32x16_bf16 v[128:143], v[228:231], v[192:195], v[128:143]
    ds_read_b64_tr_b16 v[208:209], v25 offset:12288
    ds_read_b64_tr_b16 v[210:211], v25 offset:13312
    v_mfma_f32_32x32x16_bf16 v[80:95], v[224:227], v[196:199], v[80:95]
    ds_read_b64_tr_b16 v[212:213], v26 offset:12288
    ds_read_b64_tr_b16 v[214:215], v26 offset:13312
    v_mfma_f32_32x32x16_bf16 v[144:159], v[228:231], v[196:199], v[144:159]
    ds_read_b64_tr_b16 v[216:217], v27 offset:12288
    ds_read_b64_tr_b16 v[218:219], v27 offset:13312
    v_mfma_f32_32x32x16_bf16 v[96:111], v[224:227], v[200:203], v[96:111]
    ds_read_b64_tr_b16 v[220:221], v28 offset:12288
    ds_read_b64_tr_b16 v[222:223], v28 offset:13312
    v_mfma_f32_32x32x16_bf16 v[160:175], v[228:231], v[200:203], v[160:175]
    v_mfma_f32_32x32x16_bf16 v[112:127], v[224:227], v[204:207], v[112:127]
    v_mfma_f32_32x32x16_bf16 v[176:191], v[228:231], v[204:207], v[176:191]
    s_waitcnt lgkmcnt(0)
    s_barrier
    v_mfma_f32_32x32x16_bf16 v[64:79], v[232:235], v[208:211], v[64:79]
    v_add_u32 v25, 49152, v20
    v_add_u32 v26, 49152, v21
    v_add_u32 v27, 49152, v22
    v_mfma_f32_32x32x16_bf16 v[128:143], v[236:239], v[208:211], v[128:143]
    v_add_u32 v28, 49152, v23
    v_add_u32 v30, 49152, v34
    v_add_u32 v31, 49152, v35
    v_mfma_f32_32x32x16_bf16 v[80:95], v[232:235], v[212:215], v[80:95]
    v_add_u32 v32, 49152, v36
    v_add_u32 v33, 49152, v37
    ds_read_b128 v[224:227], v30
    v_mfma_f32_32x32x16_bf16 v[144:159], v[236:239], v[212:215], v[144:159]
    ds_read_b128 v[228:231], v30 offset:16384
    ds_read_b64_tr_b16 v[192:193], v25 offset:0
    ds_read_b64_tr_b16 v[194:195], v25 offset:1024
    v_mfma_f32_32x32x16_bf16 v[96:111], v[232:235], v[216:219], v[96:111]
    ds_read_b64_tr_b16 v[196:197], v26 offset:0
    ds_read_b64_tr_b16 v[198:199], v26 offset:1024
    ds_read_b64_tr_b16 v[200:201], v27 offset:0
    v_mfma_f32_32x32x16_bf16 v[160:175], v[236:239], v[216:219], v[160:175]
    ds_read_b64_tr_b16 v[202:203], v27 offset:1024
    ds_read_b64_tr_b16 v[204:205], v28 offset:0
    ds_read_b64_tr_b16 v[206:207], v28 offset:1024
    v_mfma_f32_32x32x16_bf16 v[112:127], v[232:235], v[220:223], v[112:127]
    v_mfma_f32_32x32x16_bf16 v[176:191], v[236:239], v[220:223], v[176:191]
    s_waitcnt lgkmcnt(0)
    v_mfma_f32_32x32x16_bf16 v[64:79], v[224:227], v[192:195], v[64:79]
    ds_read_b128 v[232:235], v31
    ds_read_b128 v[236:239], v31 offset:16384
    v_mfma_f32_32x32x16_bf16 v[128:143], v[228:231], v[192:195], v[128:143]
    ds_read_b64_tr_b16 v[208:209], v25 offset:4096
    ds_read_b64_tr_b16 v[210:211], v25 offset:5120
    v_mfma_f32_32x32x16_bf16 v[80:95], v[224:227], v[196:199], v[80:95]
    ds_read_b64_tr_b16 v[212:213], v26 offset:4096
    ds_read_b64_tr_b16 v[214:215], v26 offset:5120
    v_mfma_f32_32x32x16_bf16 v[144:159], v[228:231], v[196:199], v[144:159]
    ds_read_b64_tr_b16 v[216:217], v27 offset:4096
    ds_read_b64_tr_b16 v[218:219], v27 offset:5120
    v_mfma_f32_32x32x16_bf16 v[96:111], v[224:227], v[200:203], v[96:111]
    ds_read_b64_tr_b16 v[220:221], v28 offset:4096
    ds_read_b64_tr_b16 v[222:223], v28 offset:5120
    v_mfma_f32_32x32x16_bf16 v[160:175], v[228:231], v[200:203], v[160:175]
    v_mfma_f32_32x32x16_bf16 v[112:127], v[224:227], v[204:207], v[112:127]
    v_mfma_f32_32x32x16_bf16 v[176:191], v[228:231], v[204:207], v[176:191]
    s_waitcnt lgkmcnt(0)
    v_mfma_f32_32x32x16_bf16 v[64:79], v[232:235], v[208:211], v[64:79]
    ds_read_b128 v[224:227], v32
    ds_read_b128 v[228:231], v32 offset:16384
    s_add_u32 s38, s52, 71680
    buffer_store_dwordx4 v[252:255], v1, s[12:15], s38 offen sc0 sc1
    v_mfma_f32_32x32x16_bf16 v[128:143], v[236:239], v[208:211], v[128:143]
    ds_read_b64_tr_b16 v[192:193], v25 offset:8192
    ds_read_b64_tr_b16 v[194:195], v25 offset:9216
    v_mfma_f32_32x32x16_bf16 v[80:95], v[232:235], v[212:215], v[80:95]
    ds_read_b64_tr_b16 v[196:197], v26 offset:8192
    ds_read_b64_tr_b16 v[198:199], v26 offset:9216
    v_mfma_f32_32x32x16_bf16 v[144:159], v[236:239], v[212:215], v[144:159]
    ds_read_b64_tr_b16 v[200:201], v27 offset:8192
    ds_read_b64_tr_b16 v[202:203], v27 offset:9216
    v_mfma_f32_32x32x16_bf16 v[96:111], v[232:235], v[216:219], v[96:111]
    ds_read_b64_tr_b16 v[204:205], v28 offset:8192
    ds_read_b64_tr_b16 v[206:207], v28 offset:9216
    v_mfma_f32_32x32x16_bf16 v[160:175], v[236:239], v[216:219], v[160:175]
    v_mfma_f32_32x32x16_bf16 v[112:127], v[232:235], v[220:223], v[112:127]
    v_mfma_f32_32x32x16_bf16 v[176:191], v[236:239], v[220:223], v[176:191]
    s_waitcnt lgkmcnt(0)
    v_mfma_f32_32x32x16_bf16 v[64:79], v[224:227], v[192:195], v[64:79]
    ds_read_b128 v[232:235], v33
    ds_read_b128 v[236:239], v33 offset:16384
    v_mfma_f32_32x32x16_bf16 v[128:143], v[228:231], v[192:195], v[128:143]
    ds_read_b64_tr_b16 v[208:209], v25 offset:12288
    ds_read_b64_tr_b16 v[210:211], v25 offset:13312
    v_mfma_f32_32x32x16_bf16 v[80:95], v[224:227], v[196:199], v[80:95]
    ds_read_b64_tr_b16 v[212:213], v26 offset:12288
    ds_read_b64_tr_b16 v[214:215], v26 offset:13312
    v_mfma_f32_32x32x16_bf16 v[144:159], v[228:231], v[196:199], v[144:159]
    ds_read_b64_tr_b16 v[216:217], v27 offset:12288
    ds_read_b64_tr_b16 v[218:219], v27 offset:13312
    v_mfma_f32_32x32x16_bf16 v[96:111], v[224:227], v[200:203], v[96:111]
    ds_read_b64_tr_b16 v[220:221], v28 offset:12288
    ds_read_b64_tr_b16 v[222:223], v28 offset:13312
    v_mfma_f32_32x32x16_bf16 v[160:175], v[228:231], v[200:203], v[160:175]
    v_mfma_f32_32x32x16_bf16 v[112:127], v[224:227], v[204:207], v[112:127]
    v_mfma_f32_32x32x16_bf16 v[176:191], v[228:231], v[204:207], v[176:191]
    s_waitcnt lgkmcnt(0)
    s_barrier
    v_mfma_f32_32x32x16_bf16 v[64:79], v[232:235], v[208:211], v[64:79]
    v_add_u32 v25, 98304, v20
    v_add_u32 v26, 98304, v21
    v_add_u32 v27, 98304, v22
    v_mfma_f32_32x32x16_bf16 v[128:143], v[236:239], v[208:211], v[128:143]
    v_add_u32 v28, 98304, v23
    v_add_u32 v30, 98304, v34
    v_add_u32 v31, 98304, v35
    v_mfma_f32_32x32x16_bf16 v[80:95], v[232:235], v[212:215], v[80:95]
    v_add_u32 v32, 98304, v36
    v_add_u32 v33, 98304, v37
    ds_read_b128 v[224:227], v30
    v_mfma_f32_32x32x16_bf16 v[144:159], v[236:239], v[212:215], v[144:159]
    ds_read_b128 v[228:231], v30 offset:16384
    ds_read_b64_tr_b16 v[192:193], v25 offset:0
    ds_read_b64_tr_b16 v[194:195], v25 offset:1024
    v_mfma_f32_32x32x16_bf16 v[96:111], v[232:235], v[216:219], v[96:111]
    ds_read_b64_tr_b16 v[196:197], v26 offset:0
    ds_read_b64_tr_b16 v[198:199], v26 offset:1024
    ds_read_b64_tr_b16 v[200:201], v27 offset:0
    v_mfma_f32_32x32x16_bf16 v[160:175], v[236:239], v[216:219], v[160:175]
    ds_read_b64_tr_b16 v[202:203], v27 offset:1024
    ds_read_b64_tr_b16 v[204:205], v28 offset:0
    ds_read_b64_tr_b16 v[206:207], v28 offset:1024
    v_mfma_f32_32x32x16_bf16 v[112:127], v[232:235], v[220:223], v[112:127]
    v_mfma_f32_32x32x16_bf16 v[176:191], v[236:239], v[220:223], v[176:191]
    s_waitcnt lgkmcnt(0)
    v_mfma_f32_32x32x16_bf16 v[64:79], v[224:227], v[192:195], v[64:79]
    ds_read_b128 v[232:235], v31
    ds_read_b128 v[236:239], v31 offset:16384
    s_add_u32 s38, s52, 72704
    buffer_store_dwordx4 v[16:19], v1, s[12:15], s38 offen sc0 sc1
    v_mfma_f32_32x32x16_bf16 v[128:143], v[228:231], v[192:195], v[128:143]
    ds_read_b64_tr_b16 v[208:209], v25 offset:4096
    ds_read_b64_tr_b16 v[210:211], v25 offset:5120
    v_mfma_f32_32x32x16_bf16 v[80:95], v[224:227], v[196:199], v[80:95]
    ds_read_b64_tr_b16 v[212:213], v26 offset:4096
    ds_read_b64_tr_b16 v[214:215], v26 offset:5120
    v_mfma_f32_32x32x16_bf16 v[144:159], v[228:231], v[196:199], v[144:159]
    ds_read_b64_tr_b16 v[216:217], v27 offset:4096
    ds_read_b64_tr_b16 v[218:219], v27 offset:5120
    v_mfma_f32_32x32x16_bf16 v[96:111], v[224:227], v[200:203], v[96:111]
    ds_read_b64_tr_b16 v[220:221], v28 offset:4096
    ds_read_b64_tr_b16 v[222:223], v28 offset:5120
    v_mfma_f32_32x32x16_bf16 v[160:175], v[228:231], v[200:203], v[160:175]
    v_mfma_f32_32x32x16_bf16 v[112:127], v[224:227], v[204:207], v[112:127]
    v_mfma_f32_32x32x16_bf16 v[176:191], v[228:231], v[204:207], v[176:191]
    s_waitcnt lgkmcnt(0)
    v_mfma_f32_32x32x16_bf16 v[64:79], v[232:235], v[208:211], v[64:79]
    ds_read_b128 v[224:227], v32
    ds_read_b128 v[228:231], v32 offset:16384
    v_mfma_f32_32x32x16_bf16 v[128:143], v[236:239], v[208:211], v[128:143]
    ds_read_b64_tr_b16 v[192:193], v25 offset:8192
    ds_read_b64_tr_b16 v[194:195], v25 offset:9216
    v_mfma_f32_32x32x16_bf16 v[80:95], v[232:235], v[212:215], v[80:95]
    ds_read_b64_tr_b16 v[196:197], v26 offset:8192
    ds_read_b64_tr_b16 v[198:199], v26 offset:9216
    v_mfma_f32_32x32x16_bf16 v[144:159], v[236:239], v[212:215], v[144:159]
    ds_read_b64_tr_b16 v[200:201], v27 offset:8192
    ds_read_b64_tr_b16 v[202:203], v27 offset:9216
    v_mfma_f32_32x32x16_bf16 v[96:111], v[232:235], v[216:219], v[96:111]
    ds_read_b64_tr_b16 v[204:205], v28 offset:8192
    ds_read_b64_tr_b16 v[206:207], v28 offset:9216
    v_mfma_f32_32x32x16_bf16 v[160:175], v[236:239], v[216:219], v[160:175]
    v_mfma_f32_32x32x16_bf16 v[112:127], v[232:235], v[220:223], v[112:127]
    v_mfma_f32_32x32x16_bf16 v[176:191], v[236:239], v[220:223], v[176:191]
    s_waitcnt lgkmcnt(0)
    v_mfma_f32_32x32x16_bf16 v[64:79], v[224:227], v[192:195], v[64:79]
    ds_read_b128 v[232:235], v33
    ds_read_b128 v[236:239], v33 offset:16384
    v_mfma_f32_32x32x16_bf16 v[128:143], v[228:231], v[192:195], v[128:143]
    ds_read_b64_tr_b16 v[208:209], v25 offset:12288
    ds_read_b64_tr_b16 v[210:211], v25 offset:13312
    v_mfma_f32_32x32x16_bf16 v[80:95], v[224:227], v[196:199], v[80:95]
    ds_read_b64_tr_b16 v[212:213], v26 offset:12288
    ds_read_b64_tr_b16 v[214:215], v26 offset:13312
    v_mfma_f32_32x32x16_bf16 v[144:159], v[228:231], v[196:199], v[144:159]
    ds_read_b64_tr_b16 v[216:217], v27 offset:12288
    ds_read_b64_tr_b16 v[218:219], v27 offset:13312
    v_mfma_f32_32x32x16_bf16 v[96:111], v[224:227], v[200:203], v[96:111]
    ds_read_b64_tr_b16 v[220:221], v28 offset:12288
    ds_read_b64_tr_b16 v[222:223], v28 offset:13312
    v_mfma_f32_32x32x16_bf16 v[160:175], v[228:231], v[200:203], v[160:175]
    v_mfma_f32_32x32x16_bf16 v[112:127], v[224:227], v[204:207], v[112:127]
    v_mfma_f32_32x32x16_bf16 v[176:191], v[228:231], v[204:207], v[176:191]
    s_waitcnt lgkmcnt(0)
    s_barrier
    v_mfma_f32_32x32x16_bf16 v[64:79], v[232:235], v[208:211], v[64:79]
    v_add_u32 v25, 0, v20
    v_add_u32 v26, 0, v21
    v_add_u32 v27, 0, v22
    v_mfma_f32_32x32x16_bf16 v[128:143], v[236:239], v[208:211], v[128:143]
    v_add_u32 v28, 0, v23
    v_add_u32 v29, 0, v24
    ds_read_b128 v[224:227], v29 offset:0
    v_mfma_f32_32x32x16_bf16 v[80:95], v[232:235], v[212:215], v[80:95]
    ds_read_b128 v[228:231], v29 offset:16384
    ds_read_b64_tr_b16 v[192:193], v25 offset:0
    ds_read_b64_tr_b16 v[194:195], v25 offset:1024
    v_mfma_f32_32x32x16_bf16 v[144:159], v[236:239], v[212:215], v[144:159]
    ds_read_b64_tr_b16 v[196:197], v26 offset:0
    ds_read_b64_tr_b16 v[198:199], v26 offset:1024
    ds_read_b64_tr_b16 v[200:201], v27 offset:0
    v_mfma_f32_32x32x16_bf16 v[96:111], v[232:235], v[216:219], v[96:111]
    ds_read_b64_tr_b16 v[202:203], v27 offset:1024
    ds_read_b64_tr_b16 v[204:205], v28 offset:0
    ds_read_b64_tr_b16 v[206:207], v28 offset:1024
    v_mfma_f32_32x32x16_bf16 v[160:175], v[236:239], v[216:219], v[160:175]
    v_mfma_f32_32x32x16_bf16 v[112:127], v[232:235], v[220:223], v[112:127]
    v_mfma_f32_32x32x16_bf16 v[176:191], v[236:239], v[220:223], v[176:191]
    s_nop 15
    v_cvt_pk_bf16_f32 v64, v64, v65
    v_cvt_pk_bf16_f32 v65, v66, v67
    v_cvt_pk_bf16_f32 v66, v68, v69
    v_cvt_pk_bf16_f32 v67, v70, v71
    s_add_u32 s38, s53, 0
    buffer_store_dwordx4 v[64:67], v1, s[12:15], s38 offen sc0 sc1
    v_cvt_pk_bf16_f32 v72, v72, v73
    v_cvt_pk_bf16_f32 v73, v74, v75
    v_cvt_pk_bf16_f32 v74, v76, v77
    v_cvt_pk_bf16_f32 v75, v78, v79
    s_add_u32 s38, s53, 1024
    buffer_store_dwordx4 v[72:75], v1, s[12:15], s38 offen sc0 sc1
    v_cvt_pk_bf16_f32 v80, v80, v81
    v_cvt_pk_bf16_f32 v81, v82, v83
    v_cvt_pk_bf16_f32 v82, v84, v85
    v_cvt_pk_bf16_f32 v83, v86, v87
    s_add_u32 s38, s53, 4096
    buffer_store_dwordx4 v[80:83], v1, s[12:15], s38 offen sc0 sc1
    v_cvt_pk_bf16_f32 v88, v88, v89
    v_cvt_pk_bf16_f32 v89, v90, v91
    v_cvt_pk_bf16_f32 v90, v92, v93
    v_cvt_pk_bf16_f32 v91, v94, v95
    s_add_u32 s38, s53, 5120
    buffer_store_dwordx4 v[88:91], v1, s[12:15], s38 offen sc0 sc1
    v_cvt_pk_bf16_f32 v96, v96, v97
    v_cvt_pk_bf16_f32 v97, v98, v99
    v_cvt_pk_bf16_f32 v98, v100, v101
    v_cvt_pk_bf16_f32 v99, v102, v103
    s_add_u32 s38, s53, 8192
    buffer_store_dwordx4 v[96:99], v1, s[12:15], s38 offen sc0 sc1
    v_cvt_pk_bf16_f32 v40, v104, v105
    v_cvt_pk_bf16_f32 v41, v106, v107
    v_cvt_pk_bf16_f32 v42, v108, v109
    v_cvt_pk_bf16_f32 v43, v110, v111
    v_cvt_pk_bf16_f32 v44, v112, v113
    v_cvt_pk_bf16_f32 v45, v114, v115
    v_cvt_pk_bf16_f32 v46, v116, v117
    v_cvt_pk_bf16_f32 v47, v118, v119
    v_cvt_pk_bf16_f32 v48, v120, v121
    v_cvt_pk_bf16_f32 v49, v122, v123
    v_cvt_pk_bf16_f32 v50, v124, v125
    v_cvt_pk_bf16_f32 v51, v126, v127
    v_cvt_pk_bf16_f32 v52, v128, v129
    v_cvt_pk_bf16_f32 v53, v130, v131
    v_cvt_pk_bf16_f32 v54, v132, v133
    v_cvt_pk_bf16_f32 v55, v134, v135
    v_cvt_pk_bf16_f32 v56, v136, v137
    v_cvt_pk_bf16_f32 v57, v138, v139
    v_cvt_pk_bf16_f32 v58, v140, v141
    v_cvt_pk_bf16_f32 v59, v142, v143
    v_cvt_pk_bf16_f32 v60, v144, v145
    v_cvt_pk_bf16_f32 v61, v146, v147
    v_cvt_pk_bf16_f32 v62, v148, v149
    v_cvt_pk_bf16_f32 v63, v150, v151
    v_cvt_pk_bf16_f32 v240, v152, v153
    v_cvt_pk_bf16_f32 v241, v154, v155
    v_cvt_pk_bf16_f32 v242, v156, v157
    v_cvt_pk_bf16_f32 v243, v158, v159
    v_cvt_pk_bf16_f32 v244, v160, v161
    v_cvt_pk_bf16_f32 v245, v162, v163
    v_cvt_pk_bf16_f32 v246, v164, v165
    v_cvt_pk_bf16_f32 v247, v166, v167
    v_cvt_pk_bf16_f32 v248, v168, v169
    v_cvt_pk_bf16_f32 v249, v170, v171
    v_cvt_pk_bf16_f32 v250, v172, v173
    v_cvt_pk_bf16_f32 v251, v174, v175
    v_cvt_pk_bf16_f32 v252, v176, v177
    v_cvt_pk_bf16_f32 v253, v178, v179
    v_cvt_pk_bf16_f32 v254, v180, v181
    v_cvt_pk_bf16_f32 v255, v182, v183
    v_cvt_pk_bf16_f32 v16, v184, v185
    v_cvt_pk_bf16_f32 v17, v186, v187
    v_cvt_pk_bf16_f32 v18, v188, v189
    v_cvt_pk_bf16_f32 v19, v190, v191
    s_nop 3
    s_waitcnt lgkmcnt(0)
    v_mfma_f32_32x32x16_bf16 v[64:79], v[192:195], v[224:227], 0
    ds_read_b128 v[232:235], v29 offset:1024
    ds_read_b128 v[236:239], v29 offset:17408
    s_add_u32 s38, s53, 9216
    buffer_store_dwordx4 v[40:43], v1, s[12:15], s38 offen sc0 sc1
    v_mfma_f32_32x32x16_bf16 v[128:143], v[192:195], v[228:231], 0
    ds_read_b64_tr_b16 v[208:209], v25 offset:4096
    ds_read_b64_tr_b16 v[210:211], v25 offset:5120
    v_mfma_f32_32x32x16_bf16 v[80:95], v[196:199], v[224:227], 0
    ds_read_b64_tr_b16 v[212:213], v26 offset:4096
    ds_read_b64_tr_b16 v[214:215], v26 offset:5120
    v_mfma_f32_32x32x16_bf16 v[144:159], v[196:199], v[228:231], 0
    ds_read_b64_tr_b16 v[216:217], v27 offset:4096
    ds_read_b64_tr_b16 v[218:219], v27 offset:5120
    v_mfma_f32_32x32x16_bf16 v[96:111], v[200:203], v[224:227], 0
    ds_read_b64_tr_b16 v[220:221], v28 offset:4096
    ds_read_b64_tr_b16 v[222:223], v28 offset:5120
    v_mfma_f32_32x32x16_bf16 v[160:175], v[200:203], v[228:231], 0
    v_mfma_f32_32x32x16_bf16 v[112:127], v[204:207], v[224:227], 0
    v_mfma_f32_32x32x16_bf16 v[176:191], v[204:207], v[228:231], 0
    s_waitcnt lgkmcnt(0)
    v_mfma_f32_32x32x16_bf16 v[64:79], v[208:211], v[232:235], v[64:79]
    ds_read_b128 v[224:227], v29 offset:2048
    ds_read_b128 v[228:231], v29 offset:18432
    s_add_u32 s38, s53, 12288
    buffer_store_dwordx4 v[44:47], v1, s[12:15], s38 offen sc0 sc1
    v_mfma_f32_32x32x16_bf16 v[128:143], v[208:211], v[236:239], v[128:143]
    ds_read_b64_tr_b16 v[192:193], v25 offset:8192
    ds_read_b64_tr_b16 v[194:195], v25 offset:9216
    v_mfma_f32_32x32x16_bf16 v[80:95], v[212:215], v[232:235], v[80:95]
    ds_read_b64_tr_b16 v[196:197], v26 offset:8192
    ds_read_b64_tr_b16 v[198:199], v26 offset:9216
    v_mfma_f32_32x32x16_bf16 v[144:159], v[212:215], v[236:239], v[144:159]
    ds_read_b64_tr_b16 v[200:201], v27 offset:8192
    ds_read_b64_tr_b16 v[202:203], v27 offset:9216
    v_mfma_f32_32x32x16_bf16 v[96:111], v[216:219], v[232:235], v[96:111]
    ds_read_b64_tr_b16 v[204:205], v28 offset:8192
    ds_read_b64_tr_b16 v[206:207], v28 offset:9216
    v_mfma_f32_32x32x16_bf16 v[160:175], v[216:219], v[236:239], v[160:175]
    v_mfma_f32_32x32x16_bf16 v[112:127], v[220:223], v[232:235], v[112:127]
    v_mfma_f32_32x32x16_bf16 v[176:191], v[220:223], v[236:239], v[176:191]
    s_waitcnt lgkmcnt(0)
    v_mfma_f32_32x32x16_bf16 v[64:79], v[192:195], v[224:227], v[64:79]
    ds_read_b128 v[232:235], v29 offset:3072
    ds_read_b128 v[236:239], v29 offset:19456
    s_add_u32 s38, s53, 13312
    buffer_store_dwordx4 v[48:51], v1, s[12:15], s38 offen sc0 sc1
    v_mfma_f32_32x32x16_bf16 v[128:143], v[192:195], v[228:231], v[128:143]
    ds_read_b64_tr_b16 v[208:209], v25 offset:12288
    ds_read_b64_tr_b16 v[210:211], v25 offset:13312
    v_mfma_f32_32x32x16_bf16 v[80:95], v[196:199], v[224:227], v[80:95]
    ds_read_b64_tr_b16 v[212:213], v26 offset:12288
    ds_read_b64_tr_b16 v[214:215], v26 offset:13312
    v_mfma_f32_32x32x16_bf16 v[144:159], v[196:199], v[228:231], v[144:159]
    ds_read_b64_tr_b16 v[216:217], v27 offset:12288
    ds_read_b64_tr_b16 v[218:219], v27 offset:13312
    v_mfma_f32_32x32x16_bf16 v[96:111], v[200:203], v[224:227], v[96:111]
    ds_read_b64_tr_b16 v[220:221], v28 offset:12288
    ds_read_b64_tr_b16 v[222:223], v28 offset:13312
    v_mfma_f32_32x32x16_bf16 v[160:175], v[200:203], v[228:231], v[160:175]
    v_mfma_f32_32x32x16_bf16 v[112:127], v[204:207], v[224:227], v[112:127]
    v_mfma_f32_32x32x16_bf16 v[176:191], v[204:207], v[228:231], v[176:191]
    s_waitcnt lgkmcnt(0)
    s_barrier
    v_mfma_f32_32x32x16_bf16 v[64:79], v[208:211], v[232:235], v[64:79]
    v_add_u32 v25, 49152, v20
    v_add_u32 v26, 49152, v21
    v_add_u32 v27, 49152, v22
    v_mfma_f32_32x32x16_bf16 v[128:143], v[208:211], v[236:239], v[128:143]
    v_add_u32 v28, 49152, v23
    v_add_u32 v29, 49152, v24
    ds_read_b128 v[224:227], v29 offset:0
    v_mfma_f32_32x32x16_bf16 v[80:95], v[212:215], v[232:235], v[80:95]
    ds_read_b128 v[228:231], v29 offset:16384
    ds_read_b64_tr_b16 v[192:193], v25 offset:0
    ds_read_b64_tr_b16 v[194:195], v25 offset:1024
    v_mfma_f32_32x32x16_bf16 v[144:159], v[212:215], v[236:239], v[144:159]
    ds_read_b64_tr_b16 v[196:197], v26 offset:0
    ds_read_b64_tr_b16 v[198:199], v26 offset:1024
    ds_read_b64_tr_b16 v[200:201], v27 offset:0
    v_mfma_f32_32x32x16_bf16 v[96:111], v[216:219], v[232:235], v[96:111]
    ds_read_b64_tr_b16 v[202:203], v27 offset:1024
    ds_read_b64_tr_b16 v[204:205], v28 offset:0
    ds_read_b64_tr_b16 v[206:207], v28 offset:1024
    v_mfma_f32_32x32x16_bf16 v[160:175], v[216:219], v[236:239], v[160:175]
    v_mfma_f32_32x32x16_bf16 v[112:127], v[220:223], v[232:235], v[112:127]
    v_mfma_f32_32x32x16_bf16 v[176:191], v[220:223], v[236:239], v[176:191]
    s_waitcnt lgkmcnt(0)
    v_mfma_f32_32x32x16_bf16 v[64:79], v[192:195], v[224:227], v[64:79]
    ds_read_b128 v[232:235], v29 offset:1024
    ds_read_b128 v[236:239], v29 offset:17408
    s_add_u32 s38, s53, 65536
    buffer_store_dwordx4 v[52:55], v1, s[12:15], s38 offen sc0 sc1
    v_mfma_f32_32x32x16_bf16 v[128:143], v[192:195], v[228:231], v[128:143]
    ds_read_b64_tr_b16 v[208:209], v25 offset:4096
    ds_read_b64_tr_b16 v[210:211], v25 offset:5120
    v_mfma_f32_32x32x16_bf16 v[80:95], v[196:199], v[224:227], v[80:95]
    ds_read_b64_tr_b16 v[212:213], v26 offset:4096
    ds_read_b64_tr_b16 v[214:215], v26 offset:5120
    v_mfma_f32_32x32x16_bf16 v[144:159], v[196:199], v[228:231], v[144:159]
    ds_read_b64_tr_b16 v[216:217], v27 offset:4096
    ds_read_b64_tr_b16 v[218:219], v27 offset:5120
    v_mfma_f32_32x32x16_bf16 v[96:111], v[200:203], v[224:227], v[96:111]
    ds_read_b64_tr_b16 v[220:221], v28 offset:4096
    ds_read_b64_tr_b16 v[222:223], v28 offset:5120
    v_mfma_f32_32x32x16_bf16 v[160:175], v[200:203], v[228:231], v[160:175]
    v_mfma_f32_32x32x16_bf16 v[112:127], v[204:207], v[224:227], v[112:127]
    v_mfma_f32_32x32x16_bf16 v[176:191], v[204:207], v[228:231], v[176:191]
    s_waitcnt lgkmcnt(0)
    v_mfma_f32_32x32x16_bf16 v[64:79], v[208:211], v[232:235], v[64:79]
    ds_read_b128 v[224:227], v29 offset:2048
    ds_read_b128 v[228:231], v29 offset:18432
    s_add_u32 s38, s53, 66560
    buffer_store_dwordx4 v[56:59], v1, s[12:15], s38 offen sc0 sc1
    v_mfma_f32_32x32x16_bf16 v[128:143], v[208:211], v[236:239], v[128:143]
    ds_read_b64_tr_b16 v[192:193], v25 offset:8192
    ds_read_b64_tr_b16 v[194:195], v25 offset:9216
    v_mfma_f32_32x32x16_bf16 v[80:95], v[212:215], v[232:235], v[80:95]
    ds_read_b64_tr_b16 v[196:197], v26 offset:8192
    ds_read_b64_tr_b16 v[198:199], v26 offset:9216
    v_mfma_f32_32x32x16_bf16 v[144:159], v[212:215], v[236:239], v[144:159]
    ds_read_b64_tr_b16 v[200:201], v27 offset:8192
    ds_read_b64_tr_b16 v[202:203], v27 offset:9216
    v_mfma_f32_32x32x16_bf16 v[96:111], v[216:219], v[232:235], v[96:111]
    ds_read_b64_tr_b16 v[204:205], v28 offset:8192
    ds_read_b64_tr_b16 v[206:207], v28 offset:9216
    v_mfma_f32_32x32x16_bf16 v[160:175], v[216:219], v[236:239], v[160:175]
    v_mfma_f32_32x32x16_bf16 v[112:127], v[220:223], v[232:235], v[112:127]
    v_mfma_f32_32x32x16_bf16 v[176:191], v[220:223], v[236:239], v[176:191]
    s_waitcnt lgkmcnt(0)
    v_mfma_f32_32x32x16_bf16 v[64:79], v[192:195], v[224:227], v[64:79]
    ds_read_b128 v[232:235], v29 offset:3072
    ds_read_b128 v[236:239], v29 offset:19456
    v_mfma_f32_32x32x16_bf16 v[128:143], v[192:195], v[228:231], v[128:143]
    ds_read_b64_tr_b16 v[208:209], v25 offset:12288
    ds_read_b64_tr_b16 v[210:211], v25 offset:13312
    v_mfma_f32_32x32x16_bf16 v[80:95], v[196:199], v[224:227], v[80:95]
    ds_read_b64_tr_b16 v[212:213], v26 offset:12288
    ds_read_b64_tr_b16 v[214:215], v26 offset:13312
    v_mfma_f32_32x32x16_bf16 v[144:159], v[196:199], v[228:231], v[144:159]
    ds_read_b64_tr_b16 v[216:217], v27 offset:12288
    ds_read_b64_tr_b16 v[218:219], v27 offset:13312
    v_mfma_f32_32x32x16_bf16 v[96:111], v[200:203], v[224:227], v[96:111]
    ds_read_b64_tr_b16 v[220:221], v28 offset:12288
    ds_read_b64_tr_b16 v[222:223], v28 offset:13312
    v_mfma_f32_32x32x16_bf16 v[160:175], v[200:203], v[228:231], v[160:175]
    v_mfma_f32_32x32x16_bf16 v[112:127], v[204:207], v[224:227], v[112:127]
    v_mfma_f32_32x32x16_bf16 v[176:191], v[204:207], v[228:231], v[176:191]
    s_waitcnt lgkmcnt(0)
    s_barrier
    v_mfma_f32_32x32x16_bf16 v[64:79], v[208:211], v[232:235], v[64:79]
    v_add_u32 v25, 98304, v20
    v_add_u32 v26, 98304, v21
    v_add_u32 v27, 98304, v22
    s_add_u32 s38, s53, 69632
    buffer_store_dwordx4 v[60:63], v1, s[12:15], s38 offen sc0 sc1
    v_mfma_f32_32x32x16_bf16 v[128:143], v[208:211], v[236:239], v[128:143]
    v_add_u32 v28, 98304, v23
    v_add_u32 v29, 98304, v24
    ds_read_b128 v[224:227], v29 offset:0
    v_mfma_f32_32x32x16_bf16 v[80:95], v[212:215], v[232:235], v[80:95]
    ds_read_b128 v[228:231], v29 offset:16384
    ds_read_b64_tr_b16 v[192:193], v25 offset:0
    ds_read_b64_tr_b16 v[194:195], v25 offset:1024
    v_mfma_f32_32x32x16_bf16 v[144:159], v[212:215], v[236:239], v[144:159]
    ds_read_b64_tr_b16 v[196:197], v26 offset:0
    ds_read_b64_tr_b16 v[198:199], v26 offset:1024
    ds_read_b64_tr_b16 v[200:201], v27 offset:0
    v_mfma_f32_32x32x16_bf16 v[96:111], v[216:219], v[232:235], v[96:111]
    ds_read_b64_tr_b16 v[202:203], v27 offset:1024
    ds_read_b64_tr_b16 v[204:205], v28 offset:0
    ds_read_b64_tr_b16 v[206:207], v28 offset:1024
    v_mfma_f32_32x32x16_bf16 v[160:175], v[216:219], v[236:239], v[160:175]
    v_mfma_f32_32x32x16_bf16 v[112:127], v[220:223], v[232:235], v[112:127]
    v_mfma_f32_32x32x16_bf16 v[176:191], v[220:223], v[236:239], v[176:191]
    s_waitcnt lgkmcnt(0)
    v_mfma_f32_32x32x16_bf16 v[64:79], v[192:195], v[224:227], v[64:79]
    ds_read_b128 v[232:235], v29 offset:1024
    ds_read_b128 v[236:239], v29 offset:17408
    s_add_u32 s38, s53, 70656
    buffer_store_dwordx4 v[240:243], v1, s[12:15], s38 offen sc0 sc1
    v_mfma_f32_32x32x16_bf16 v[128:143], v[192:195], v[228:231], v[128:143]
    ds_read_b64_tr_b16 v[208:209], v25 offset:4096
    ds_read_b64_tr_b16 v[210:211], v25 offset:5120
    v_mfma_f32_32x32x16_bf16 v[80:95], v[196:199], v[224:227], v[80:95]
    ds_read_b64_tr_b16 v[212:213], v26 offset:4096
    ds_read_b64_tr_b16 v[214:215], v26 offset:5120
    v_mfma_f32_32x32x16_bf16 v[144:159], v[196:199], v[228:231], v[144:159]
    ds_read_b64_tr_b16 v[216:217], v27 offset:4096
    ds_read_b64_tr_b16 v[218:219], v27 offset:5120
    v_mfma_f32_32x32x16_bf16 v[96:111], v[200:203], v[224:227], v[96:111]
    ds_read_b64_tr_b16 v[220:221], v28 offset:4096
    ds_read_b64_tr_b16 v[222:223], v28 offset:5120
    v_mfma_f32_32x32x16_bf16 v[160:175], v[200:203], v[228:231], v[160:175]
    v_mfma_f32_32x32x16_bf16 v[112:127], v[204:207], v[224:227], v[112:127]
    v_mfma_f32_32x32x16_bf16 v[176:191], v[204:207], v[228:231], v[176:191]
    s_waitcnt lgkmcnt(0)
    v_mfma_f32_32x32x16_bf16 v[64:79], v[208:211], v[232:235], v[64:79]
    ds_read_b128 v[224:227], v29 offset:2048
    ds_read_b128 v[228:231], v29 offset:18432
    v_mfma_f32_32x32x16_bf16 v[128:143], v[208:211], v[236:239], v[128:143]
    ds_read_b64_tr_b16 v[192:193], v25 offset:8192
    ds_read_b64_tr_b16 v[194:195], v25 offset:9216
    v_mfma_f32_32x32x16_bf16 v[80:95], v[212:215], v[232:235], v[80:95]
    ds_read_b64_tr_b16 v[196:197], v26 offset:8192
    ds_read_b64_tr_b16 v[198:199], v26 offset:9216
    v_mfma_f32_32x32x16_bf16 v[144:159], v[212:215], v[236:239], v[144:159]
    ds_read_b64_tr_b16 v[200:201], v27 offset:8192
    ds_read_b64_tr_b16 v[202:203], v27 offset:9216
    v_mfma_f32_32x32x16_bf16 v[96:111], v[216:219], v[232:235], v[96:111]
    ds_read_b64_tr_b16 v[204:205], v28 offset:8192
    ds_read_b64_tr_b16 v[206:207], v28 offset:9216
    v_mfma_f32_32x32x16_bf16 v[160:175], v[216:219], v[236:239], v[160:175]
    v_mfma_f32_32x32x16_bf16 v[112:127], v[220:223], v[232:235], v[112:127]
    v_mfma_f32_32x32x16_bf16 v[176:191], v[220:223], v[236:239], v[176:191]
    s_waitcnt lgkmcnt(0)
    v_mfma_f32_32x32x16_bf16 v[64:79], v[192:195], v[224:227], v[64:79]
    ds_read_b128 v[232:235], v29 offset:3072
    ds_read_b128 v[236:239], v29 offset:19456
    s_add_u32 s38, s53, 73728
    buffer_store_dwordx4 v[244:247], v1, s[12:15], s38 offen sc0 sc1
    v_mfma_f32_32x32x16_bf16 v[128:143], v[192:195], v[228:231], v[128:143]
    ds_read_b64_tr_b16 v[208:209], v25 offset:12288
    ds_read_b64_tr_b16 v[210:211], v25 offset:13312
    v_mfma_f32_32x32x16_bf16 v[80:95], v[196:199], v[224:227], v[80:95]
    ds_read_b64_tr_b16 v[212:213], v26 offset:12288
    ds_read_b64_tr_b16 v[214:215], v26 offset:13312
    v_mfma_f32_32x32x16_bf16 v[144:159], v[196:199], v[228:231], v[144:159]
    ds_read_b64_tr_b16 v[216:217], v27 offset:12288
    ds_read_b64_tr_b16 v[218:219], v27 offset:13312
    v_mfma_f32_32x32x16_bf16 v[96:111], v[200:203], v[224:227], v[96:111]
    ds_read_b64_tr_b16 v[220:221], v28 offset:12288
    ds_read_b64_tr_b16 v[222:223], v28 offset:13312
    v_mfma_f32_32x32x16_bf16 v[160:175], v[200:203], v[228:231], v[160:175]
    v_mfma_f32_32x32x16_bf16 v[112:127], v[204:207], v[224:227], v[112:127]
    v_mfma_f32_32x32x16_bf16 v[176:191], v[204:207], v[228:231], v[176:191]
    s_waitcnt lgkmcnt(0)
    s_barrier
    v_mfma_f32_32x32x16_bf16 v[64:79], v[208:211], v[232:235], v[64:79]
    v_add_u32 v25, 0, v20
    v_add_u32 v26, 0, v21
    v_add_u32 v27, 0, v22
    s_add_u32 s38, s53, 74752
    buffer_store_dwordx4 v[248:251], v1, s[12:15], s38 offen sc0 sc1
    v_mfma_f32_32x32x16_bf16 v[128:143], v[208:211], v[236:239], v[128:143]
    v_add_u32 v28, 0, v23
    v_add_u32 v29, 0, v24
    ds_read_b128 v[224:227], v29 offset:0
    v_mfma_f32_32x32x16_bf16 v[80:95], v[212:215], v[232:235], v[80:95]
    ds_read_b128 v[228:231], v29 offset:16384
    ds_read_b64_tr_b16 v[192:193], v25 offset:0
    ds_read_b64_tr_b16 v[194:195], v25 offset:1024
    v_mfma_f32_32x32x16_bf16 v[144:159], v[212:215], v[236:239], v[144:159]
    ds_read_b64_tr_b16 v[196:197], v26 offset:0
    ds_read_b64_tr_b16 v[198:199], v26 offset:1024
    ds_read_b64_tr_b16 v[200:201], v27 offset:0
    v_mfma_f32_32x32x16_bf16 v[96:111], v[216:219], v[232:235], v[96:111]
    ds_read_b64_tr_b16 v[202:203], v27 offset:1024
    ds_read_b64_tr_b16 v[204:205], v28 offset:0
    ds_read_b64_tr_b16 v[206:207], v28 offset:1024
    v_mfma_f32_32x32x16_bf16 v[160:175], v[216:219], v[236:239], v[160:175]
    v_mfma_f32_32x32x16_bf16 v[112:127], v[220:223], v[232:235], v[112:127]
    v_mfma_f32_32x32x16_bf16 v[176:191], v[220:223], v[236:239], v[176:191]
    s_waitcnt lgkmcnt(0)
    v_mfma_f32_32x32x16_bf16 v[64:79], v[192:195], v[224:227], v[64:79]
    ds_read_b128 v[232:235], v29 offset:1024
    ds_read_b128 v[236:239], v29 offset:17408
    v_mfma_f32_32x32x16_bf16 v[128:143], v[192:195], v[228:231], v[128:143]
    ds_read_b64_tr_b16 v[208:209], v25 offset:4096
    ds_read_b64_tr_b16 v[210:211], v25 offset:5120
    v_mfma_f32_32x32x16_bf16 v[80:95], v[196:199], v[224:227], v[80:95]
    ds_read_b64_tr_b16 v[212:213], v26 offset:4096
    ds_read_b64_tr_b16 v[214:215], v26 offset:5120
    v_mfma_f32_32x32x16_bf16 v[144:159], v[196:199], v[228:231], v[144:159]
    ds_read_b64_tr_b16 v[216:217], v27 offset:4096
    ds_read_b64_tr_b16 v[218:219], v27 offset:5120
    v_mfma_f32_32x32x16_bf16 v[96:111], v[200:203], v[224:227], v[96:111]
    ds_read_b64_tr_b16 v[220:221], v28 offset:4096
    ds_read_b64_tr_b16 v[222:223], v28 offset:5120
    v_mfma_f32_32x32x16_bf16 v[160:175], v[200:203], v[228:231], v[160:175]
    v_mfma_f32_32x32x16_bf16 v[112:127], v[204:207], v[224:227], v[112:127]
    v_mfma_f32_32x32x16_bf16 v[176:191], v[204:207], v[228:231], v[176:191]
    s_waitcnt lgkmcnt(0)
    v_mfma_f32_32x32x16_bf16 v[64:79], v[208:211], v[232:235], v[64:79]
    ds_read_b128 v[224:227], v29 offset:2048
    ds_read_b128 v[228:231], v29 offset:18432
    s_add_u32 s38, s53, 77824
    buffer_store_dwordx4 v[252:255], v1, s[12:15], s38 offen sc0 sc1
    v_mfma_f32_32x32x16_bf16 v[128:143], v[208:211], v[236:239], v[128:143]
    ds_read_b64_tr_b16 v[192:193], v25 offset:8192
    ds_read_b64_tr_b16 v[194:195], v25 offset:9216
    v_mfma_f32_32x32x16_bf16 v[80:95], v[212:215], v[232:235], v[80:95]
    ds_read_b64_tr_b16 v[196:197], v26 offset:8192
    ds_read_b64_tr_b16 v[198:199], v26 offset:9216
    v_mfma_f32_32x32x16_bf16 v[144:159], v[212:215], v[236:239], v[144:159]
    ds_read_b64_tr_b16 v[200:201], v27 offset:8192
    ds_read_b64_tr_b16 v[202:203], v27 offset:9216
    v_mfma_f32_32x32x16_bf16 v[96:111], v[216:219], v[232:235], v[96:111]
    ds_read_b64_tr_b16 v[204:205], v28 offset:8192
    ds_read_b64_tr_b16 v[206:207], v28 offset:9216
    v_mfma_f32_32x32x16_bf16 v[160:175], v[216:219], v[236:239], v[160:175]
    v_mfma_f32_32x32x16_bf16 v[112:127], v[220:223], v[232:235], v[112:127]
    v_mfma_f32_32x32x16_bf16 v[176:191], v[220:223], v[236:239], v[176:191]
    s_waitcnt lgkmcnt(0)
    v_mfma_f32_32x32x16_bf16 v[64:79], v[192:195], v[224:227], v[64:79]
    ds_read_b128 v[232:235], v29 offset:3072
    ds_read_b128 v[236:239], v29 offset:19456
    s_add_u32 s38, s53, 78848
    buffer_store_dwordx4 v[16:19], v1, s[12:15], s38 offen sc0 sc1
    v_mfma_f32_32x32x16_bf16 v[128:143], v[192:195], v[228:231], v[128:143]
    ds_read_b64_tr_b16 v[208:209], v25 offset:12288
    ds_read_b64_tr_b16 v[210:211], v25 offset:13312
    v_mfma_f32_32x32x16_bf16 v[80:95], v[196:199], v[224:227], v[80:95]
    ds_read_b64_tr_b16 v[212:213], v26 offset:12288
    ds_read_b64_tr_b16 v[214:215], v26 offset:13312
    v_mfma_f32_32x32x16_bf16 v[144:159], v[196:199], v[228:231], v[144:159]
    ds_read_b64_tr_b16 v[216:217], v27 offset:12288
    ds_read_b64_tr_b16 v[218:219], v27 offset:13312
    v_mfma_f32_32x32x16_bf16 v[96:111], v[200:203], v[224:227], v[96:111]
    ds_read_b64_tr_b16 v[220:221], v28 offset:12288
    ds_read_b64_tr_b16 v[222:223], v28 offset:13312
    v_mfma_f32_32x32x16_bf16 v[160:175], v[200:203], v[228:231], v[160:175]
    v_mfma_f32_32x32x16_bf16 v[112:127], v[204:207], v[224:227], v[112:127]
    v_mfma_f32_32x32x16_bf16 v[176:191], v[204:207], v[228:231], v[176:191]
    s_waitcnt lgkmcnt(0)
    s_barrier
    v_mfma_f32_32x32x16_bf16 v[64:79], v[208:211], v[232:235], v[64:79]
    v_add_u32 v25, 49152, v20
    v_add_u32 v26, 49152, v21
    v_add_u32 v27, 49152, v22
    v_mfma_f32_32x32x16_bf16 v[128:143], v[208:211], v[236:239], v[128:143]
    v_add_u32 v28, 49152, v23
    v_add_u32 v29, 49152, v24
    ds_read_b128 v[224:227], v29 offset:0
    v_mfma_f32_32x32x16_bf16 v[80:95], v[212:215], v[232:235], v[80:95]
    ds_read_b128 v[228:231], v29 offset:16384
    ds_read_b64_tr_b16 v[192:193], v25 offset:0
    ds_read_b64_tr_b16 v[194:195], v25 offset:1024
    v_mfma_f32_32x32x16_bf16 v[144:159], v[212:215], v[236:239], v[144:159]
    ds_read_b64_tr_b16 v[196:197], v26 offset:0
    ds_read_b64_tr_b16 v[198:199], v26 offset:1024
    ds_read_b64_tr_b16 v[200:201], v27 offset:0
    v_mfma_f32_32x32x16_bf16 v[96:111], v[216:219], v[232:235], v[96:111]
    ds_read_b64_tr_b16 v[202:203], v27 offset:1024
    ds_read_b64_tr_b16 v[204:205], v28 offset:0
    ds_read_b64_tr_b16 v[206:207], v28 offset:1024
    v_mfma_f32_32x32x16_bf16 v[160:175], v[216:219], v[236:239], v[160:175]
    v_mfma_f32_32x32x16_bf16 v[112:127], v[220:223], v[232:235], v[112:127]
    v_mfma_f32_32x32x16_bf16 v[176:191], v[220:223], v[236:239], v[176:191]
    s_waitcnt lgkmcnt(0)
    v_mfma_f32_32x32x16_bf16 v[64:79], v[192:195], v[224:227], v[64:79]
    ds_read_b128 v[232:235], v29 offset:1024
    ds_read_b128 v[236:239], v29 offset:17408
    v_mfma_f32_32x32x16_bf16 v[128:143], v[192:195], v[228:231], v[128:143]
    ds_read_b64_tr_b16 v[208:209], v25 offset:4096
    ds_read_b64_tr_b16 v[210:211], v25 offset:5120
    v_mfma_f32_32x32x16_bf16 v[80:95], v[196:199], v[224:227], v[80:95]
    ds_read_b64_tr_b16 v[212:213], v26 offset:4096
    ds_read_b64_tr_b16 v[214:215], v26 offset:5120
    v_mfma_f32_32x32x16_bf16 v[144:159], v[196:199], v[228:231], v[144:159]
    ds_read_b64_tr_b16 v[216:217], v27 offset:4096
    ds_read_b64_tr_b16 v[218:219], v27 offset:5120
    v_mfma_f32_32x32x16_bf16 v[96:111], v[200:203], v[224:227], v[96:111]
    ds_read_b64_tr_b16 v[220:221], v28 offset:4096
    ds_read_b64_tr_b16 v[222:223], v28 offset:5120
    v_mfma_f32_32x32x16_bf16 v[160:175], v[200:203], v[228:231], v[160:175]
    v_mfma_f32_32x32x16_bf16 v[112:127], v[204:207], v[224:227], v[112:127]
    v_mfma_f32_32x32x16_bf16 v[176:191], v[204:207], v[228:231], v[176:191]
    s_waitcnt lgkmcnt(0)
    v_mfma_f32_32x32x16_bf16 v[64:79], v[208:211], v[232:235], v[64:79]
    ds_read_b128 v[224:227], v29 offset:2048
    ds_read_b128 v[228:231], v29 offset:18432
    v_mfma_f32_32x32x16_bf16 v[128:143], v[208:211], v[236:239], v[128:143]
    ds_read_b64_tr_b16 v[192:193], v25 offset:8192
    ds_read_b64_tr_b16 v[194:195], v25 offset:9216
    v_mfma_f32_32x32x16_bf16 v[80:95], v[212:215], v[232:235], v[80:95]
    ds_read_b64_tr_b16 v[196:197], v26 offset:8192
    ds_read_b64_tr_b16 v[198:199], v26 offset:9216
    v_mfma_f32_32x32x16_bf16 v[144:159], v[212:215], v[236:239], v[144:159]
    ds_read_b64_tr_b16 v[200:201], v27 offset:8192
    ds_read_b64_tr_b16 v[202:203], v27 offset:9216
    v_mfma_f32_32x32x16_bf16 v[96:111], v[216:219], v[232:235], v[96:111]
    ds_read_b64_tr_b16 v[204:205], v28 offset:8192
    ds_read_b64_tr_b16 v[206:207], v28 offset:9216
    v_mfma_f32_32x32x16_bf16 v[160:175], v[216:219], v[236:239], v[160:175]
    v_mfma_f32_32x32x16_bf16 v[112:127], v[220:223], v[232:235], v[112:127]
    v_mfma_f32_32x32x16_bf16 v[176:191], v[220:223], v[236:239], v[176:191]
    s_waitcnt lgkmcnt(0)
    v_mfma_f32_32x32x16_bf16 v[64:79], v[192:195], v[224:227], v[64:79]
    ds_read_b128 v[232:235], v29 offset:3072
    ds_read_b128 v[236:239], v29 offset:19456
    v_mfma_f32_32x32x16_bf16 v[128:143], v[192:195], v[228:231], v[128:143]
    ds_read_b64_tr_b16 v[208:209], v25 offset:12288
    ds_read_b64_tr_b16 v[210:211], v25 offset:13312
    v_mfma_f32_32x32x16_bf16 v[80:95], v[196:199], v[224:227], v[80:95]
    ds_read_b64_tr_b16 v[212:213], v26 offset:12288
    ds_read_b64_tr_b16 v[214:215], v26 offset:13312
    v_mfma_f32_32x32x16_bf16 v[144:159], v[196:199], v[228:231], v[144:159]
    ds_read_b64_tr_b16 v[216:217], v27 offset:12288
    ds_read_b64_tr_b16 v[218:219], v27 offset:13312
    v_mfma_f32_32x32x16_bf16 v[96:111], v[200:203], v[224:227], v[96:111]
    ds_read_b64_tr_b16 v[220:221], v28 offset:12288
    ds_read_b64_tr_b16 v[222:223], v28 offset:13312
    v_mfma_f32_32x32x16_bf16 v[160:175], v[200:203], v[228:231], v[160:175]
    v_mfma_f32_32x32x16_bf16 v[112:127], v[204:207], v[224:227], v[112:127]
    v_mfma_f32_32x32x16_bf16 v[176:191], v[204:207], v[228:231], v[176:191]
    s_waitcnt lgkmcnt(0)
    s_waitcnt vmcnt(0)
    s_barrier
    v_mfma_f32_32x32x16_bf16 v[64:79], v[208:211], v[232:235], v[64:79]
    v_add_u32 v25, 98304, v20
    v_add_u32 v26, 98304, v21
    v_add_u32 v27, 98304, v22
    v_mfma_f32_32x32x16_bf16 v[128:143], v[208:211], v[236:239], v[128:143]
    v_add_u32 v28, 98304, v23
    v_add_u32 v29, 98304, v24
    ds_read_b128 v[224:227], v29 offset:0
    v_mfma_f32_32x32x16_bf16 v[80:95], v[212:215], v[232:235], v[80:95]
    ds_read_b128 v[228:231], v29 offset:16384
    ds_read_b64_tr_b16 v[192:193], v25 offset:0
    ds_read_b64_tr_b16 v[194:195], v25 offset:1024
    v_mfma_f32_32x32x16_bf16 v[144:159], v[212:215], v[236:239], v[144:159]
    ds_read_b64_tr_b16 v[196:197], v26 offset:0
    ds_read_b64_tr_b16 v[198:199], v26 offset:1024
    ds_read_b64_tr_b16 v[200:201], v27 offset:0
    v_mfma_f32_32x32x16_bf16 v[96:111], v[216:219], v[232:235], v[96:111]
    ds_read_b64_tr_b16 v[202:203], v27 offset:1024
    ds_read_b64_tr_b16 v[204:205], v28 offset:0
    ds_read_b64_tr_b16 v[206:207], v28 offset:1024
    v_mfma_f32_32x32x16_bf16 v[160:175], v[216:219], v[236:239], v[160:175]
    v_mfma_f32_32x32x16_bf16 v[112:127], v[220:223], v[232:235], v[112:127]
    v_mfma_f32_32x32x16_bf16 v[176:191], v[220:223], v[236:239], v[176:191]
    s_waitcnt lgkmcnt(0)
    v_mfma_f32_32x32x16_bf16 v[64:79], v[192:195], v[224:227], v[64:79]
    ds_read_b128 v[232:235], v29 offset:1024
    ds_read_b128 v[236:239], v29 offset:17408
    v_mfma_f32_32x32x16_bf16 v[128:143], v[192:195], v[228:231], v[128:143]
    ds_read_b64_tr_b16 v[208:209], v25 offset:4096
    ds_read_b64_tr_b16 v[210:211], v25 offset:5120
    v_mfma_f32_32x32x16_bf16 v[80:95], v[196:199], v[224:227], v[80:95]
    ds_read_b64_tr_b16 v[212:213], v26 offset:4096
    ds_read_b64_tr_b16 v[214:215], v26 offset:5120
    v_mfma_f32_32x32x16_bf16 v[144:159], v[196:199], v[228:231], v[144:159]
    ds_read_b64_tr_b16 v[216:217], v27 offset:4096
    ds_read_b64_tr_b16 v[218:219], v27 offset:5120
    v_mfma_f32_32x32x16_bf16 v[96:111], v[200:203], v[224:227], v[96:111]
    ds_read_b64_tr_b16 v[220:221], v28 offset:4096
    ds_read_b64_tr_b16 v[222:223], v28 offset:5120
    v_mfma_f32_32x32x16_bf16 v[160:175], v[200:203], v[228:231], v[160:175]
    v_mfma_f32_32x32x16_bf16 v[112:127], v[204:207], v[224:227], v[112:127]
    v_mfma_f32_32x32x16_bf16 v[176:191], v[204:207], v[228:231], v[176:191]
    s_waitcnt lgkmcnt(0)
    v_mfma_f32_32x32x16_bf16 v[64:79], v[208:211], v[232:235], v[64:79]
    ds_read_b128 v[224:227], v29 offset:2048
    ds_read_b128 v[228:231], v29 offset:18432
    v_mfma_f32_32x32x16_bf16 v[128:143], v[208:211], v[236:239], v[128:143]
    ds_read_b64_tr_b16 v[192:193], v25 offset:8192
    ds_read_b64_tr_b16 v[194:195], v25 offset:9216
    v_mfma_f32_32x32x16_bf16 v[80:95], v[212:215], v[232:235], v[80:95]
    ds_read_b64_tr_b16 v[196:197], v26 offset:8192
    ds_read_b64_tr_b16 v[198:199], v26 offset:9216
    v_mfma_f32_32x32x16_bf16 v[144:159], v[212:215], v[236:239], v[144:159]
    ds_read_b64_tr_b16 v[200:201], v27 offset:8192
    ds_read_b64_tr_b16 v[202:203], v27 offset:9216
    v_mfma_f32_32x32x16_bf16 v[96:111], v[216:219], v[232:235], v[96:111]
    ds_read_b64_tr_b16 v[204:205], v28 offset:8192
    ds_read_b64_tr_b16 v[206:207], v28 offset:9216
    v_mfma_f32_32x32x16_bf16 v[160:175], v[216:219], v[236:239], v[160:175]
    v_mfma_f32_32x32x16_bf16 v[112:127], v[220:223], v[232:235], v[112:127]
    v_mfma_f32_32x32x16_bf16 v[176:191], v[220:223], v[236:239], v[176:191]
    s_waitcnt lgkmcnt(0)
    v_mfma_f32_32x32x16_bf16 v[64:79], v[192:195], v[224:227], v[64:79]
    ds_read_b128 v[232:235], v29 offset:3072
    ds_read_b128 v[236:239], v29 offset:19456
    v_mfma_f32_32x32x16_bf16 v[128:143], v[192:195], v[228:231], v[128:143]
    ds_read_b64_tr_b16 v[208:209], v25 offset:12288
    ds_read_b64_tr_b16 v[210:211], v25 offset:13312
    v_mfma_f32_32x32x16_bf16 v[80:95], v[196:199], v[224:227], v[80:95]
    ds_read_b64_tr_b16 v[212:213], v26 offset:12288
    ds_read_b64_tr_b16 v[214:215], v26 offset:13312
    v_mfma_f32_32x32x16_bf16 v[144:159], v[196:199], v[228:231], v[144:159]
    ds_read_b64_tr_b16 v[216:217], v27 offset:12288
    ds_read_b64_tr_b16 v[218:219], v27 offset:13312
    v_mfma_f32_32x32x16_bf16 v[96:111], v[200:203], v[224:227], v[96:111]
    ds_read_b64_tr_b16 v[220:221], v28 offset:12288
    ds_read_b64_tr_b16 v[222:223], v28 offset:13312
    v_mfma_f32_32x32x16_bf16 v[160:175], v[200:203], v[228:231], v[160:175]
    v_mfma_f32_32x32x16_bf16 v[112:127], v[204:207], v[224:227], v[112:127]
    v_mfma_f32_32x32x16_bf16 v[176:191], v[204:207], v[228:231], v[176:191]
    s_waitcnt lgkmcnt(0)
    s_barrier
    v_mfma_f32_32x32x16_bf16 v[64:79], v[208:211], v[232:235], v[64:79]
    v_add_u32 v25, 0, v20
    v_add_u32 v26, 0, v21
    v_add_u32 v27, 0, v22
    v_mfma_f32_32x32x16_bf16 v[128:143], v[208:211], v[236:239], v[128:143]
    v_add_u32 v28, 0, v23
    v_add_u32 v29, 0, v24
    ds_read_b128 v[224:227], v29 offset:0
    v_mfma_f32_32x32x16_bf16 v[80:95], v[212:215], v[232:235], v[80:95]
    ds_read_b128 v[228:231], v29 offset:16384
    ds_read_b64_tr_b16 v[192:193], v25 offset:0
    ds_read_b64_tr_b16 v[194:195], v25 offset:1024
    v_mfma_f32_32x32x16_bf16 v[144:159], v[212:215], v[236:239], v[144:159]
    ds_read_b64_tr_b16 v[196:197], v26 offset:0
    ds_read_b64_tr_b16 v[198:199], v26 offset:1024
    ds_read_b64_tr_b16 v[200:201], v27 offset:0
    v_mfma_f32_32x32x16_bf16 v[96:111], v[216:219], v[232:235], v[96:111]
    ds_read_b64_tr_b16 v[202:203], v27 offset:1024
    ds_read_b64_tr_b16 v[204:205], v28 offset:0
    ds_read_b64_tr_b16 v[206:207], v28 offset:1024
    v_mfma_f32_32x32x16_bf16 v[160:175], v[216:219], v[236:239], v[160:175]
    v_mfma_f32_32x32x16_bf16 v[112:127], v[220:223], v[232:235], v[112:127]
    v_mfma_f32_32x32x16_bf16 v[176:191], v[220:223], v[236:239], v[176:191]
    s_waitcnt lgkmcnt(0)
    v_mfma_f32_32x32x16_bf16 v[64:79], v[192:195], v[224:227], v[64:79]
    ds_read_b128 v[232:235], v29 offset:1024
    ds_read_b128 v[236:239], v29 offset:17408
    v_mfma_f32_32x32x16_bf16 v[128:143], v[192:195], v[228:231], v[128:143]
    ds_read_b64_tr_b16 v[208:209], v25 offset:4096
    ds_read_b64_tr_b16 v[210:211], v25 offset:5120
    v_mfma_f32_32x32x16_bf16 v[80:95], v[196:199], v[224:227], v[80:95]
    ds_read_b64_tr_b16 v[212:213], v26 offset:4096
    ds_read_b64_tr_b16 v[214:215], v26 offset:5120
    v_mfma_f32_32x32x16_bf16 v[144:159], v[196:199], v[228:231], v[144:159]
    ds_read_b64_tr_b16 v[216:217], v27 offset:4096
    ds_read_b64_tr_b16 v[218:219], v27 offset:5120
    v_mfma_f32_32x32x16_bf16 v[96:111], v[200:203], v[224:227], v[96:111]
    ds_read_b64_tr_b16 v[220:221], v28 offset:4096
    ds_read_b64_tr_b16 v[222:223], v28 offset:5120
    v_mfma_f32_32x32x16_bf16 v[160:175], v[200:203], v[228:231], v[160:175]
    v_mfma_f32_32x32x16_bf16 v[112:127], v[204:207], v[224:227], v[112:127]
    v_mfma_f32_32x32x16_bf16 v[176:191], v[204:207], v[228:231], v[176:191]
    s_waitcnt lgkmcnt(0)
    v_mfma_f32_32x32x16_bf16 v[64:79], v[208:211], v[232:235], v[64:79]
    ds_read_b128 v[224:227], v29 offset:2048
    ds_read_b128 v[228:231], v29 offset:18432
    v_mfma_f32_32x32x16_bf16 v[128:143], v[208:211], v[236:239], v[128:143]
    ds_read_b64_tr_b16 v[192:193], v25 offset:8192
    ds_read_b64_tr_b16 v[194:195], v25 offset:9216
    v_mfma_f32_32x32x16_bf16 v[80:95], v[212:215], v[232:235], v[80:95]
    ds_read_b64_tr_b16 v[196:197], v26 offset:8192
    ds_read_b64_tr_b16 v[198:199], v26 offset:9216
    v_mfma_f32_32x32x16_bf16 v[144:159], v[212:215], v[236:239], v[144:159]
    ds_read_b64_tr_b16 v[200:201], v27 offset:8192
    ds_read_b64_tr_b16 v[202:203], v27 offset:9216
    v_mfma_f32_32x32x16_bf16 v[96:111], v[216:219], v[232:235], v[96:111]
    ds_read_b64_tr_b16 v[204:205], v28 offset:8192
    ds_read_b64_tr_b16 v[206:207], v28 offset:9216
    v_mfma_f32_32x32x16_bf16 v[160:175], v[216:219], v[236:239], v[160:175]
    v_mfma_f32_32x32x16_bf16 v[112:127], v[220:223], v[232:235], v[112:127]
    v_mfma_f32_32x32x16_bf16 v[176:191], v[220:223], v[236:239], v[176:191]
    s_waitcnt lgkmcnt(0)
    v_mfma_f32_32x32x16_bf16 v[64:79], v[192:195], v[224:227], v[64:79]
    ds_read_b128 v[232:235], v29 offset:3072
    ds_read_b128 v[236:239], v29 offset:19456
    v_mfma_f32_32x32x16_bf16 v[128:143], v[192:195], v[228:231], v[128:143]
    ds_read_b64_tr_b16 v[208:209], v25 offset:12288
    ds_read_b64_tr_b16 v[210:211], v25 offset:13312
    v_mfma_f32_32x32x16_bf16 v[80:95], v[196:199], v[224:227], v[80:95]
    ds_read_b64_tr_b16 v[212:213], v26 offset:12288
    ds_read_b64_tr_b16 v[214:215], v26 offset:13312
    v_mfma_f32_32x32x16_bf16 v[144:159], v[196:199], v[228:231], v[144:159]
    ds_read_b64_tr_b16 v[216:217], v27 offset:12288
    ds_read_b64_tr_b16 v[218:219], v27 offset:13312
    v_mfma_f32_32x32x16_bf16 v[96:111], v[200:203], v[224:227], v[96:111]
    ds_read_b64_tr_b16 v[220:221], v28 offset:12288
    ds_read_b64_tr_b16 v[222:223], v28 offset:13312
    v_mfma_f32_32x32x16_bf16 v[160:175], v[200:203], v[228:231], v[160:175]
    v_mfma_f32_32x32x16_bf16 v[112:127], v[204:207], v[224:227], v[112:127]
    v_mfma_f32_32x32x16_bf16 v[176:191], v[204:207], v[228:231], v[176:191]
    s_waitcnt lgkmcnt(0)
    s_barrier
    v_mfma_f32_32x32x16_bf16 v[64:79], v[208:211], v[232:235], v[64:79]
    v_add_u32 v25, 49152, v20
    v_add_u32 v26, 49152, v21
    v_add_u32 v27, 49152, v22
    v_mfma_f32_32x32x16_bf16 v[128:143], v[208:211], v[236:239], v[128:143]
    v_add_u32 v28, 49152, v23
    v_add_u32 v29, 49152, v24
    ds_read_b128 v[224:227], v29 offset:0
    v_mfma_f32_32x32x16_bf16 v[80:95], v[212:215], v[232:235], v[80:95]
    ds_read_b128 v[228:231], v29 offset:16384
    ds_read_b64_tr_b16 v[192:193], v25 offset:0
    ds_read_b64_tr_b16 v[194:195], v25 offset:1024
    v_mfma_f32_32x32x16_bf16 v[144:159], v[212:215], v[236:239], v[144:159]
    ds_read_b64_tr_b16 v[196:197], v26 offset:0
    ds_read_b64_tr_b16 v[198:199], v26 offset:1024
    ds_read_b64_tr_b16 v[200:201], v27 offset:0
    v_mfma_f32_32x32x16_bf16 v[96:111], v[216:219], v[232:235], v[96:111]
    ds_read_b64_tr_b16 v[202:203], v27 offset:1024
    ds_read_b64_tr_b16 v[204:205], v28 offset:0
    ds_read_b64_tr_b16 v[206:207], v28 offset:1024
    v_mfma_f32_32x32x16_bf16 v[160:175], v[216:219], v[236:239], v[160:175]
    v_mfma_f32_32x32x16_bf16 v[112:127], v[220:223], v[232:235], v[112:127]
    v_mfma_f32_32x32x16_bf16 v[176:191], v[220:223], v[236:239], v[176:191]
    s_waitcnt lgkmcnt(0)
    v_mfma_f32_32x32x16_bf16 v[64:79], v[192:195], v[224:227], v[64:79]
    ds_read_b128 v[232:235], v29 offset:1024
    ds_read_b128 v[236:239], v29 offset:17408
    v_mfma_f32_32x32x16_bf16 v[128:143], v[192:195], v[228:231], v[128:143]
    ds_read_b64_tr_b16 v[208:209], v25 offset:4096
    ds_read_b64_tr_b16 v[210:211], v25 offset:5120
    v_mfma_f32_32x32x16_bf16 v[80:95], v[196:199], v[224:227], v[80:95]
    ds_read_b64_tr_b16 v[212:213], v26 offset:4096
    ds_read_b64_tr_b16 v[214:215], v26 offset:5120
    v_mfma_f32_32x32x16_bf16 v[144:159], v[196:199], v[228:231], v[144:159]
    ds_read_b64_tr_b16 v[216:217], v27 offset:4096
    ds_read_b64_tr_b16 v[218:219], v27 offset:5120
    v_mfma_f32_32x32x16_bf16 v[96:111], v[200:203], v[224:227], v[96:111]
    ds_read_b64_tr_b16 v[220:221], v28 offset:4096
    ds_read_b64_tr_b16 v[222:223], v28 offset:5120
    v_mfma_f32_32x32x16_bf16 v[160:175], v[200:203], v[228:231], v[160:175]
    v_mfma_f32_32x32x16_bf16 v[112:127], v[204:207], v[224:227], v[112:127]
    v_mfma_f32_32x32x16_bf16 v[176:191], v[204:207], v[228:231], v[176:191]
    s_waitcnt lgkmcnt(0)
    v_mfma_f32_32x32x16_bf16 v[64:79], v[208:211], v[232:235], v[64:79]
    ds_read_b128 v[224:227], v29 offset:2048
    ds_read_b128 v[228:231], v29 offset:18432
    v_mfma_f32_32x32x16_bf16 v[128:143], v[208:211], v[236:239], v[128:143]
    ds_read_b64_tr_b16 v[192:193], v25 offset:8192
    ds_read_b64_tr_b16 v[194:195], v25 offset:9216
    v_mfma_f32_32x32x16_bf16 v[80:95], v[212:215], v[232:235], v[80:95]
    ds_read_b64_tr_b16 v[196:197], v26 offset:8192
    ds_read_b64_tr_b16 v[198:199], v26 offset:9216
    v_mfma_f32_32x32x16_bf16 v[144:159], v[212:215], v[236:239], v[144:159]
    ds_read_b64_tr_b16 v[200:201], v27 offset:8192
    ds_read_b64_tr_b16 v[202:203], v27 offset:9216
    v_mfma_f32_32x32x16_bf16 v[96:111], v[216:219], v[232:235], v[96:111]
    ds_read_b64_tr_b16 v[204:205], v28 offset:8192
    ds_read_b64_tr_b16 v[206:207], v28 offset:9216
    v_mfma_f32_32x32x16_bf16 v[160:175], v[216:219], v[236:239], v[160:175]
    v_mfma_f32_32x32x16_bf16 v[112:127], v[220:223], v[232:235], v[112:127]
    v_mfma_f32_32x32x16_bf16 v[176:191], v[220:223], v[236:239], v[176:191]
    s_waitcnt lgkmcnt(0)
    v_mfma_f32_32x32x16_bf16 v[64:79], v[192:195], v[224:227], v[64:79]
    ds_read_b128 v[232:235], v29 offset:3072
    ds_read_b128 v[236:239], v29 offset:19456
    v_mfma_f32_32x32x16_bf16 v[128:143], v[192:195], v[228:231], v[128:143]
    ds_read_b64_tr_b16 v[208:209], v25 offset:12288
    ds_read_b64_tr_b16 v[210:211], v25 offset:13312
    v_mfma_f32_32x32x16_bf16 v[80:95], v[196:199], v[224:227], v[80:95]
    ds_read_b64_tr_b16 v[212:213], v26 offset:12288
    ds_read_b64_tr_b16 v[214:215], v26 offset:13312
    v_mfma_f32_32x32x16_bf16 v[144:159], v[196:199], v[228:231], v[144:159]
    ds_read_b64_tr_b16 v[216:217], v27 offset:12288
    ds_read_b64_tr_b16 v[218:219], v27 offset:13312
    v_mfma_f32_32x32x16_bf16 v[96:111], v[200:203], v[224:227], v[96:111]
    ds_read_b64_tr_b16 v[220:221], v28 offset:12288
    ds_read_b64_tr_b16 v[222:223], v28 offset:13312
    v_mfma_f32_32x32x16_bf16 v[160:175], v[200:203], v[228:231], v[160:175]
    v_mfma_f32_32x32x16_bf16 v[112:127], v[204:207], v[224:227], v[112:127]
    v_mfma_f32_32x32x16_bf16 v[176:191], v[204:207], v[228:231], v[176:191]
    s_waitcnt lgkmcnt(0)
    v_mfma_f32_32x32x16_bf16 v[64:79], v[208:211], v[232:235], v[64:79]
    v_mfma_f32_32x32x16_bf16 v[128:143], v[208:211], v[236:239], v[128:143]
    v_mfma_f32_32x32x16_bf16 v[80:95], v[212:215], v[232:235], v[80:95]
    v_mfma_f32_32x32x16_bf16 v[144:159], v[212:215], v[236:239], v[144:159]
    v_mfma_f32_32x32x16_bf16 v[96:111], v[216:219], v[232:235], v[96:111]
    v_mfma_f32_32x32x16_bf16 v[160:175], v[216:219], v[236:239], v[160:175]
    v_mfma_f32_32x32x16_bf16 v[112:127], v[220:223], v[232:235], v[112:127]
    v_mfma_f32_32x32x16_bf16 v[176:191], v[220:223], v[236:239], v[176:191]
    s_nop 15
    v_cvt_pk_bf16_f32 v224, v128, v129
    v_cvt_pk_bf16_f32 v225, v130, v131
    v_cvt_pk_bf16_f32 v226, v132, v133
    v_cvt_pk_bf16_f32 v227, v134, v135
    v_cvt_pk_bf16_f32 v228, v136, v137
    v_cvt_pk_bf16_f32 v229, v138, v139
    v_cvt_pk_bf16_f32 v230, v140, v141
    v_cvt_pk_bf16_f32 v231, v142, v143
    v_cvt_pk_bf16_f32 v232, v144, v145
    v_cvt_pk_bf16_f32 v233, v146, v147
    v_cvt_pk_bf16_f32 v234, v148, v149
    v_cvt_pk_bf16_f32 v235, v150, v151
    v_cvt_pk_bf16_f32 v236, v152, v153
    v_cvt_pk_bf16_f32 v237, v154, v155
    v_cvt_pk_bf16_f32 v238, v156, v157
    v_cvt_pk_bf16_f32 v239, v158, v159
    v_cvt_pk_bf16_f32 v240, v160, v161
    v_cvt_pk_bf16_f32 v241, v162, v163
    v_cvt_pk_bf16_f32 v242, v164, v165
    v_cvt_pk_bf16_f32 v243, v166, v167
    v_cvt_pk_bf16_f32 v244, v168, v169
    v_cvt_pk_bf16_f32 v245, v170, v171
    v_cvt_pk_bf16_f32 v246, v172, v173
    v_cvt_pk_bf16_f32 v247, v174, v175
    v_cvt_pk_bf16_f32 v248, v176, v177
    v_cvt_pk_bf16_f32 v249, v178, v179
    v_cvt_pk_bf16_f32 v250, v180, v181
    v_cvt_pk_bf16_f32 v251, v182, v183
    v_cvt_pk_bf16_f32 v252, v184, v185
    v_cvt_pk_bf16_f32 v253, v186, v187
    v_cvt_pk_bf16_f32 v254, v188, v189
    v_cvt_pk_bf16_f32 v255, v190, v191
    s_barrier
    s_mov_b32 s27, 98304
    s_mov_b32 s26, 131072
    v_add_u32 v2, 98304, v1
    ds_read_b128 v[128:131], v2 offset:0
    ds_read_b128 v[132:135], v2 offset:1024
    ds_read_b128 v[136:139], v2 offset:2048
    ds_read_b128 v[140:143], v2 offset:3072
    ds_read_b128 v[144:147], v2 offset:4096
    ds_read_b128 v[148:151], v2 offset:5120
    ds_read_b128 v[152:155], v2 offset:6144
    ds_read_b128 v[156:159], v2 offset:7168
    v_cvt_pk_bf16_f32 v192, v64, v65
    v_cvt_pk_bf16_f32 v193, v66, v67
    v_cvt_pk_bf16_f32 v194, v68, v69
    v_cvt_pk_bf16_f32 v195, v70, v71
    v_cvt_pk_bf16_f32 v196, v72, v73
    v_cvt_pk_bf16_f32 v197, v74, v75
    v_cvt_pk_bf16_f32 v198, v76, v77
    v_cvt_pk_bf16_f32 v199, v78, v79
    v_cvt_pk_bf16_f32 v200, v80, v81
    v_cvt_pk_bf16_f32 v201, v82, v83
    v_cvt_pk_bf16_f32 v202, v84, v85
    v_cvt_pk_bf16_f32 v203, v86, v87
    v_cvt_pk_bf16_f32 v204, v88, v89
    v_cvt_pk_bf16_f32 v205, v90, v91
    v_cvt_pk_bf16_f32 v206, v92, v93
    v_cvt_pk_bf16_f32 v207, v94, v95
    v_cvt_pk_bf16_f32 v208, v96, v97
    v_cvt_pk_bf16_f32 v209, v98, v99
    v_cvt_pk_bf16_f32 v210, v100, v101
    v_cvt_pk_bf16_f32 v211, v102, v103
    v_cvt_pk_bf16_f32 v212, v104, v105
    v_cvt_pk_bf16_f32 v213, v106, v107
    v_cvt_pk_bf16_f32 v214, v108, v109
    v_cvt_pk_bf16_f32 v215, v110, v111
    v_cvt_pk_bf16_f32 v216, v112, v113
    v_cvt_pk_bf16_f32 v217, v114, v115
    v_cvt_pk_bf16_f32 v218, v116, v117
    v_cvt_pk_bf16_f32 v219, v118, v119
    v_cvt_pk_bf16_f32 v220, v120, v121
    v_cvt_pk_bf16_f32 v221, v122, v123
    v_cvt_pk_bf16_f32 v222, v124, v125
    v_cvt_pk_bf16_f32 v223, v126, v127
    v_mov_b32 v10, 0
    v_mov_b32 v11, 0
    v_mov_b32 v12, 0
    v_mov_b32 v13, 0
    s_waitcnt lgkmcnt(0)
    v_mfma_f32_32x32x16_bf16 v[16:31], v[128:131], v[192:195], 0
    ds_read_b128 v[128:131], v2 offset:8192
    v_mfma_f32_32x32x16_bf16 v[16:31], v[132:135], v[196:199], v[16:31]
    ds_read_b128 v[132:135], v2 offset:9216
    v_mfma_f32_32x32x16_bf16 v[16:31], v[136:139], v[200:203], v[16:31]
    ds_read_b128 v[136:139], v2 offset:10240
    v_mfma_f32_32x32x16_bf16 v[16:31], v[140:143], v[204:207], v[16:31]
    ds_read_b128 v[140:143], v2 offset:11264
    v_mfma_f32_32x32x16_bf16 v[16:31], v[144:147], v[208:211], v[16:31]
    ds_read_b128 v[144:147], v2 offset:12288
    v_mfma_f32_32x32x16_bf16 v[16:31], v[148:151], v[212:215], v[16:31]
    ds_read_b128 v[148:151], v2 offset:13312
    v_mfma_f32_32x32x16_bf16 v[16:31], v[152:155], v[216:219], v[16:31]
    ds_read_b128 v[152:155], v2 offset:14336
    v_mfma_f32_32x32x16_bf16 v[16:31], v[156:159], v[220:223], v[16:31]
    ds_read_b128 v[156:159], v2 offset:15360
    s_nop 15
    v_mov_b32 v9, 0x53800000
    v_mov_b32 v14, 0
    s_barrier
    v_add_u32 v2, s26, v1
    v_add_u32 v3, s27, v1
    s_mov_b32 s27, s26
    s_add_u32 s26, s26, 32768
    s_cmp_eq_u32 s26, 163840
    s_cselect_b32 s26, 0, s26
    s_lshl_b32 s38, s22, 7
    s_sub_u32 s38, s38, 0
    v_add_u32 v6, s38, v7
    s_waitcnt lgkmcnt(0)
    v_mfma_f32_32x32x16_bf16 v[32:47], v[128:131], v[192:195], 0
    ds_read_b128 v[128:131], v2 offset:0
    v_cmp_ge_i32 s[48:49], v6, 1
    v_cmp_ge_i32 s[46:47], v6, 0
    s_nop 1
    v_cndmask_b32 v16, v8, v16, s[46:47]
    v_exp_f32 v16, v16
    ds_read_b128 v[160:163], v3 offset:16384
    v_cmp_ge_i32 s[46:47], v6, 2
    v_cndmask_b32 v17, v8, v17, s[48:49]
    v_exp_f32 v17, v17
    v_add_f32 v10, v10, v16
    v_mfma_f32_32x32x16_bf16 v[32:47], v[132:135], v[196:199], v[32:47]
    ds_read_b128 v[132:135], v2 offset:1024
    v_cmp_ge_i32 s[48:49], v6, 3
    v_cndmask_b32 v18, v8, v18, s[46:47]
    v_exp_f32 v18, v18
    v_add_f32 v11, v11, v17
    v_cvt_pk_bf16_f32 v48, v16, v17
    ds_read_b128 v[168:171], v3 offset:20480
    v_cmp_ge_i32 s[46:47], v6, 8
    v_cndmask_b32 v19, v8, v19, s[48:49]
    v_exp_f32 v19, v19
    v_add_f32 v10, v10, v18
    v_mfma_f32_32x32x16_bf16 v[32:47], v[136:139], v[200:203], v[32:47]
    ds_read_b128 v[136:139], v2 offset:2048
    v_cmp_ge_i32 s[48:49], v6, 9
    v_cndmask_b32 v20, v8, v20, s[46:47]
    v_exp_f32 v20, v20
    v_add_f32 v11, v11, v19
    v_cvt_pk_bf16_f32 v49, v18, v19
    v_mfma_f32_32x32x16_bf16 v[32:47], v[140:143], v[204:207], v[32:47]
    ds_read_b128 v[140:143], v2 offset:3072
    v_cmp_ge_i32 s[46:47], v6, 10
    v_cndmask_b32 v21, v8, v21, s[48:49]
    v_exp_f32 v21, v21
    v_add_f32 v10, v10, v20
    ds_read_b128 v[176:179], v3 offset:24576
    v_cmp_ge_i32 s[48:49], v6, 11
    v_cndmask_b32 v22, v8, v22, s[46:47]
    v_exp_f32 v22, v22
    v_add_f32 v11, v11, v21
    v_cvt_pk_bf16_f32 v50, v20, v21
    v_mfma_f32_32x32x16_bf16 v[32:47], v[144:147], v[208:211], v[32:47]
    ds_read_b128 v[144:147], v2 offset:4096
    v_cmp_ge_i32 s[46:47], v6, 16
    v_cndmask_b32 v23, v8, v23, s[48:49]
    v_exp_f32 v23, v23
    v_add_f32 v10, v10, v22
    s_waitcnt lgkmcnt(0)
    v_mfma_f32_32x32x16_bf16 v[32:47], v[148:151], v[212:215], v[32:47]
    ds_read_b128 v[148:151], v2 offset:5120
    v_cmp_ge_i32 s[48:49], v6, 17
    v_cndmask_b32 v24, v8, v24, s[46:47]
    v_exp_f32 v24, v24
    v_add_f32 v11, v11, v23
    v_cvt_pk_bf16_f32 v51, v22, v23
    ds_read_b128 v[184:187], v3 offset:28672
    v_cmp_ge_i32 s[46:47], v6, 18
    v_cndmask_b32 v25, v8, v25, s[48:49]
    v_exp_f32 v25, v25
    v_add_f32 v10, v10, v24
    v_mfma_f32_32x32x16_bf16 v[32:47], v[152:155], v[216:219], v[32:47]
    ds_read_b128 v[152:155], v2 offset:6144
    v_cmp_ge_i32 s[48:49], v6, 19
    v_cndmask_b32 v26, v8, v26, s[46:47]
    v_exp_f32 v26, v26
    v_add_f32 v11, v11, v25
    v_cvt_pk_bf16_f32 v52, v24, v25
    v_mfma_f32_32x32x16_bf16 v[32:47], v[156:159], v[220:223], v[32:47]
    ds_read_b128 v[156:159], v2 offset:7168
    v_cmp_ge_i32 s[46:47], v6, 24
    v_cndmask_b32 v27, v8, v27, s[48:49]
    v_exp_f32 v27, v27
    v_add_f32 v10, v10, v26
    ds_read_b128 v[164:167], v3 offset:17408
    v_cmp_ge_i32 s[48:49], v6, 25
    v_cndmask_b32 v28, v8, v28, s[46:47]
    v_exp_f32 v28, v28
    v_add_f32 v11, v11, v27
    v_cvt_pk_bf16_f32 v53, v26, v27
    ds_read_b128 v[172:175], v3 offset:21504
    v_cmp_ge_i32 s[46:47], v6, 26
    v_cndmask_b32 v29, v8, v29, s[48:49]
    v_exp_f32 v29, v29
    v_add_f32 v10, v10, v28
    ds_read_b128 v[180:183], v3 offset:25600
    v_cmp_ge_i32 s[48:49], v6, 27
    v_cndmask_b32 v30, v8, v30, s[46:47]
    v_exp_f32 v30, v30
    v_add_f32 v11, v11, v29
    v_cvt_pk_bf16_f32 v54, v28, v29
    ds_read_b128 v[188:191], v3 offset:29696
    v_cndmask_b32 v31, v8, v31, s[48:49]
    v_exp_f32 v31, v31
    v_add_f32 v10, v10, v30
    s_nop 0
    v_add_f32 v11, v11, v31
    v_cvt_pk_bf16_f32 v55, v30, v31
    s_lshl_b32 s38, s22, 7
    s_sub_u32 s38, s38, 32
    v_add_u32 v6, s38, v7
    s_waitcnt lgkmcnt(0)
    v_mfma_f32_32x32x16_bf16 v[16:31], v[128:131], v[192:195], 0
    ds_read_b128 v[128:131], v2 offset:8192
    v_cmp_ge_i32 s[48:49], v6, 1
    v_cmp_ge_i32 s[46:47], v6, 0
    s_nop 1
    v_cndmask_b32 v32, v8, v32, s[46:47]
    v_exp_f32 v32, v32
    v_mfma_f32_32x32x16_bf16 v[64:79], v[160:163], v[48:51], 0
    ds_read_b128 v[160:163], v3 offset:18432
    v_cmp_ge_i32 s[46:47], v6, 2
    v_cndmask_b32 v33, v8, v33, s[48:49]
    v_exp_f32 v33, v33
    v_add_f32 v10, v10, v32
    v_mfma_f32_32x32x16_bf16 v[16:31], v[132:135], v[196:199], v[16:31]
    ds_read_b128 v[132:135], v2 offset:9216
    v_cmp_ge_i32 s[48:49], v6, 3
    v_cndmask_b32 v34, v8, v34, s[46:47]
    v_exp_f32 v34, v34
    v_add_f32 v11, v11, v33
    v_cvt_pk_bf16_f32 v56, v32, v33
    v_mfma_f32_32x32x16_bf16 v[80:95], v[168:171], v[48:51], 0
    ds_read_b128 v[168:171], v3 offset:22528
    v_cmp_ge_i32 s[46:47], v6, 8
    v_cndmask_b32 v35, v8, v35, s[48:49]
    v_exp_f32 v35, v35
    v_add_f32 v10, v10, v34
    v_mfma_f32_32x32x16_bf16 v[16:31], v[136:139], v[200:203], v[16:31]
    ds_read_b128 v[136:139], v2 offset:10240
    v_cmp_ge_i32 s[48:49], v6, 9
    v_cndmask_b32 v36, v8, v36, s[46:47]
    v_exp_f32 v36, v36
    v_add_f32 v11, v11, v35
    v_cvt_pk_bf16_f32 v57, v34, v35
    v_mfma_f32_32x32x16_bf16 v[16:31], v[140:143], v[204:207], v[16:31]
    ds_read_b128 v[140:143], v2 offset:11264
    v_cmp_ge_i32 s[46:47], v6, 10
    v_cndmask_b32 v37, v8, v37, s[48:49]
    v_exp_f32 v37, v37
    v_add_f32 v10, v10, v36
    v_mfma_f32_32x32x16_bf16 v[96:111], v[176:179], v[48:51], 0
    ds_read_b128 v[176:179], v3 offset:26624
    v_cmp_ge_i32 s[48:49], v6, 11
    v_cndmask_b32 v38, v8, v38, s[46:47]
    v_exp_f32 v38, v38
    v_add_f32 v11, v11, v37
    v_cvt_pk_bf16_f32 v58, v36, v37
    v_mfma_f32_32x32x16_bf16 v[16:31], v[144:147], v[208:211], v[16:31]
    ds_read_b128 v[144:147], v2 offset:12288
    v_cmp_ge_i32 s[46:47], v6, 16
    v_cndmask_b32 v39, v8, v39, s[48:49]
    v_exp_f32 v39, v39
    v_add_f32 v10, v10, v38
    s_waitcnt lgkmcnt(0)
    v_mfma_f32_32x32x16_bf16 v[16:31], v[148:151], v[212:215], v[16:31]
    ds_read_b128 v[148:151], v2 offset:13312
    v_cmp_ge_i32 s[48:49], v6, 17
    v_cndmask_b32 v40, v8, v40, s[46:47]
    v_exp_f32 v40, v40
    v_add_f32 v11, v11, v39
    v_cvt_pk_bf16_f32 v59, v38, v39
    v_mfma_f32_32x32x16_bf16 v[112:127], v[184:187], v[48:51], 0
    ds_read_b128 v[184:187], v3 offset:30720
    v_cmp_ge_i32 s[46:47], v6, 18
    v_cndmask_b32 v41, v8, v41, s[48:49]
    v_exp_f32 v41, v41
    v_add_f32 v10, v10, v40
    v_mfma_f32_32x32x16_bf16 v[16:31], v[152:155], v[216:219], v[16:31]
    ds_read_b128 v[152:155], v2 offset:14336
    v_cmp_ge_i32 s[48:49], v6, 19
    v_cndmask_b32 v42, v8, v42, s[46:47]
    v_exp_f32 v42, v42
    v_add_f32 v11, v11, v41
    v_cvt_pk_bf16_f32 v60, v40, v41
    v_mfma_f32_32x32x16_bf16 v[16:31], v[156:159], v[220:223], v[16:31]
    ds_read_b128 v[156:159], v2 offset:15360
    v_cmp_ge_i32 s[46:47], v6, 24
    v_cndmask_b32 v43, v8, v43, s[48:49]
    v_exp_f32 v43, v43
    v_add_f32 v10, v10, v42
    v_mfma_f32_32x32x16_bf16 v[64:79], v[164:167], v[52:55], v[64:79]
    ds_read_b128 v[164:167], v3 offset:19456
    v_cmp_ge_i32 s[48:49], v6, 25
    v_cndmask_b32 v44, v8, v44, s[46:47]
    v_exp_f32 v44, v44
    v_add_f32 v11, v11, v43
    v_cvt_pk_bf16_f32 v61, v42, v43
    v_mfma_f32_32x32x16_bf16 v[80:95], v[172:175], v[52:55], v[80:95]
    ds_read_b128 v[172:175], v3 offset:23552
    v_cmp_ge_i32 s[46:47], v6, 26
    v_cndmask_b32 v45, v8, v45, s[48:49]
    v_exp_f32 v45, v45
    v_add_f32 v10, v10, v44
    v_mfma_f32_32x32x16_bf16 v[96:111], v[180:183], v[52:55], v[96:111]
    ds_read_b128 v[180:183], v3 offset:27648
    v_cmp_ge_i32 s[48:49], v6, 27
    v_cndmask_b32 v46, v8, v46, s[46:47]
    v_exp_f32 v46, v46
    v_add_f32 v11, v11, v45
    v_cvt_pk_bf16_f32 v62, v44, v45
    v_mfma_f32_32x32x16_bf16 v[112:127], v[188:191], v[52:55], v[112:127]
    ds_read_b128 v[188:191], v3 offset:31744
    v_cndmask_b32 v47, v8, v47, s[48:49]
    v_exp_f32 v47, v47
    v_add_f32 v10, v10, v46
    s_nop 0
    v_add_f32 v11, v11, v47
    v_cvt_pk_bf16_f32 v63, v46, v47
    s_lshl_b32 s29, s22, 1
    s_cmp_eq_u32 s29, 0
    s_cbranch_scc1 at_A_last
    s_sub_u32 s29, s29, 1
at_A_loop:
    s_barrier
    v_add_u32 v2, s26, v1
    v_add_u32 v3, s27, v1
    s_mov_b32 s27, s26
    s_add_u32 s26, s26, 32768
    s_cmp_eq_u32 s26, 163840
    s_cselect_b32 s26, 0, s26
    s_waitcnt lgkmcnt(8)
    v_mfma_f32_32x32x16_bf16 v[32:47], v[128:131], v[192:195], 0
    ds_read_b128 v[128:131], v2 offset:0
    v_exp_f32 v16, v16
    v_mfma_f32_32x32x16_bf16 v[64:79], v[160:163], v[56:59], v[64:79]
    ds_read_b128 v[160:163], v3 offset:16384
    v_exp_f32 v17, v17
    v_add_f32 v10, v10, v16
    v_mfma_f32_32x32x16_bf16 v[32:47], v[132:135], v[196:199], v[32:47]
    ds_read_b128 v[132:135], v2 offset:1024
    v_exp_f32 v18, v18
    v_add_f32 v11, v11, v17
    v_cvt_pk_bf16_f32 v48, v16, v17
    v_mfma_f32_32x32x16_bf16 v[80:95], v[168:171], v[56:59], v[80:95]
    ds_read_b128 v[168:171], v3 offset:20480
    v_exp_f32 v19, v19
    v_add_f32 v10, v10, v18
    v_mfma_f32_32x32x16_bf16 v[32:47], v[136:139], v[200:203], v[32:47]
    ds_read_b128 v[136:139], v2 offset:2048
    v_exp_f32 v20, v20
    v_add_f32 v11, v11, v19
    v_cvt_pk_bf16_f32 v49, v18, v19
    v_mfma_f32_32x32x16_bf16 v[32:47], v[140:143], v[204:207], v[32:47]
    ds_read_b128 v[140:143], v2 offset:3072
    v_exp_f32 v21, v21
    v_add_f32 v10, v10, v20
    v_mfma_f32_32x32x16_bf16 v[96:111], v[176:179], v[56:59], v[96:111]
    ds_read_b128 v[176:179], v3 offset:24576
    v_exp_f32 v22, v22
    v_add_f32 v11, v11, v21
    v_cvt_pk_bf16_f32 v50, v20, v21
    v_mfma_f32_32x32x16_bf16 v[32:47], v[144:147], v[208:211], v[32:47]
    ds_read_b128 v[144:147], v2 offset:4096
    v_exp_f32 v23, v23
    v_add_f32 v10, v10, v22
    s_waitcnt lgkmcnt(8)
    v_mfma_f32_32x32x16_bf16 v[32:47], v[148:151], v[212:215], v[32:47]
    ds_read_b128 v[148:151], v2 offset:5120
    v_exp_f32 v24, v24
    v_add_f32 v11, v11, v23
    v_cvt_pk_bf16_f32 v51, v22, v23
    v_mfma_f32_32x32x16_bf16 v[112:127], v[184:187], v[56:59], v[112:127]
    ds_read_b128 v[184:187], v3 offset:28672
    v_exp_f32 v25, v25
    v_add_f32 v10, v10, v24
    v_mfma_f32_32x32x16_bf16 v[32:47], v[152:155], v[216:219], v[32:47]
    ds_read_b128 v[152:155], v2 offset:6144
    v_exp_f32 v26, v26
    v_add_f32 v11, v11, v25
    v_cvt_pk_bf16_f32 v52, v24, v25
    v_mfma_f32_32x32x16_bf16 v[32:47], v[156:159], v[220:223], v[32:47]
    ds_read_b128 v[156:159], v2 offset:7168
    v_exp_f32 v27, v27
    v_add_f32 v10, v10, v26
    v_mfma_f32_32x32x16_bf16 v[64:79], v[164:167], v[60:63], v[64:79]
    ds_read_b128 v[164:167], v3 offset:17408
    v_exp_f32 v28, v28
    v_add_f32 v11, v11, v27
    v_cvt_pk_bf16_f32 v53, v26, v27
    v_mfma_f32_32x32x16_bf16 v[80:95], v[172:175], v[60:63], v[80:95]
    ds_read_b128 v[172:175], v3 offset:21504
    v_exp_f32 v29, v29
    v_add_f32 v10, v10, v28
    v_mfma_f32_32x32x16_bf16 v[96:111], v[180:183], v[60:63], v[96:111]
    ds_read_b128 v[180:183], v3 offset:25600
    v_exp_f32 v30, v30
    v_add_f32 v11, v11, v29
    v_cvt_pk_bf16_f32 v54, v28, v29
    v_mfma_f32_32x32x16_bf16 v[112:127], v[188:191], v[60:63], v[112:127]
    ds_read_b128 v[188:191], v3 offset:29696
    v_exp_f32 v31, v31
    v_add_f32 v10, v10, v30
    s_nop 0
    v_add_f32 v11, v11, v31
    v_cvt_pk_bf16_f32 v55, v30, v31
    s_waitcnt lgkmcnt(8)
    v_mfma_f32_32x32x16_bf16 v[16:31], v[128:131], v[192:195], 0
    ds_read_b128 v[128:131], v2 offset:8192
    v_exp_f32 v32, v32
    v_mfma_f32_32x32x16_bf16 v[64:79], v[160:163], v[48:51], v[64:79]
    ds_read_b128 v[160:163], v3 offset:18432
    v_exp_f32 v33, v33
    v_add_f32 v10, v10, v32
    v_mfma_f32_32x32x16_bf16 v[16:31], v[132:135], v[196:199], v[16:31]
    ds_read_b128 v[132:135], v2 offset:9216
    v_exp_f32 v34, v34
    v_add_f32 v11, v11, v33
    v_cvt_pk_bf16_f32 v56, v32, v33
    v_mfma_f32_32x32x16_bf16 v[80:95], v[168:171], v[48:51], v[80:95]
    ds_read_b128 v[168:171], v3 offset:22528
    v_exp_f32 v35, v35
    v_add_f32 v10, v10, v34
    v_mfma_f32_32x32x16_bf16 v[16:31], v[136:139], v[200:203], v[16:31]
    ds_read_b128 v[136:139], v2 offset:10240
    v_exp_f32 v36, v36
    v_add_f32 v11, v11, v35
    v_cvt_pk_bf16_f32 v57, v34, v35
    v_mfma_f32_32x32x16_bf16 v[16:31], v[140:143], v[204:207], v[16:31]
    ds_read_b128 v[140:143], v2 offset:11264
    v_exp_f32 v37, v37
    v_add_f32 v10, v10, v36
    v_mfma_f32_32x32x16_bf16 v[96:111], v[176:179], v[48:51], v[96:111]
    ds_read_b128 v[176:179], v3 offset:26624
    v_exp_f32 v38, v38
    v_add_f32 v11, v11, v37
    v_cvt_pk_bf16_f32 v58, v36, v37
    v_mfma_f32_32x32x16_bf16 v[16:31], v[144:147], v[208:211], v[16:31]
    ds_read_b128 v[144:147], v2 offset:12288
    v_exp_f32 v39, v39
    v_add_f32 v10, v10, v38
    s_waitcnt lgkmcnt(8)
    v_mfma_f32_32x32x16_bf16 v[16:31], v[148:151], v[212:215], v[16:31]
    ds_read_b128 v[148:151], v2 offset:13312
    v_exp_f32 v40, v40
    v_add_f32 v11, v11, v39
    v_cvt_pk_bf16_f32 v59, v38, v39
    v_mfma_f32_32x32x16_bf16 v[112:127], v[184:187], v[48:51], v[112:127]
    ds_read_b128 v[184:187], v3 offset:30720
    v_exp_f32 v41, v41
    v_add_f32 v10, v10, v40
    v_mfma_f32_32x32x16_bf16 v[16:31], v[152:155], v[216:219], v[16:31]
    ds_read_b128 v[152:155], v2 offset:14336
    v_exp_f32 v42, v42
    v_add_f32 v11, v11, v41
    v_cvt_pk_bf16_f32 v60, v40, v41
    v_mfma_f32_32x32x16_bf16 v[16:31], v[156:159], v[220:223], v[16:31]
    ds_read_b128 v[156:159], v2 offset:15360
    v_exp_f32 v43, v43
    v_add_f32 v10, v10, v42
    v_mfma_f32_32x32x16_bf16 v[64:79], v[164:167], v[52:55], v[64:79]
    ds_read_b128 v[164:167], v3 offset:19456
    v_exp_f32 v44, v44
    v_add_f32 v11, v11, v43
    v_cvt_pk_bf16_f32 v61, v42, v43
    v_mfma_f32_32x32x16_bf16 v[80:95], v[172:175], v[52:55], v[80:95]
    ds_read_b128 v[172:175], v3 offset:23552
    v_exp_f32 v45, v45
    v_add_f32 v10, v10, v44
    v_mfma_f32_32x32x16_bf16 v[96:111], v[180:183], v[52:55], v[96:111]
    ds_read_b128 v[180:183], v3 offset:27648
    v_exp_f32 v46, v46
    v_add_f32 v11, v11, v45
    v_cvt_pk_bf16_f32 v62, v44, v45
    v_mfma_f32_32x32x16_bf16 v[112:127], v[188:191], v[52:55], v[112:127]
    ds_read_b128 v[188:191], v3 offset:31744
    v_exp_f32 v47, v47
    v_add_f32 v10, v10, v46
    s_nop 0
    v_add_f32 v11, v11, v47
    v_cvt_pk_bf16_f32 v63, v46, v47
    s_sub_u32 s29, s29, 1
    s_cmp_lg_u32 s29, 0
    s_cbranch_scc1 at_A_loop
    s_barrier
    v_add_u32 v2, s26, v1
    v_add_u32 v3, s27, v1
    s_mov_b32 s27, s26
    s_add_u32 s26, s26, 32768
    s_cmp_eq_u32 s26, 163840
    s_cselect_b32 s26, 0, s26
    v_mov_b32 v6, v7
    s_waitcnt lgkmcnt(8)
    v_mfma_f32_32x32x16_bf16 v[32:47], v[128:131], v[192:195], 0
    ds_read_b128 v[128:131], v2 offset:0
    v_cmp_ge_i32 s[48:49], v6, 1
    v_cmp_ge_i32 s[46:47], v6, 0
    s_nop 1
    v_cndmask_b32 v16, v8, v16, s[46:47]
    v_exp_f32 v16, v16
    v_mfma_f32_32x32x16_bf16 v[64:79], v[160:163], v[56:59], v[64:79]
    ds_read_b128 v[160:163], v3 offset:16384
    v_cmp_ge_i32 s[46:47], v6, 2
    v_cndmask_b32 v17, v8, v17, s[48:49]
    v_exp_f32 v17, v17
    v_add_f32 v10, v10, v16
    v_mfma_f32_32x32x16_bf16 v[32:47], v[132:135], v[196:199], v[32:47]
    ds_read_b128 v[132:135], v2 offset:1024
    v_cmp_ge_i32 s[48:49], v6, 3
    v_cndmask_b32 v18, v8, v18, s[46:47]
    v_exp_f32 v18, v18
    v_add_f32 v11, v11, v17
    v_cvt_pk_bf16_f32 v48, v16, v17
    v_mfma_f32_32x32x16_bf16 v[80:95], v[168:171], v[56:59], v[80:95]
    ds_read_b128 v[168:171], v3 offset:20480
    v_cmp_ge_i32 s[46:47], v6, 8
    v_cndmask_b32 v19, v8, v19, s[48:49]
    v_exp_f32 v19, v19
    v_add_f32 v10, v10, v18
    v_mfma_f32_32x32x16_bf16 v[32:47], v[136:139], v[200:203], v[32:47]
    ds_read_b128 v[136:139], v2 offset:2048
    v_cmp_ge_i32 s[48:49], v6, 9
    v_cndmask_b32 v20, v8, v20, s[46:47]
    v_exp_f32 v20, v20
    v_add_f32 v11, v11, v19
    v_cvt_pk_bf16_f32 v49, v18, v19
    v_mfma_f32_32x32x16_bf16 v[32:47], v[140:143], v[204:207], v[32:47]
    ds_read_b128 v[140:143], v2 offset:3072
    v_cmp_ge_i32 s[46:47], v6, 10
    v_cndmask_b32 v21, v8, v21, s[48:49]
    v_exp_f32 v21, v21
    v_add_f32 v10, v10, v20
    v_mfma_f32_32x32x16_bf16 v[96:111], v[176:179], v[56:59], v[96:111]
    ds_read_b128 v[176:179], v3 offset:24576
    v_cmp_ge_i32 s[48:49], v6, 11
    v_cndmask_b32 v22, v8, v22, s[46:47]
    v_exp_f32 v22, v22
    v_add_f32 v11, v11, v21
    v_cvt_pk_bf16_f32 v50, v20, v21
    v_mfma_f32_32x32x16_bf16 v[32:47], v[144:147], v[208:211], v[32:47]
    ds_read_b128 v[144:147], v2 offset:4096
    v_cmp_ge_i32 s[46:47], v6, 16
    v_cndmask_b32 v23, v8, v23, s[48:49]
    v_exp_f32 v23, v23
    v_add_f32 v10, v10, v22
    s_waitcnt lgkmcnt(8)
    v_mfma_f32_32x32x16_bf16 v[32:47], v[148:151], v[212:215], v[32:47]
    ds_read_b128 v[148:151], v2 offset:5120
    v_cmp_ge_i32 s[48:49], v6, 17
    v_cndmask_b32 v24, v8, v24, s[46:47]
    v_exp_f32 v24, v24
    v_add_f32 v11, v11, v23
    v_cvt_pk_bf16_f32 v51, v22, v23
    v_mfma_f32_32x32x16_bf16 v[112:127], v[184:187], v[56:59], v[112:127]
    ds_read_b128 v[184:187], v3 offset:28672
    v_cmp_ge_i32 s[46:47], v6, 18
    v_cndmask_b32 v25, v8, v25, s[48:49]
    v_exp_f32 v25, v25
    v_add_f32 v10, v10, v24
    v_mfma_f32_32x32x16_bf16 v[32:47], v[152:155], v[216:219], v[32:47]
    ds_read_b128 v[152:155], v2 offset:6144
    v_cmp_ge_i32 s[48:49], v6, 19
    v_cndmask_b32 v26, v8, v26, s[46:47]
    v_exp_f32 v26, v26
    v_add_f32 v11, v11, v25
    v_cvt_pk_bf16_f32 v52, v24, v25
    v_mfma_f32_32x32x16_bf16 v[32:47], v[156:159], v[220:223], v[32:47]
    ds_read_b128 v[156:159], v2 offset:7168
    v_cmp_ge_i32 s[46:47], v6, 24
    v_cndmask_b32 v27, v8, v27, s[48:49]
    v_exp_f32 v27, v27
    v_add_f32 v10, v10, v26
    v_mfma_f32_32x32x16_bf16 v[64:79], v[164:167], v[60:63], v[64:79]
    ds_read_b128 v[164:167], v3 offset:17408
    v_cmp_ge_i32 s[48:49], v6, 25
    v_cndmask_b32 v28, v8, v28, s[46:47]
    v_exp_f32 v28, v28
    v_add_f32 v11, v11, v27
    v_cvt_pk_bf16_f32 v53, v26, v27
    v_mfma_f32_32x32x16_bf16 v[80:95], v[172:175], v[60:63], v[80:95]
    ds_read_b128 v[172:175], v3 offset:21504
    v_cmp_ge_i32 s[46:47], v6, 26
    v_cndmask_b32 v29, v8, v29, s[48:49]
    v_exp_f32 v29, v29
    v_add_f32 v10, v10, v28
    v_mfma_f32_32x32x16_bf16 v[96:111], v[180:183], v[60:63], v[96:111]
    ds_read_b128 v[180:183], v3 offset:25600
    v_cmp_ge_i32 s[48:49], v6, 27
    v_cndmask_b32 v30, v8, v30, s[46:47]
    v_exp_f32 v30, v30
    v_add_f32 v11, v11, v29
    v_cvt_pk_bf16_f32 v54, v28, v29
    v_mfma_f32_32x32x16_bf16 v[112:127], v[188:191], v[60:63], v[112:127]
    ds_read_b128 v[188:191], v3 offset:29696
    v_cndmask_b32 v31, v8, v31, s[48:49]
    v_exp_f32 v31, v31
    v_add_f32 v10, v10, v30
    s_nop 0
    v_add_f32 v11, v11, v31
    v_cvt_pk_bf16_f32 v55, v30, v31
    v_subrev_u32 v6, 32, v7
    s_waitcnt lgkmcnt(8)
    v_mfma_f32_32x32x16_bf16 v[16:31], v[128:131], v[192:195], 0
    ds_read_b128 v[128:131], v2 offset:8192
    v_cmp_ge_i32 s[48:49], v6, 1
    v_cmp_ge_i32 s[46:47], v6, 0
    s_nop 1
    v_cndmask_b32 v32, v8, v32, s[46:47]
    v_exp_f32 v32, v32
    v_mfma_f32_32x32x16_bf16 v[64:79], v[160:163], v[48:51], v[64:79]
    ds_read_b128 v[160:163], v3 offset:18432
    v_cmp_ge_i32 s[46:47], v6, 2
    v_cndmask_b32 v33, v8, v33, s[48:49]
    v_exp_f32 v33, v33
    v_add_f32 v10, v10, v32
    v_mfma_f32_32x32x16_bf16 v[16:31], v[132:135], v[196:199], v[16:31]
    ds_read_b128 v[132:135], v2 offset:9216
    v_cmp_ge_i32 s[48:49], v6, 3
    v_cndmask_b32 v34, v8, v34, s[46:47]
    v_exp_f32 v34, v34
    v_add_f32 v11, v11, v33
    v_cvt_pk_bf16_f32 v56, v32, v33
    v_mfma_f32_32x32x16_bf16 v[80:95], v[168:171], v[48:51], v[80:95]
    ds_read_b128 v[168:171], v3 offset:22528
    v_cmp_ge_i32 s[46:47], v6, 8
    v_cndmask_b32 v35, v8, v35, s[48:49]
    v_exp_f32 v35, v35
    v_add_f32 v10, v10, v34
    v_mfma_f32_32x32x16_bf16 v[16:31], v[136:139], v[200:203], v[16:31]
    ds_read_b128 v[136:139], v2 offset:10240
    v_cmp_ge_i32 s[48:49], v6, 9
    v_cndmask_b32 v36, v8, v36, s[46:47]
    v_exp_f32 v36, v36
    v_add_f32 v11, v11, v35
    v_cvt_pk_bf16_f32 v57, v34, v35
    v_mfma_f32_32x32x16_bf16 v[16:31], v[140:143], v[204:207], v[16:31]
    ds_read_b128 v[140:143], v2 offset:11264
    v_cmp_ge_i32 s[46:47], v6, 10
    v_cndmask_b32 v37, v8, v37, s[48:49]
    v_exp_f32 v37, v37
    v_add_f32 v10, v10, v36
    v_mfma_f32_32x32x16_bf16 v[96:111], v[176:179], v[48:51], v[96:111]
    ds_read_b128 v[176:179], v3 offset:26624
    v_cmp_ge_i32 s[48:49], v6, 11
    v_cndmask_b32 v38, v8, v38, s[46:47]
    v_exp_f32 v38, v38
    v_add_f32 v11, v11, v37
    v_cvt_pk_bf16_f32 v58, v36, v37
    v_mfma_f32_32x32x16_bf16 v[16:31], v[144:147], v[208:211], v[16:31]
    ds_read_b128 v[144:147], v2 offset:12288
    v_cmp_ge_i32 s[46:47], v6, 16
    v_cndmask_b32 v39, v8, v39, s[48:49]
    v_exp_f32 v39, v39
    v_add_f32 v10, v10, v38
    s_waitcnt lgkmcnt(8)
    v_mfma_f32_32x32x16_bf16 v[16:31], v[148:151], v[212:215], v[16:31]
    ds_read_b128 v[148:151], v2 offset:13312
    v_cmp_ge_i32 s[48:49], v6, 17
    v_cndmask_b32 v40, v8, v40, s[46:47]
    v_exp_f32 v40, v40
    v_add_f32 v11, v11, v39
    v_cvt_pk_bf16_f32 v59, v38, v39
    v_mfma_f32_32x32x16_bf16 v[112:127], v[184:187], v[48:51], v[112:127]
    ds_read_b128 v[184:187], v3 offset:30720
    v_cmp_ge_i32 s[46:47], v6, 18
    v_cndmask_b32 v41, v8, v41, s[48:49]
    v_exp_f32 v41, v41
    v_add_f32 v10, v10, v40
    v_mfma_f32_32x32x16_bf16 v[16:31], v[152:155], v[216:219], v[16:31]
    ds_read_b128 v[152:155], v2 offset:14336
    v_cmp_ge_i32 s[48:49], v6, 19
    v_cndmask_b32 v42, v8, v42, s[46:47]
    v_exp_f32 v42, v42
    v_add_f32 v11, v11, v41
    v_cvt_pk_bf16_f32 v60, v40, v41
    v_mfma_f32_32x32x16_bf16 v[16:31], v[156:159], v[220:223], v[16:31]
    ds_read_b128 v[156:159], v2 offset:15360
    v_cmp_ge_i32 s[46:47], v6, 24
    v_cndmask_b32 v43, v8, v43, s[48:49]
    v_exp_f32 v43, v43
    v_add_f32 v10, v10, v42
    v_mfma_f32_32x32x16_bf16 v[64:79], v[164:167], v[52:55], v[64:79]
    ds_read_b128 v[164:167], v3 offset:19456
    v_cmp_ge_i32 s[48:49], v6, 25
    v_cndmask_b32 v44, v8, v44, s[46:47]
    v_exp_f32 v44, v44
    v_add_f32 v11, v11, v43
    v_cvt_pk_bf16_f32 v61, v42, v43
    v_mfma_f32_32x32x16_bf16 v[80:95], v[172:175], v[52:55], v[80:95]
    ds_read_b128 v[172:175], v3 offset:23552
    v_cmp_ge_i32 s[46:47], v6, 26
    v_cndmask_b32 v45, v8, v45, s[48:49]
    v_exp_f32 v45, v45
    v_add_f32 v10, v10, v44
    v_mfma_f32_32x32x16_bf16 v[96:111], v[180:183], v[52:55], v[96:111]
    ds_read_b128 v[180:183], v3 offset:27648
    v_cmp_ge_i32 s[48:49], v6, 27
    v_cndmask_b32 v46, v8, v46, s[46:47]
    v_exp_f32 v46, v46
    v_add_f32 v11, v11, v45
    v_cvt_pk_bf16_f32 v62, v44, v45
    v_mfma_f32_32x32x16_bf16 v[112:127], v[188:191], v[52:55], v[112:127]
    ds_read_b128 v[188:191], v3 offset:31744
    v_cndmask_b32 v47, v8, v47, s[48:49]
    v_exp_f32 v47, v47
    v_add_f32 v10, v10, v46
    s_nop 0
    v_add_f32 v11, v11, v47
    v_cvt_pk_bf16_f32 v63, v46, v47
at_A_last:
    s_barrier
    v_add_u32 v2, s26, v1
    v_add_u32 v3, s27, v1
    s_mov_b32 s27, s26
    s_add_u32 s26, s26, 32768
    s_cmp_eq_u32 s26, 163840
    s_cselect_b32 s26, 0, s26
    v_subrev_u32 v6, 64, v7
    s_waitcnt lgkmcnt(8)
    v_mfma_f32_32x32x16_bf16 v[32:47], v[128:131], v[192:195], 0
    ds_read_b128 v[128:131], v2 offset:0
    v_cmp_ge_i32 s[48:49], v6, 1
    v_cmp_ge_i32 s[46:47], v6, 0
    s_nop 1
    v_cndmask_b32 v16, v8, v16, s[46:47]
    v_exp_f32 v16, v16
    v_mfma_f32_32x32x16_bf16 v[64:79], v[160:163], v[56:59], v[64:79]
    ds_read_b128 v[160:163], v3 offset:16384
    v_cmp_ge_i32 s[46:47], v6, 2
    v_cndmask_b32 v17, v8, v17, s[48:49]
    v_exp_f32 v17, v17
    v_add_f32 v10, v10, v16
    v_mfma_f32_32x32x16_bf16 v[32:47], v[132:135], v[196:199], v[32:47]
    ds_read_b128 v[132:135], v2 offset:1024
    v_cmp_ge_i32 s[48:49], v6, 3
    v_cndmask_b32 v18, v8, v18, s[46:47]
    v_exp_f32 v18, v18
    v_add_f32 v11, v11, v17
    v_cvt_pk_bf16_f32 v48, v16, v17
    v_mfma_f32_32x32x16_bf16 v[80:95], v[168:171], v[56:59], v[80:95]
    ds_read_b128 v[168:171], v3 offset:20480
    v_cmp_ge_i32 s[46:47], v6, 8
    v_cndmask_b32 v19, v8, v19, s[48:49]
    v_exp_f32 v19, v19
    v_add_f32 v10, v10, v18
    v_mfma_f32_32x32x16_bf16 v[32:47], v[136:139], v[200:203], v[32:47]
    ds_read_b128 v[136:139], v2 offset:2048
    v_cmp_ge_i32 s[48:49], v6, 9
    v_cndmask_b32 v20, v8, v20, s[46:47]
    v_exp_f32 v20, v20
    v_add_f32 v11, v11, v19
    v_cvt_pk_bf16_f32 v49, v18, v19
    v_mfma_f32_32x32x16_bf16 v[32:47], v[140:143], v[204:207], v[32:47]
    ds_read_b128 v[140:143], v2 offset:3072
    v_cmp_ge_i32 s[46:47], v6, 10
    v_cndmask_b32 v21, v8, v21, s[48:49]
    v_exp_f32 v21, v21
    v_add_f32 v10, v10, v20
    v_mfma_f32_32x32x16_bf16 v[96:111], v[176:179], v[56:59], v[96:111]
    ds_read_b128 v[176:179], v3 offset:24576
    v_cmp_ge_i32 s[48:49], v6, 11
    v_cndmask_b32 v22, v8, v22, s[46:47]
    v_exp_f32 v22, v22
    v_add_f32 v11, v11, v21
    v_cvt_pk_bf16_f32 v50, v20, v21
    v_mfma_f32_32x32x16_bf16 v[32:47], v[144:147], v[208:211], v[32:47]
    ds_read_b128 v[144:147], v2 offset:4096
    v_cmp_ge_i32 s[46:47], v6, 16
    v_cndmask_b32 v23, v8, v23, s[48:49]
    v_exp_f32 v23, v23
    v_add_f32 v10, v10, v22
    s_waitcnt lgkmcnt(8)
    v_mfma_f32_32x32x16_bf16 v[32:47], v[148:151], v[212:215], v[32:47]
    ds_read_b128 v[148:151], v2 offset:5120
    v_cmp_ge_i32 s[48:49], v6, 17
    v_cndmask_b32 v24, v8, v24, s[46:47]
    v_exp_f32 v24, v24
    v_add_f32 v11, v11, v23
    v_cvt_pk_bf16_f32 v51, v22, v23
    v_mfma_f32_32x32x16_bf16 v[112:127], v[184:187], v[56:59], v[112:127]
    ds_read_b128 v[184:187], v3 offset:28672
    v_cmp_ge_i32 s[46:47], v6, 18
    v_cndmask_b32 v25, v8, v25, s[48:49]
    v_exp_f32 v25, v25
    v_add_f32 v10, v10, v24
    v_mfma_f32_32x32x16_bf16 v[32:47], v[152:155], v[216:219], v[32:47]
    ds_read_b128 v[152:155], v2 offset:6144
    v_cmp_ge_i32 s[48:49], v6, 19
    v_cndmask_b32 v26, v8, v26, s[46:47]
    v_exp_f32 v26, v26
    v_add_f32 v11, v11, v25
    v_cvt_pk_bf16_f32 v52, v24, v25
    v_mfma_f32_32x32x16_bf16 v[32:47], v[156:159], v[220:223], v[32:47]
    ds_read_b128 v[156:159], v2 offset:7168
    v_cmp_ge_i32 s[46:47], v6, 24
    v_cndmask_b32 v27, v8, v27, s[48:49]
    v_exp_f32 v27, v27
    v_add_f32 v10, v10, v26
    v_mfma_f32_32x32x16_bf16 v[64:79], v[164:167], v[60:63], v[64:79]
    ds_read_b128 v[164:167], v3 offset:17408
    v_cmp_ge_i32 s[48:49], v6, 25
    v_cndmask_b32 v28, v8, v28, s[46:47]
    v_exp_f32 v28, v28
    v_add_f32 v11, v11, v27
    v_cvt_pk_bf16_f32 v53, v26, v27
    v_mfma_f32_32x32x16_bf16 v[80:95], v[172:175], v[60:63], v[80:95]
    ds_read_b128 v[172:175], v3 offset:21504
    v_cmp_ge_i32 s[46:47], v6, 26
    v_cndmask_b32 v29, v8, v29, s[48:49]
    v_exp_f32 v29, v29
    v_add_f32 v10, v10, v28
    v_mfma_f32_32x32x16_bf16 v[96:111], v[180:183], v[60:63], v[96:111]
    ds_read_b128 v[180:183], v3 offset:25600
    v_cmp_ge_i32 s[48:49], v6, 27
    v_cndmask_b32 v30, v8, v30, s[46:47]
    v_exp_f32 v30, v30
    v_add_f32 v11, v11, v29
    v_cvt_pk_bf16_f32 v54, v28, v29
    v_mfma_f32_32x32x16_bf16 v[112:127], v[188:191], v[60:63], v[112:127]
    ds_read_b128 v[188:191], v3 offset:29696
    v_cndmask_b32 v31, v8, v31, s[48:49]
    v_exp_f32 v31, v31
    v_add_f32 v10, v10, v30
    s_nop 0
    v_add_f32 v11, v11, v31
    v_cvt_pk_bf16_f32 v55, v30, v31
    v_subrev_u32 v6, 96, v7
    s_waitcnt lgkmcnt(8)
    v_mfma_f32_32x32x16_bf16 v[16:31], v[128:131], v[224:227], 0
    ds_read_b128 v[128:131], v2 offset:8192
    v_cmp_ge_i32 s[48:49], v6, 1
    v_cmp_ge_i32 s[46:47], v6, 0
    s_nop 1
    v_cndmask_b32 v32, v8, v32, s[46:47]
    v_exp_f32 v32, v32
    v_mfma_f32_32x32x16_bf16 v[64:79], v[160:163], v[48:51], v[64:79]
    ds_read_b128 v[160:163], v3 offset:18432
    v_cmp_ge_i32 s[46:47], v6, 2
    v_cndmask_b32 v33, v8, v33, s[48:49]
    v_exp_f32 v33, v33
    v_add_f32 v10, v10, v32
    v_mfma_f32_32x32x16_bf16 v[16:31], v[132:135], v[228:231], v[16:31]
    ds_read_b128 v[132:135], v2 offset:9216
    v_cmp_ge_i32 s[48:49], v6, 3
    v_cndmask_b32 v34, v8, v34, s[46:47]
    v_exp_f32 v34, v34
    v_add_f32 v11, v11, v33
    v_cvt_pk_bf16_f32 v56, v32, v33
    v_mfma_f32_32x32x16_bf16 v[80:95], v[168:171], v[48:51], v[80:95]
    ds_read_b128 v[168:171], v3 offset:22528
    v_cmp_ge_i32 s[46:47], v6, 8
    v_cndmask_b32 v35, v8, v35, s[48:49]
    v_exp_f32 v35, v35
    v_add_f32 v10, v10, v34
    v_mfma_f32_32x32x16_bf16 v[16:31], v[136:139], v[232:235], v[16:31]
    ds_read_b128 v[136:139], v2 offset:10240
    v_cmp_ge_i32 s[48:49], v6, 9
    v_cndmask_b32 v36, v8, v36, s[46:47]
    v_exp_f32 v36, v36
    v_add_f32 v11, v11, v35
    v_cvt_pk_bf16_f32 v57, v34, v35
    v_mfma_f32_32x32x16_bf16 v[16:31], v[140:143], v[236:239], v[16:31]
    ds_read_b128 v[140:143], v2 offset:11264
    v_cmp_ge_i32 s[46:47], v6, 10
    v_cndmask_b32 v37, v8, v37, s[48:49]
    v_exp_f32 v37, v37
    v_add_f32 v10, v10, v36
    v_mfma_f32_32x32x16_bf16 v[96:111], v[176:179], v[48:51], v[96:111]
    ds_read_b128 v[176:179], v3 offset:26624
    v_cmp_ge_i32 s[48:49], v6, 11
    v_cndmask_b32 v38, v8, v38, s[46:47]
    v_exp_f32 v38, v38
    v_add_f32 v11, v11, v37
    v_cvt_pk_bf16_f32 v58, v36, v37
    v_mfma_f32_32x32x16_bf16 v[16:31], v[144:147], v[240:243], v[16:31]
    ds_read_b128 v[144:147], v2 offset:12288
    v_cmp_ge_i32 s[46:47], v6, 16
    v_cndmask_b32 v39, v8, v39, s[48:49]
    v_exp_f32 v39, v39
    v_add_f32 v10, v10, v38
    s_waitcnt lgkmcnt(8)
    v_mfma_f32_32x32x16_bf16 v[16:31], v[148:151], v[244:247], v[16:31]
    ds_read_b128 v[148:151], v2 offset:13312
    v_cmp_ge_i32 s[48:49], v6, 17
    v_cndmask_b32 v40, v8, v40, s[46:47]
    v_exp_f32 v40, v40
    v_add_f32 v11, v11, v39
    v_cvt_pk_bf16_f32 v59, v38, v39
    v_mfma_f32_32x32x16_bf16 v[112:127], v[184:187], v[48:51], v[112:127]
    ds_read_b128 v[184:187], v3 offset:30720
    v_cmp_ge_i32 s[46:47], v6, 18
    v_cndmask_b32 v41, v8, v41, s[48:49]
    v_exp_f32 v41, v41
    v_add_f32 v10, v10, v40
    v_mfma_f32_32x32x16_bf16 v[16:31], v[152:155], v[248:251], v[16:31]
    ds_read_b128 v[152:155], v2 offset:14336
    v_cmp_ge_i32 s[48:49], v6, 19
    v_cndmask_b32 v42, v8, v42, s[46:47]
    v_exp_f32 v42, v42
    v_add_f32 v11, v11, v41
    v_cvt_pk_bf16_f32 v60, v40, v41
    v_mfma_f32_32x32x16_bf16 v[16:31], v[156:159], v[252:255], v[16:31]
    ds_read_b128 v[156:159], v2 offset:15360
    v_cmp_ge_i32 s[46:47], v6, 24
    v_cndmask_b32 v43, v8, v43, s[48:49]
    v_exp_f32 v43, v43
    v_add_f32 v10, v10, v42
    v_mfma_f32_32x32x16_bf16 v[64:79], v[164:167], v[52:55], v[64:79]
    ds_read_b128 v[164:167], v3 offset:19456
    v_cmp_ge_i32 s[48:49], v6, 25
    v_cndmask_b32 v44, v8, v44, s[46:47]
    v_exp_f32 v44, v44
    v_add_f32 v11, v11, v43
    v_cvt_pk_bf16_f32 v61, v42, v43
    v_mfma_f32_32x32x16_bf16 v[80:95], v[172:175], v[52:55], v[80:95]
    ds_read_b128 v[172:175], v3 offset:23552
    v_cmp_ge_i32 s[46:47], v6, 26
    v_cndmask_b32 v45, v8, v45, s[48:49]
    v_exp_f32 v45, v45
    v_add_f32 v10, v10, v44
    v_mfma_f32_32x32x16_bf16 v[96:111], v[180:183], v[52:55], v[96:111]
    ds_read_b128 v[180:183], v3 offset:27648
    v_cmp_ge_i32 s[48:49], v6, 27
    v_cndmask_b32 v46, v8, v46, s[46:47]
    v_exp_f32 v46, v46
    v_add_f32 v11, v11, v45
    v_cvt_pk_bf16_f32 v62, v44, v45
    v_mfma_f32_32x32x16_bf16 v[112:127], v[188:191], v[52:55], v[112:127]
    ds_read_b128 v[188:191], v3 offset:31744
    v_cndmask_b32 v47, v8, v47, s[48:49]
    v_exp_f32 v47, v47
    v_add_f32 v10, v10, v46
    s_nop 0
    v_add_f32 v11, v11, v47
    v_cvt_pk_bf16_f32 v63, v46, v47
    s_barrier
    v_add_u32 v2, s26, v1
    v_add_u32 v3, s27, v1
    s_mov_b32 s27, s26
    s_add_u32 s26, s26, 32768
    s_cmp_eq_u32 s26, 163840
    s_cselect_b32 s26, 0, s26
    s_lshl_b32 s38, s23, 7
    s_sub_u32 s38, s38, 0
    v_add_u32 v6, s38, v7
    s_waitcnt lgkmcnt(0)
    v_mfma_f32_32x32x16_bf16 v[32:47], v[128:131], v[224:227], 0
    ds_read_b128 v[128:131], v2 offset:0
    v_cmp_ge_i32 s[48:49], v6, 1
    v_cmp_ge_i32 s[46:47], v6, 0
    s_nop 1
    v_cndmask_b32 v16, v8, v16, s[46:47]
    v_exp_f32 v16, v16
    v_mfma_f32_32x32x16_bf16 v[64:79], v[160:163], v[56:59], v[64:79]
    ds_read_b128 v[160:163], v3 offset:16384
    v_cmp_ge_i32 s[46:47], v6, 2
    v_cndmask_b32 v17, v8, v17, s[48:49]
    v_exp_f32 v17, v17
    v_add_f32 v12, v12, v16
    v_mfma_f32_32x32x16_bf16 v[32:47], v[132:135], v[228:231], v[32:47]
    ds_read_b128 v[132:135], v2 offset:1024
    v_cmp_ge_i32 s[48:49], v6, 3
    v_cndmask_b32 v18, v8, v18, s[46:47]
    v_exp_f32 v18, v18
    v_add_f32 v13, v13, v17
    v_cvt_pk_bf16_f32 v48, v16, v17
    v_mfma_f32_32x32x16_bf16 v[80:95], v[168:171], v[56:59], v[80:95]
    ds_read_b128 v[168:171], v3 offset:20480
    v_cmp_ge_i32 s[46:47], v6, 8
    v_cndmask_b32 v19, v8, v19, s[48:49]
    v_exp_f32 v19, v19
    v_add_f32 v12, v12, v18
    v_mfma_f32_32x32x16_bf16 v[32:47], v[136:139], v[232:235], v[32:47]
    ds_read_b128 v[136:139], v2 offset:2048
    v_cmp_ge_i32 s[48:49], v6, 9
    v_cndmask_b32 v20, v8, v20, s[46:47]
    v_exp_f32 v20, v20
    v_add_f32 v13, v13, v19
    v_cvt_pk_bf16_f32 v49, v18, v19
    v_mfma_f32_32x32x16_bf16 v[32:47], v[140:143], v[236:239], v[32:47]
    ds_read_b128 v[140:143], v2 offset:3072
    v_cmp_ge_i32 s[46:47], v6, 10
    v_cndmask_b32 v21, v8, v21, s[48:49]
    v_exp_f32 v21, v21
    v_add_f32 v12, v12, v20
    v_mfma_f32_32x32x16_bf16 v[96:111], v[176:179], v[56:59], v[96:111]
    ds_read_b128 v[176:179], v3 offset:24576
    v_cmp_ge_i32 s[48:49], v6, 11
    v_cndmask_b32 v22, v8, v22, s[46:47]
    v_exp_f32 v22, v22
    v_add_f32 v13, v13, v21
    v_cvt_pk_bf16_f32 v50, v20, v21
    v_mfma_f32_32x32x16_bf16 v[32:47], v[144:147], v[240:243], v[32:47]
    ds_read_b128 v[144:147], v2 offset:4096
    v_cmp_ge_i32 s[46:47], v6, 16
    v_cndmask_b32 v23, v8, v23, s[48:49]
    v_exp_f32 v23, v23
    v_add_f32 v12, v12, v22
    s_waitcnt lgkmcnt(0)
    v_mfma_f32_32x32x16_bf16 v[32:47], v[148:151], v[244:247], v[32:47]
    ds_read_b128 v[148:151], v2 offset:5120
    v_cmp_ge_i32 s[48:49], v6, 17
    v_cndmask_b32 v24, v8, v24, s[46:47]
    v_exp_f32 v24, v24
    v_add_f32 v13, v13, v23
    v_cvt_pk_bf16_f32 v51, v22, v23
    v_mfma_f32_32x32x16_bf16 v[112:127], v[184:187], v[56:59], v[112:127]
    ds_read_b128 v[184:187], v3 offset:28672
    v_cmp_ge_i32 s[46:47], v6, 18
    v_cndmask_b32 v25, v8, v25, s[48:49]
    v_exp_f32 v25, v25
    v_add_f32 v12, v12, v24
    v_mfma_f32_32x32x16_bf16 v[32:47], v[152:155], v[248:251], v[32:47]
    ds_read_b128 v[152:155], v2 offset:6144
    v_cmp_ge_i32 s[48:49], v6, 19
    v_cndmask_b32 v26, v8, v26, s[46:47]
    v_exp_f32 v26, v26
    v_add_f32 v13, v13, v25
    v_cvt_pk_bf16_f32 v52, v24, v25
    v_mfma_f32_32x32x16_bf16 v[32:47], v[156:159], v[252:255], v[32:47]
    ds_read_b128 v[156:159], v2 offset:7168
    v_cmp_ge_i32 s[46:47], v6, 24
    v_cndmask_b32 v27, v8, v27, s[48:49]
    v_exp_f32 v27, v27
    v_add_f32 v12, v12, v26
    v_mfma_f32_32x32x16_bf16 v[64:79], v[164:167], v[60:63], v[64:79]
    ds_read_b128 v[164:167], v3 offset:17408
    v_cmp_ge_i32 s[48:49], v6, 25
    v_cndmask_b32 v28, v8, v28, s[46:47]
    v_exp_f32 v28, v28
    v_add_f32 v13, v13, v27
    v_cvt_pk_bf16_f32 v53, v26, v27
    v_mfma_f32_32x32x16_bf16 v[80:95], v[172:175], v[60:63], v[80:95]
    ds_read_b128 v[172:175], v3 offset:21504
    v_cmp_ge_i32 s[46:47], v6, 26
    v_cndmask_b32 v29, v8, v29, s[48:49]
    v_exp_f32 v29, v29
    v_add_f32 v12, v12, v28
    v_mfma_f32_32x32x16_bf16 v[96:111], v[180:183], v[60:63], v[96:111]
    ds_read_b128 v[180:183], v3 offset:25600
    v_cmp_ge_i32 s[48:49], v6, 27
    v_cndmask_b32 v30, v8, v30, s[46:47]
    v_exp_f32 v30, v30
    v_add_f32 v13, v13, v29
    v_cvt_pk_bf16_f32 v54, v28, v29
    v_mfma_f32_32x32x16_bf16 v[112:127], v[188:191], v[60:63], v[112:127]
    ds_read_b128 v[188:191], v3 offset:29696
    v_cndmask_b32 v31, v8, v31, s[48:49]
    v_exp_f32 v31, v31
    v_add_f32 v12, v12, v30
    s_nop 0
    v_add_f32 v13, v13, v31
    v_cvt_pk_bf16_f32 v55, v30, v31
    s_nop 7
    s_nop 7
    v_add_f32 v10, v10, v11
    v_mov_b32 v11, v10
    s_nop 1
    v_permlane32_swap_b32 v10, v11
    s_nop 1
    v_add_f32 v10, v10, v11
    v_cmp_gt_f32 vcc, 0x2b800000, v10
    s_mov_b64 s[46:47], vcc
    v_cmp_nle_f32 vcc, v10, v9
    s_or_b64 s[46:47], s[46:47], vcc
    v_rcp_f32 v10, v10
    v_mov_b32 v11, 0
    v_mul_f32 v64, v64, v10
    v_mul_f32 v65, v65, v10
    v_mul_f32 v66, v66, v10
    v_mul_f32 v67, v67, v10
    v_mul_f32 v68, v68, v10
    v_mul_f32 v69, v69, v10
    v_mul_f32 v70, v70, v10
    v_mul_f32 v71, v71, v10
    v_mul_f32 v72, v72, v10
    v_mul_f32 v73, v73, v10
    v_mul_f32 v74, v74, v10
    v_mul_f32 v75, v75, v10
    v_mul_f32 v76, v76, v10
    v_mul_f32 v77, v77, v10
    v_mul_f32 v78, v78, v10
    v_mul_f32 v79, v79, v10
    v_cvt_pk_bf16_f32 v64, v64, v65
    v_cvt_pk_bf16_f32 v65, v66, v67
    v_cvt_pk_bf16_f32 v66, v68, v69
    v_cvt_pk_bf16_f32 v67, v70, v71
    v_cvt_pk_bf16_f32 v68, v72, v73
    v_cvt_pk_bf16_f32 v69, v74, v75
    v_cvt_pk_bf16_f32 v70, v76, v77
    v_cvt_pk_bf16_f32 v71, v78, v79
    v_dot2c_f32_bf16 v11, v64, v14
    v_dot2c_f32_bf16 v11, v65, v14
    v_dot2c_f32_bf16 v11, v66, v14
    v_dot2c_f32_bf16 v11, v67, v14
    v_dot2c_f32_bf16 v11, v68, v14
    v_dot2c_f32_bf16 v11, v69, v14
    v_dot2c_f32_bf16 v11, v70, v14
    v_dot2c_f32_bf16 v11, v71, v14
    s_add_u32 s38, s36, 0
    buffer_store_dwordx4 v[64:67], v1, s[16:19], s38 offen offset:0 sc0 sc1
    buffer_store_dwordx4 v[68:71], v1, s[16:19], s38 offen offset:1024 sc0 sc1
    v_mul_f32 v80, v80, v10
    v_mul_f32 v81, v81, v10
    v_mul_f32 v82, v82, v10
    v_mul_f32 v83, v83, v10
    v_mul_f32 v84, v84, v10
    v_mul_f32 v85, v85, v10
    v_mul_f32 v86, v86, v10
    v_mul_f32 v87, v87, v10
    v_mul_f32 v88, v88, v10
    v_mul_f32 v89, v89, v10
    v_mul_f32 v90, v90, v10
    v_mul_f32 v91, v91, v10
    v_mul_f32 v92, v92, v10
    v_mul_f32 v93, v93, v10
    v_mul_f32 v94, v94, v10
    v_mul_f32 v95, v95, v10
    v_cvt_pk_bf16_f32 v80, v80, v81
    v_cvt_pk_bf16_f32 v81, v82, v83
    v_cvt_pk_bf16_f32 v82, v84, v85
    v_cvt_pk_bf16_f32 v83, v86, v87
    v_cvt_pk_bf16_f32 v84, v88, v89
    v_cvt_pk_bf16_f32 v85, v90, v91
    v_cvt_pk_bf16_f32 v86, v92, v93
    v_cvt_pk_bf16_f32 v87, v94, v95
    v_dot2c_f32_bf16 v11, v80, v14
    v_dot2c_f32_bf16 v11, v81, v14
    v_dot2c_f32_bf16 v11, v82, v14
    v_dot2c_f32_bf16 v11, v83, v14
    v_dot2c_f32_bf16 v11, v84, v14
    v_dot2c_f32_bf16 v11, v85, v14
    v_dot2c_f32_bf16 v11, v86, v14
    v_dot2c_f32_bf16 v11, v87, v14
    s_add_u32 s38, s36, 2048
    buffer_store_dwordx4 v[80:83], v1, s[16:19], s38 offen offset:0 sc0 sc1
    buffer_store_dwordx4 v[84:87], v1, s[16:19], s38 offen offset:1024 sc0 sc1
    v_mul_f32 v96, v96, v10
    v_mul_f32 v97, v97, v10
    v_mul_f32 v98, v98, v10
    v_mul_f32 v99, v99, v10
    v_mul_f32 v100, v100, v10
    v_mul_f32 v101, v101, v10
    v_mul_f32 v102, v102, v10
    v_mul_f32 v103, v103, v10
    v_mul_f32 v104, v104, v10
    v_mul_f32 v105, v105, v10
    v_mul_f32 v106, v106, v10
    v_mul_f32 v107, v107, v10
    v_mul_f32 v108, v108, v10
    v_mul_f32 v109, v109, v10
    v_mul_f32 v110, v110, v10
    v_mul_f32 v111, v111, v10
    v_cvt_pk_bf16_f32 v96, v96, v97
    v_cvt_pk_bf16_f32 v97, v98, v99
    v_cvt_pk_bf16_f32 v98, v100, v101
    v_cvt_pk_bf16_f32 v99, v102, v103
    v_cvt_pk_bf16_f32 v100, v104, v105
    v_cvt_pk_bf16_f32 v101, v106, v107
    v_cvt_pk_bf16_f32 v102, v108, v109
    v_cvt_pk_bf16_f32 v103, v110, v111
    v_dot2c_f32_bf16 v11, v96, v14
    v_dot2c_f32_bf16 v11, v97, v14
    v_dot2c_f32_bf16 v11, v98, v14
    v_dot2c_f32_bf16 v11, v99, v14
    v_dot2c_f32_bf16 v11, v100, v14
    v_dot2c_f32_bf16 v11, v101, v14
    v_dot2c_f32_bf16 v11, v102, v14
    v_dot2c_f32_bf16 v11, v103, v14
    s_add_u32 s38, s36, 4096
    buffer_store_dwordx4 v[96:99], v1, s[16:19], s38 offen offset:0 sc0 sc1
    buffer_store_dwordx4 v[100:103], v1, s[16:19], s38 offen offset:1024 sc0 sc1
    v_mul_f32 v112, v112, v10
    v_mul_f32 v113, v113, v10
    v_mul_f32 v114, v114, v10
    v_mul_f32 v115, v115, v10
    v_mul_f32 v116, v116, v10
    v_mul_f32 v117, v117, v10
    v_mul_f32 v118, v118, v10
    v_mul_f32 v119, v119, v10
    v_mul_f32 v120, v120, v10
    v_mul_f32 v121, v121, v10
    v_mul_f32 v122, v122, v10
    v_mul_f32 v123, v123, v10
    v_mul_f32 v124, v124, v10
    v_mul_f32 v125, v125, v10
    v_mul_f32 v126, v126, v10
    v_mul_f32 v127, v127, v10
    v_cvt_pk_bf16_f32 v112, v112, v113
    v_cvt_pk_bf16_f32 v113, v114, v115
    v_cvt_pk_bf16_f32 v114, v116, v117
    v_cvt_pk_bf16_f32 v115, v118, v119
    v_cvt_pk_bf16_f32 v116, v120, v121
    v_cvt_pk_bf16_f32 v117, v122, v123
    v_cvt_pk_bf16_f32 v118, v124, v125
    v_cvt_pk_bf16_f32 v119, v126, v127
    v_dot2c_f32_bf16 v11, v112, v14
    v_dot2c_f32_bf16 v11, v113, v14
    v_dot2c_f32_bf16 v11, v114, v14
    v_dot2c_f32_bf16 v11, v115, v14
    v_dot2c_f32_bf16 v11, v116, v14
    v_dot2c_f32_bf16 v11, v117, v14
    v_dot2c_f32_bf16 v11, v118, v14
    v_dot2c_f32_bf16 v11, v119, v14
    s_add_u32 s38, s36, 6144
    buffer_store_dwordx4 v[112:115], v1, s[16:19], s38 offen offset:0 sc0 sc1
    buffer_store_dwordx4 v[116:119], v1, s[16:19], s38 offen offset:1024 sc0 sc1
    s_nop 1
    v_cmp_u_f32 vcc, v11, v11
    s_or_b64 s[46:47], s[46:47], vcc
    s_cmp_eq_u64 s[46:47], 0
    s_cbranch_scc1 attn_kernel_ok1
    s_or_b32 s30, s30, 1
attn_kernel_ok1:
    s_lshl_b32 s38, s23, 7
    s_sub_u32 s38, s38, 32
    v_add_u32 v6, s38, v7
    s_waitcnt lgkmcnt(0)
    v_mfma_f32_32x32x16_bf16 v[16:31], v[128:131], v[224:227], 0
    ds_read_b128 v[128:131], v2 offset:8192
    v_cmp_ge_i32 s[48:49], v6, 1
    v_cmp_ge_i32 s[46:47], v6, 0
    s_nop 1
    v_cndmask_b32 v32, v8, v32, s[46:47]
    v_exp_f32 v32, v32
    v_mfma_f32_32x32x16_bf16 v[64:79], v[160:163], v[48:51], 0
    ds_read_b128 v[160:163], v3 offset:18432
    v_cmp_ge_i32 s[46:47], v6, 2
    v_cndmask_b32 v33, v8, v33, s[48:49]
    v_exp_f32 v33, v33
    v_add_f32 v12, v12, v32
    v_mfma_f32_32x32x16_bf16 v[16:31], v[132:135], v[228:231], v[16:31]
    ds_read_b128 v[132:135], v2 offset:9216
    v_cmp_ge_i32 s[48:49], v6, 3
    v_cndmask_b32 v34, v8, v34, s[46:47]
    v_exp_f32 v34, v34
    v_add_f32 v13, v13, v33
    v_cvt_pk_bf16_f32 v56, v32, v33
    v_mfma_f32_32x32x16_bf16 v[80:95], v[168:171], v[48:51], 0
    ds_read_b128 v[168:171], v3 offset:22528
    v_cmp_ge_i32 s[46:47], v6, 8
    v_cndmask_b32 v35, v8, v35, s[48:49]
    v_exp_f32 v35, v35
    v_add_f32 v12, v12, v34
    v_mfma_f32_32x32x16_bf16 v[16:31], v[136:139], v[232:235], v[16:31]
    ds_read_b128 v[136:139], v2 offset:10240
    v_cmp_ge_i32 s[48:49], v6, 9
    v_cndmask_b32 v36, v8, v36, s[46:47]
    v_exp_f32 v36, v36
    v_add_f32 v13, v13, v35
    v_cvt_pk_bf16_f32 v57, v34, v35
    v_mfma_f32_32x32x16_bf16 v[16:31], v[140:143], v[236:239], v[16:31]
    ds_read_b128 v[140:143], v2 offset:11264
    v_cmp_ge_i32 s[46:47], v6, 10
    v_cndmask_b32 v37, v8, v37, s[48:49]
    v_exp_f32 v37, v37
    v_add_f32 v12, v12, v36
    v_mfma_f32_32x32x16_bf16 v[96:111], v[176:179], v[48:51], 0
    ds_read_b128 v[176:179], v3 offset:26624
    v_cmp_ge_i32 s[48:49], v6, 11
    v_cndmask_b32 v38, v8, v38, s[46:47]
    v_exp_f32 v38, v38
    v_add_f32 v13, v13, v37
    v_cvt_pk_bf16_f32 v58, v36, v37
    v_mfma_f32_32x32x16_bf16 v[16:31], v[144:147], v[240:243], v[16:31]
    ds_read_b128 v[144:147], v2 offset:12288
    v_cmp_ge_i32 s[46:47], v6, 16
    v_cndmask_b32 v39, v8, v39, s[48:49]
    v_exp_f32 v39, v39
    v_add_f32 v12, v12, v38
    s_waitcnt lgkmcnt(0)
    v_mfma_f32_32x32x16_bf16 v[16:31], v[148:151], v[244:247], v[16:31]
    ds_read_b128 v[148:151], v2 offset:13312
    v_cmp_ge_i32 s[48:49], v6, 17
    v_cndmask_b32 v40, v8, v40, s[46:47]
    v_exp_f32 v40, v40
    v_add_f32 v13, v13, v39
    v_cvt_pk_bf16_f32 v59, v38, v39
    v_mfma_f32_32x32x16_bf16 v[112:127], v[184:187], v[48:51], 0
    ds_read_b128 v[184:187], v3 offset:30720
    v_cmp_ge_i32 s[46:47], v6, 18
    v_cndmask_b32 v41, v8, v41, s[48:49]
    v_exp_f32 v41, v41
    v_add_f32 v12, v12, v40
    v_mfma_f32_32x32x16_bf16 v[16:31], v[152:155], v[248:251], v[16:31]
    ds_read_b128 v[152:155], v2 offset:14336
    v_cmp_ge_i32 s[48:49], v6, 19
    v_cndmask_b32 v42, v8, v42, s[46:47]
    v_exp_f32 v42, v42
    v_add_f32 v13, v13, v41
    v_cvt_pk_bf16_f32 v60, v40, v41
    v_mfma_f32_32x32x16_bf16 v[16:31], v[156:159], v[252:255], v[16:31]
    ds_read_b128 v[156:159], v2 offset:15360
    v_cmp_ge_i32 s[46:47], v6, 24
    v_cndmask_b32 v43, v8, v43, s[48:49]
    v_exp_f32 v43, v43
    v_add_f32 v12, v12, v42
    v_mfma_f32_32x32x16_bf16 v[64:79], v[164:167], v[52:55], v[64:79]
    ds_read_b128 v[164:167], v3 offset:19456
    v_cmp_ge_i32 s[48:49], v6, 25
    v_cndmask_b32 v44, v8, v44, s[46:47]
    v_exp_f32 v44, v44
    v_add_f32 v13, v13, v43
    v_cvt_pk_bf16_f32 v61, v42, v43
    v_mfma_f32_32x32x16_bf16 v[80:95], v[172:175], v[52:55], v[80:95]
    ds_read_b128 v[172:175], v3 offset:23552
    v_cmp_ge_i32 s[46:47], v6, 26
    v_cndmask_b32 v45, v8, v45, s[48:49]
    v_exp_f32 v45, v45
    v_add_f32 v12, v12, v44
    v_mfma_f32_32x32x16_bf16 v[96:111], v[180:183], v[52:55], v[96:111]
    ds_read_b128 v[180:183], v3 offset:27648
    v_cmp_ge_i32 s[48:49], v6, 27
    v_cndmask_b32 v46, v8, v46, s[46:47]
    v_exp_f32 v46, v46
    v_add_f32 v13, v13, v45
    v_cvt_pk_bf16_f32 v62, v44, v45
    v_mfma_f32_32x32x16_bf16 v[112:127], v[188:191], v[52:55], v[112:127]
    ds_read_b128 v[188:191], v3 offset:31744
    v_cndmask_b32 v47, v8, v47, s[48:49]
    v_exp_f32 v47, v47
    v_add_f32 v12, v12, v46
    s_nop 0
    v_add_f32 v13, v13, v47
    v_cvt_pk_bf16_f32 v63, v46, v47
    s_lshl_b32 s29, s23, 1
    s_cmp_eq_u32 s29, 0
    s_cbranch_scc1 at_B_last
    s_sub_u32 s29, s29, 1
at_B_loop:
    s_barrier
    v_add_u32 v2, s26, v1
    v_add_u32 v3, s27, v1
    s_mov_b32 s27, s26
    s_add_u32 s26, s26, 32768
    s_cmp_eq_u32 s26, 163840
    s_cselect_b32 s26, 0, s26
    s_waitcnt lgkmcnt(8)
    v_mfma_f32_32x32x16_bf16 v[32:47], v[128:131], v[224:227], 0
    ds_read_b128 v[128:131], v2 offset:0
    v_exp_f32 v16, v16
    v_mfma_f32_32x32x16_bf16 v[64:79], v[160:163], v[56:59], v[64:79]
    ds_read_b128 v[160:163], v3 offset:16384
    v_exp_f32 v17, v17
    v_add_f32 v12, v12, v16
    v_mfma_f32_32x32x16_bf16 v[32:47], v[132:135], v[228:231], v[32:47]
    ds_read_b128 v[132:135], v2 offset:1024
    v_exp_f32 v18, v18
    v_add_f32 v13, v13, v17
    v_cvt_pk_bf16_f32 v48, v16, v17
    v_mfma_f32_32x32x16_bf16 v[80:95], v[168:171], v[56:59], v[80:95]
    ds_read_b128 v[168:171], v3 offset:20480
    v_exp_f32 v19, v19
    v_add_f32 v12, v12, v18
    v_mfma_f32_32x32x16_bf16 v[32:47], v[136:139], v[232:235], v[32:47]
    ds_read_b128 v[136:139], v2 offset:2048
    v_exp_f32 v20, v20
    v_add_f32 v13, v13, v19
    v_cvt_pk_bf16_f32 v49, v18, v19
    v_mfma_f32_32x32x16_bf16 v[32:47], v[140:143], v[236:239], v[32:47]
    ds_read_b128 v[140:143], v2 offset:3072
    v_exp_f32 v21, v21
    v_add_f32 v12, v12, v20
    v_mfma_f32_32x32x16_bf16 v[96:111], v[176:179], v[56:59], v[96:111]
    ds_read_b128 v[176:179], v3 offset:24576
    v_exp_f32 v22, v22
    v_add_f32 v13, v13, v21
    v_cvt_pk_bf16_f32 v50, v20, v21
    v_mfma_f32_32x32x16_bf16 v[32:47], v[144:147], v[240:243], v[32:47]
    ds_read_b128 v[144:147], v2 offset:4096
    v_exp_f32 v23, v23
    v_add_f32 v12, v12, v22
    s_waitcnt lgkmcnt(8)
    v_mfma_f32_32x32x16_bf16 v[32:47], v[148:151], v[244:247], v[32:47]
    ds_read_b128 v[148:151], v2 offset:5120
    v_exp_f32 v24, v24
    v_add_f32 v13, v13, v23
    v_cvt_pk_bf16_f32 v51, v22, v23
    v_mfma_f32_32x32x16_bf16 v[112:127], v[184:187], v[56:59], v[112:127]
    ds_read_b128 v[184:187], v3 offset:28672
    v_exp_f32 v25, v25
    v_add_f32 v12, v12, v24
    v_mfma_f32_32x32x16_bf16 v[32:47], v[152:155], v[248:251], v[32:47]
    ds_read_b128 v[152:155], v2 offset:6144
    v_exp_f32 v26, v26
    v_add_f32 v13, v13, v25
    v_cvt_pk_bf16_f32 v52, v24, v25
    v_mfma_f32_32x32x16_bf16 v[32:47], v[156:159], v[252:255], v[32:47]
    ds_read_b128 v[156:159], v2 offset:7168
    v_exp_f32 v27, v27
    v_add_f32 v12, v12, v26
    v_mfma_f32_32x32x16_bf16 v[64:79], v[164:167], v[60:63], v[64:79]
    ds_read_b128 v[164:167], v3 offset:17408
    v_exp_f32 v28, v28
    v_add_f32 v13, v13, v27
    v_cvt_pk_bf16_f32 v53, v26, v27
    v_mfma_f32_32x32x16_bf16 v[80:95], v[172:175], v[60:63], v[80:95]
    ds_read_b128 v[172:175], v3 offset:21504
    v_exp_f32 v29, v29
    v_add_f32 v12, v12, v28
    v_mfma_f32_32x32x16_bf16 v[96:111], v[180:183], v[60:63], v[96:111]
    ds_read_b128 v[180:183], v3 offset:25600
    v_exp_f32 v30, v30
    v_add_f32 v13, v13, v29
    v_cvt_pk_bf16_f32 v54, v28, v29
    v_mfma_f32_32x32x16_bf16 v[112:127], v[188:191], v[60:63], v[112:127]
    ds_read_b128 v[188:191], v3 offset:29696
    v_exp_f32 v31, v31
    v_add_f32 v12, v12, v30
    s_nop 0
    v_add_f32 v13, v13, v31
    v_cvt_pk_bf16_f32 v55, v30, v31
    s_waitcnt lgkmcnt(8)
    v_mfma_f32_32x32x16_bf16 v[16:31], v[128:131], v[224:227], 0
    ds_read_b128 v[128:131], v2 offset:8192
    v_exp_f32 v32, v32
    v_mfma_f32_32x32x16_bf16 v[64:79], v[160:163], v[48:51], v[64:79]
    ds_read_b128 v[160:163], v3 offset:18432
    v_exp_f32 v33, v33
    v_add_f32 v12, v12, v32
    v_mfma_f32_32x32x16_bf16 v[16:31], v[132:135], v[228:231], v[16:31]
    ds_read_b128 v[132:135], v2 offset:9216
    v_exp_f32 v34, v34
    v_add_f32 v13, v13, v33
    v_cvt_pk_bf16_f32 v56, v32, v33
    v_mfma_f32_32x32x16_bf16 v[80:95], v[168:171], v[48:51], v[80:95]
    ds_read_b128 v[168:171], v3 offset:22528
    v_exp_f32 v35, v35
    v_add_f32 v12, v12, v34
    v_mfma_f32_32x32x16_bf16 v[16:31], v[136:139], v[232:235], v[16:31]
    ds_read_b128 v[136:139], v2 offset:10240
    v_exp_f32 v36, v36
    v_add_f32 v13, v13, v35
    v_cvt_pk_bf16_f32 v57, v34, v35
    v_mfma_f32_32x32x16_bf16 v[16:31], v[140:143], v[236:239], v[16:31]
    ds_read_b128 v[140:143], v2 offset:11264
    v_exp_f32 v37, v37
    v_add_f32 v12, v12, v36
    v_mfma_f32_32x32x16_bf16 v[96:111], v[176:179], v[48:51], v[96:111]
    ds_read_b128 v[176:179], v3 offset:26624
    v_exp_f32 v38, v38
    v_add_f32 v13, v13, v37
    v_cvt_pk_bf16_f32 v58, v36, v37
    v_mfma_f32_32x32x16_bf16 v[16:31], v[144:147], v[240:243], v[16:31]
    ds_read_b128 v[144:147], v2 offset:12288
    v_exp_f32 v39, v39
    v_add_f32 v12, v12, v38
    s_waitcnt lgkmcnt(8)
    v_mfma_f32_32x32x16_bf16 v[16:31], v[148:151], v[244:247], v[16:31]
    ds_read_b128 v[148:151], v2 offset:13312
    v_exp_f32 v40, v40
    v_add_f32 v13, v13, v39
    v_cvt_pk_bf16_f32 v59, v38, v39
    v_mfma_f32_32x32x16_bf16 v[112:127], v[184:187], v[48:51], v[112:127]
    ds_read_b128 v[184:187], v3 offset:30720
    v_exp_f32 v41, v41
    v_add_f32 v12, v12, v40
    v_mfma_f32_32x32x16_bf16 v[16:31], v[152:155], v[248:251], v[16:31]
    ds_read_b128 v[152:155], v2 offset:14336
    v_exp_f32 v42, v42
    v_add_f32 v13, v13, v41
    v_cvt_pk_bf16_f32 v60, v40, v41
    v_mfma_f32_32x32x16_bf16 v[16:31], v[156:159], v[252:255], v[16:31]
    ds_read_b128 v[156:159], v2 offset:15360
    v_exp_f32 v43, v43
    v_add_f32 v12, v12, v42
    v_mfma_f32_32x32x16_bf16 v[64:79], v[164:167], v[52:55], v[64:79]
    ds_read_b128 v[164:167], v3 offset:19456
    v_exp_f32 v44, v44
    v_add_f32 v13, v13, v43
    v_cvt_pk_bf16_f32 v61, v42, v43
    v_mfma_f32_32x32x16_bf16 v[80:95], v[172:175], v[52:55], v[80:95]
    ds_read_b128 v[172:175], v3 offset:23552
    v_exp_f32 v45, v45
    v_add_f32 v12, v12, v44
    v_mfma_f32_32x32x16_bf16 v[96:111], v[180:183], v[52:55], v[96:111]
    ds_read_b128 v[180:183], v3 offset:27648
    v_exp_f32 v46, v46
    v_add_f32 v13, v13, v45
    v_cvt_pk_bf16_f32 v62, v44, v45
    v_mfma_f32_32x32x16_bf16 v[112:127], v[188:191], v[52:55], v[112:127]
    ds_read_b128 v[188:191], v3 offset:31744
    v_exp_f32 v47, v47
    v_add_f32 v12, v12, v46
    s_nop 0
    v_add_f32 v13, v13, v47
    v_cvt_pk_bf16_f32 v63, v46, v47
    s_sub_u32 s29, s29, 1
    s_cmp_lg_u32 s29, 0
    s_cbranch_scc1 at_B_loop
    s_barrier
    v_add_u32 v2, s26, v1
    v_add_u32 v3, s27, v1
    s_mov_b32 s27, s26
    s_add_u32 s26, s26, 32768
    s_cmp_eq_u32 s26, 163840
    s_cselect_b32 s26, 0, s26
    v_mov_b32 v6, v7
    s_waitcnt lgkmcnt(8)
    v_mfma_f32_32x32x16_bf16 v[32:47], v[128:131], v[224:227], 0
    ds_read_b128 v[128:131], v2 offset:0
    v_cmp_ge_i32 s[48:49], v6, 1
    v_cmp_ge_i32 s[46:47], v6, 0
    s_nop 1
    v_cndmask_b32 v16, v8, v16, s[46:47]
    v_exp_f32 v16, v16
    v_mfma_f32_32x32x16_bf16 v[64:79], v[160:163], v[56:59], v[64:79]
    ds_read_b128 v[160:163], v3 offset:16384
    v_cmp_ge_i32 s[46:47], v6, 2
    v_cndmask_b32 v17, v8, v17, s[48:49]
    v_exp_f32 v17, v17
    v_add_f32 v12, v12, v16
    v_mfma_f32_32x32x16_bf16 v[32:47], v[132:135], v[228:231], v[32:47]
    ds_read_b128 v[132:135], v2 offset:1024
    v_cmp_ge_i32 s[48:49], v6, 3
    v_cndmask_b32 v18, v8, v18, s[46:47]
    v_exp_f32 v18, v18
    v_add_f32 v13, v13, v17
    v_cvt_pk_bf16_f32 v48, v16, v17
    v_mfma_f32_32x32x16_bf16 v[80:95], v[168:171], v[56:59], v[80:95]
    ds_read_b128 v[168:171], v3 offset:20480
    v_cmp_ge_i32 s[46:47], v6, 8
    v_cndmask_b32 v19, v8, v19, s[48:49]
    v_exp_f32 v19, v19
    v_add_f32 v12, v12, v18
    v_mfma_f32_32x32x16_bf16 v[32:47], v[136:139], v[232:235], v[32:47]
    ds_read_b128 v[136:139], v2 offset:2048
    v_cmp_ge_i32 s[48:49], v6, 9
    v_cndmask_b32 v20, v8, v20, s[46:47]
    v_exp_f32 v20, v20
    v_add_f32 v13, v13, v19
    v_cvt_pk_bf16_f32 v49, v18, v19
    v_mfma_f32_32x32x16_bf16 v[32:47], v[140:143], v[236:239], v[32:47]
    ds_read_b128 v[140:143], v2 offset:3072
    v_cmp_ge_i32 s[46:47], v6, 10
    v_cndmask_b32 v21, v8, v21, s[48:49]
    v_exp_f32 v21, v21
    v_add_f32 v12, v12, v20
    v_mfma_f32_32x32x16_bf16 v[96:111], v[176:179], v[56:59], v[96:111]
    ds_read_b128 v[176:179], v3 offset:24576
    v_cmp_ge_i32 s[48:49], v6, 11
    v_cndmask_b32 v22, v8, v22, s[46:47]
    v_exp_f32 v22, v22
    v_add_f32 v13, v13, v21
    v_cvt_pk_bf16_f32 v50, v20, v21
    v_mfma_f32_32x32x16_bf16 v[32:47], v[144:147], v[240:243], v[32:47]
    ds_read_b128 v[144:147], v2 offset:4096
    v_cmp_ge_i32 s[46:47], v6, 16
    v_cndmask_b32 v23, v8, v23, s[48:49]
    v_exp_f32 v23, v23
    v_add_f32 v12, v12, v22
    s_waitcnt lgkmcnt(8)
    v_mfma_f32_32x32x16_bf16 v[32:47], v[148:151], v[244:247], v[32:47]
    ds_read_b128 v[148:151], v2 offset:5120
    v_cmp_ge_i32 s[48:49], v6, 17
    v_cndmask_b32 v24, v8, v24, s[46:47]
    v_exp_f32 v24, v24
    v_add_f32 v13, v13, v23
    v_cvt_pk_bf16_f32 v51, v22, v23
    v_mfma_f32_32x32x16_bf16 v[112:127], v[184:187], v[56:59], v[112:127]
    ds_read_b128 v[184:187], v3 offset:28672
    v_cmp_ge_i32 s[46:47], v6, 18
    v_cndmask_b32 v25, v8, v25, s[48:49]
    v_exp_f32 v25, v25
    v_add_f32 v12, v12, v24
    v_mfma_f32_32x32x16_bf16 v[32:47], v[152:155], v[248:251], v[32:47]
    ds_read_b128 v[152:155], v2 offset:6144
    v_cmp_ge_i32 s[48:49], v6, 19
    v_cndmask_b32 v26, v8, v26, s[46:47]
    v_exp_f32 v26, v26
    v_add_f32 v13, v13, v25
    v_cvt_pk_bf16_f32 v52, v24, v25
    v_mfma_f32_32x32x16_bf16 v[32:47], v[156:159], v[252:255], v[32:47]
    ds_read_b128 v[156:159], v2 offset:7168
    v_cmp_ge_i32 s[46:47], v6, 24
    v_cndmask_b32 v27, v8, v27, s[48:49]
    v_exp_f32 v27, v27
    v_add_f32 v12, v12, v26
    v_mfma_f32_32x32x16_bf16 v[64:79], v[164:167], v[60:63], v[64:79]
    ds_read_b128 v[164:167], v3 offset:17408
    v_cmp_ge_i32 s[48:49], v6, 25
    v_cndmask_b32 v28, v8, v28, s[46:47]
    v_exp_f32 v28, v28
    v_add_f32 v13, v13, v27
    v_cvt_pk_bf16_f32 v53, v26, v27
    v_mfma_f32_32x32x16_bf16 v[80:95], v[172:175], v[60:63], v[80:95]
    ds_read_b128 v[172:175], v3 offset:21504
    v_cmp_ge_i32 s[46:47], v6, 26
    v_cndmask_b32 v29, v8, v29, s[48:49]
    v_exp_f32 v29, v29
    v_add_f32 v12, v12, v28
    v_mfma_f32_32x32x16_bf16 v[96:111], v[180:183], v[60:63], v[96:111]
    ds_read_b128 v[180:183], v3 offset:25600
    v_cmp_ge_i32 s[48:49], v6, 27
    v_cndmask_b32 v30, v8, v30, s[46:47]
    v_exp_f32 v30, v30
    v_add_f32 v13, v13, v29
    v_cvt_pk_bf16_f32 v54, v28, v29
    v_mfma_f32_32x32x16_bf16 v[112:127], v[188:191], v[60:63], v[112:127]
    ds_read_b128 v[188:191], v3 offset:29696
    v_cndmask_b32 v31, v8, v31, s[48:49]
    v_exp_f32 v31, v31
    v_add_f32 v12, v12, v30
    s_nop 0
    v_add_f32 v13, v13, v31
    v_cvt_pk_bf16_f32 v55, v30, v31
    v_subrev_u32 v6, 32, v7
    s_waitcnt lgkmcnt(8)
    v_mfma_f32_32x32x16_bf16 v[16:31], v[128:131], v[224:227], 0
    ds_read_b128 v[128:131], v2 offset:8192
    v_cmp_ge_i32 s[48:49], v6, 1
    v_cmp_ge_i32 s[46:47], v6, 0
    s_nop 1
    v_cndmask_b32 v32, v8, v32, s[46:47]
    v_exp_f32 v32, v32
    v_mfma_f32_32x32x16_bf16 v[64:79], v[160:163], v[48:51], v[64:79]
    ds_read_b128 v[160:163], v3 offset:18432
    v_cmp_ge_i32 s[46:47], v6, 2
    v_cndmask_b32 v33, v8, v33, s[48:49]
    v_exp_f32 v33, v33
    v_add_f32 v12, v12, v32
    v_mfma_f32_32x32x16_bf16 v[16:31], v[132:135], v[228:231], v[16:31]
    ds_read_b128 v[132:135], v2 offset:9216
    v_cmp_ge_i32 s[48:49], v6, 3
    v_cndmask_b32 v34, v8, v34, s[46:47]
    v_exp_f32 v34, v34
    v_add_f32 v13, v13, v33
    v_cvt_pk_bf16_f32 v56, v32, v33
    v_mfma_f32_32x32x16_bf16 v[80:95], v[168:171], v[48:51], v[80:95]
    ds_read_b128 v[168:171], v3 offset:22528
    v_cmp_ge_i32 s[46:47], v6, 8
    v_cndmask_b32 v35, v8, v35, s[48:49]
    v_exp_f32 v35, v35
    v_add_f32 v12, v12, v34
    v_mfma_f32_32x32x16_bf16 v[16:31], v[136:139], v[232:235], v[16:31]
    ds_read_b128 v[136:139], v2 offset:10240
    v_cmp_ge_i32 s[48:49], v6, 9
    v_cndmask_b32 v36, v8, v36, s[46:47]
    v_exp_f32 v36, v36
    v_add_f32 v13, v13, v35
    v_cvt_pk_bf16_f32 v57, v34, v35
    v_mfma_f32_32x32x16_bf16 v[16:31], v[140:143], v[236:239], v[16:31]
    ds_read_b128 v[140:143], v2 offset:11264
    v_cmp_ge_i32 s[46:47], v6, 10
    v_cndmask_b32 v37, v8, v37, s[48:49]
    v_exp_f32 v37, v37
    v_add_f32 v12, v12, v36
    v_mfma_f32_32x32x16_bf16 v[96:111], v[176:179], v[48:51], v[96:111]
    ds_read_b128 v[176:179], v3 offset:26624
    v_cmp_ge_i32 s[48:49], v6, 11
    v_cndmask_b32 v38, v8, v38, s[46:47]
    v_exp_f32 v38, v38
    v_add_f32 v13, v13, v37
    v_cvt_pk_bf16_f32 v58, v36, v37
    v_mfma_f32_32x32x16_bf16 v[16:31], v[144:147], v[240:243], v[16:31]
    ds_read_b128 v[144:147], v2 offset:12288
    v_cmp_ge_i32 s[46:47], v6, 16
    v_cndmask_b32 v39, v8, v39, s[48:49]
    v_exp_f32 v39, v39
    v_add_f32 v12, v12, v38
    s_waitcnt lgkmcnt(8)
    v_mfma_f32_32x32x16_bf16 v[16:31], v[148:151], v[244:247], v[16:31]
    ds_read_b128 v[148:151], v2 offset:13312
    v_cmp_ge_i32 s[48:49], v6, 17
    v_cndmask_b32 v40, v8, v40, s[46:47]
    v_exp_f32 v40, v40
    v_add_f32 v13, v13, v39
    v_cvt_pk_bf16_f32 v59, v38, v39
    v_mfma_f32_32x32x16_bf16 v[112:127], v[184:187], v[48:51], v[112:127]
    ds_read_b128 v[184:187], v3 offset:30720
    v_cmp_ge_i32 s[46:47], v6, 18
    v_cndmask_b32 v41, v8, v41, s[48:49]
    v_exp_f32 v41, v41
    v_add_f32 v12, v12, v40
    v_mfma_f32_32x32x16_bf16 v[16:31], v[152:155], v[248:251], v[16:31]
    ds_read_b128 v[152:155], v2 offset:14336
    v_cmp_ge_i32 s[48:49], v6, 19
    v_cndmask_b32 v42, v8, v42, s[46:47]
    v_exp_f32 v42, v42
    v_add_f32 v13, v13, v41
    v_cvt_pk_bf16_f32 v60, v40, v41
    v_mfma_f32_32x32x16_bf16 v[16:31], v[156:159], v[252:255], v[16:31]
    ds_read_b128 v[156:159], v2 offset:15360
    v_cmp_ge_i32 s[46:47], v6, 24
    v_cndmask_b32 v43, v8, v43, s[48:49]
    v_exp_f32 v43, v43
    v_add_f32 v12, v12, v42
    v_mfma_f32_32x32x16_bf16 v[64:79], v[164:167], v[52:55], v[64:79]
    ds_read_b128 v[164:167], v3 offset:19456
    v_cmp_ge_i32 s[48:49], v6, 25
    v_cndmask_b32 v44, v8, v44, s[46:47]
    v_exp_f32 v44, v44
    v_add_f32 v13, v13, v43
    v_cvt_pk_bf16_f32 v61, v42, v43
    v_mfma_f32_32x32x16_bf16 v[80:95], v[172:175], v[52:55], v[80:95]
    ds_read_b128 v[172:175], v3 offset:23552
    v_cmp_ge_i32 s[46:47], v6, 26
    v_cndmask_b32 v45, v8, v45, s[48:49]
    v_exp_f32 v45, v45
    v_add_f32 v12, v12, v44
    v_mfma_f32_32x32x16_bf16 v[96:111], v[180:183], v[52:55], v[96:111]
    ds_read_b128 v[180:183], v3 offset:27648
    v_cmp_ge_i32 s[48:49], v6, 27
    v_cndmask_b32 v46, v8, v46, s[46:47]
    v_exp_f32 v46, v46
    v_add_f32 v13, v13, v45
    v_cvt_pk_bf16_f32 v62, v44, v45
    v_mfma_f32_32x32x16_bf16 v[112:127], v[188:191], v[52:55], v[112:127]
    ds_read_b128 v[188:191], v3 offset:31744
    v_cndmask_b32 v47, v8, v47, s[48:49]
    v_exp_f32 v47, v47
    v_add_f32 v12, v12, v46
    s_nop 0
    v_add_f32 v13, v13, v47
    v_cvt_pk_bf16_f32 v63, v46, v47
at_B_last:
    s_barrier
    v_add_u32 v2, s26, v1
    v_add_u32 v3, s27, v1
    s_mov_b32 s27, s26
    s_add_u32 s26, s26, 32768
    s_cmp_eq_u32 s26, 163840
    s_cselect_b32 s26, 0, s26
    v_subrev_u32 v6, 64, v7
    s_waitcnt lgkmcnt(0)
    v_mfma_f32_32x32x16_bf16 v[32:47], v[128:131], v[224:227], 0
    v_cmp_ge_i32 s[48:49], v6, 1
    v_cmp_ge_i32 s[46:47], v6, 0
    s_nop 1
    v_cndmask_b32 v16, v8, v16, s[46:47]
    v_exp_f32 v16, v16
    v_mfma_f32_32x32x16_bf16 v[64:79], v[160:163], v[56:59], v[64:79]
    ds_read_b128 v[160:163], v3 offset:16384
    v_cmp_ge_i32 s[46:47], v6, 2
    v_cndmask_b32 v17, v8, v17, s[48:49]
    v_exp_f32 v17, v17
    v_add_f32 v12, v12, v16
    v_mfma_f32_32x32x16_bf16 v[32:47], v[132:135], v[228:231], v[32:47]
    v_cmp_ge_i32 s[48:49], v6, 3
    v_cndmask_b32 v18, v8, v18, s[46:47]
    v_exp_f32 v18, v18
    v_add_f32 v13, v13, v17
    v_cvt_pk_bf16_f32 v48, v16, v17
    v_mfma_f32_32x32x16_bf16 v[80:95], v[168:171], v[56:59], v[80:95]
    ds_read_b128 v[168:171], v3 offset:20480
    v_cmp_ge_i32 s[46:47], v6, 8
    v_cndmask_b32 v19, v8, v19, s[48:49]
    v_exp_f32 v19, v19
    v_add_f32 v12, v12, v18
    v_mfma_f32_32x32x16_bf16 v[32:47], v[136:139], v[232:235], v[32:47]
    v_cmp_ge_i32 s[48:49], v6, 9
    v_cndmask_b32 v20, v8, v20, s[46:47]
    v_exp_f32 v20, v20
    v_add_f32 v13, v13, v19
    v_cvt_pk_bf16_f32 v49, v18, v19
    v_mfma_f32_32x32x16_bf16 v[32:47], v[140:143], v[236:239], v[32:47]
    v_cmp_ge_i32 s[46:47], v6, 10
    v_cndmask_b32 v21, v8, v21, s[48:49]
    v_exp_f32 v21, v21
    v_add_f32 v12, v12, v20
    v_mfma_f32_32x32x16_bf16 v[96:111], v[176:179], v[56:59], v[96:111]
    ds_read_b128 v[176:179], v3 offset:24576
    v_cmp_ge_i32 s[48:49], v6, 11
    v_cndmask_b32 v22, v8, v22, s[46:47]
    v_exp_f32 v22, v22
    v_add_f32 v13, v13, v21
    v_cvt_pk_bf16_f32 v50, v20, v21
    v_mfma_f32_32x32x16_bf16 v[32:47], v[144:147], v[240:243], v[32:47]
    v_cmp_ge_i32 s[46:47], v6, 16
    v_cndmask_b32 v23, v8, v23, s[48:49]
    v_exp_f32 v23, v23
    v_add_f32 v12, v12, v22
    s_waitcnt lgkmcnt(0)
    v_mfma_f32_32x32x16_bf16 v[32:47], v[148:151], v[244:247], v[32:47]
    v_cmp_ge_i32 s[48:49], v6, 17
    v_cndmask_b32 v24, v8, v24, s[46:47]
    v_exp_f32 v24, v24
    v_add_f32 v13, v13, v23
    v_cvt_pk_bf16_f32 v51, v22, v23
    v_mfma_f32_32x32x16_bf16 v[112:127], v[184:187], v[56:59], v[112:127]
    ds_read_b128 v[184:187], v3 offset:28672
    v_cmp_ge_i32 s[46:47], v6, 18
    v_cndmask_b32 v25, v8, v25, s[48:49]
    v_exp_f32 v25, v25
    v_add_f32 v12, v12, v24
    v_mfma_f32_32x32x16_bf16 v[32:47], v[152:155], v[248:251], v[32:47]
    v_cmp_ge_i32 s[48:49], v6, 19
    v_cndmask_b32 v26, v8, v26, s[46:47]
    v_exp_f32 v26, v26
    v_add_f32 v13, v13, v25
    v_cvt_pk_bf16_f32 v52, v24, v25
    v_mfma_f32_32x32x16_bf16 v[32:47], v[156:159], v[252:255], v[32:47]
    v_cmp_ge_i32 s[46:47], v6, 24
    v_cndmask_b32 v27, v8, v27, s[48:49]
    v_exp_f32 v27, v27
    v_add_f32 v12, v12, v26
    v_mfma_f32_32x32x16_bf16 v[64:79], v[164:167], v[60:63], v[64:79]
    ds_read_b128 v[164:167], v3 offset:17408
    v_cmp_ge_i32 s[48:49], v6, 25
    v_cndmask_b32 v28, v8, v28, s[46:47]
    v_exp_f32 v28, v28
    v_add_f32 v13, v13, v27
    v_cvt_pk_bf16_f32 v53, v26, v27
    v_mfma_f32_32x32x16_bf16 v[80:95], v[172:175], v[60:63], v[80:95]
    ds_read_b128 v[172:175], v3 offset:21504
    v_cmp_ge_i32 s[46:47], v6, 26
    v_cndmask_b32 v29, v8, v29, s[48:49]
    v_exp_f32 v29, v29
    v_add_f32 v12, v12, v28
    v_mfma_f32_32x32x16_bf16 v[96:111], v[180:183], v[60:63], v[96:111]
    ds_read_b128 v[180:183], v3 offset:25600
    v_cmp_ge_i32 s[48:49], v6, 27
    v_cndmask_b32 v30, v8, v30, s[46:47]
    v_exp_f32 v30, v30
    v_add_f32 v13, v13, v29
    v_cvt_pk_bf16_f32 v54, v28, v29
    v_mfma_f32_32x32x16_bf16 v[112:127], v[188:191], v[60:63], v[112:127]
    ds_read_b128 v[188:191], v3 offset:29696
    v_cndmask_b32 v31, v8, v31, s[48:49]
    v_exp_f32 v31, v31
    v_add_f32 v12, v12, v30
    s_nop 0
    v_add_f32 v13, v13, v31
    v_cvt_pk_bf16_f32 v55, v30, v31
    v_subrev_u32 v6, 96, v7
    s_waitcnt lgkmcnt(0)
    v_cmp_ge_i32 s[48:49], v6, 1
    v_cmp_ge_i32 s[46:47], v6, 0
    s_nop 1
    v_cndmask_b32 v32, v8, v32, s[46:47]
    v_exp_f32 v32, v32
    v_mfma_f32_32x32x16_bf16 v[64:79], v[160:163], v[48:51], v[64:79]
    ds_read_b128 v[160:163], v3 offset:18432
    v_cmp_ge_i32 s[46:47], v6, 2
    v_cndmask_b32 v33, v8, v33, s[48:49]
    v_exp_f32 v33, v33
    v_add_f32 v12, v12, v32
    v_cmp_ge_i32 s[48:49], v6, 3
    v_cndmask_b32 v34, v8, v34, s[46:47]
    v_exp_f32 v34, v34
    v_add_f32 v13, v13, v33
    v_cvt_pk_bf16_f32 v56, v32, v33
    v_mfma_f32_32x32x16_bf16 v[80:95], v[168:171], v[48:51], v[80:95]
    ds_read_b128 v[168:171], v3 offset:22528
    v_cmp_ge_i32 s[46:47], v6, 8
    v_cndmask_b32 v35, v8, v35, s[48:49]
    v_exp_f32 v35, v35
    v_add_f32 v12, v12, v34
    v_cmp_ge_i32 s[48:49], v6, 9
    v_cndmask_b32 v36, v8, v36, s[46:47]
    v_exp_f32 v36, v36
    v_add_f32 v13, v13, v35
    v_cvt_pk_bf16_f32 v57, v34, v35
    v_cmp_ge_i32 s[46:47], v6, 10
    v_cndmask_b32 v37, v8, v37, s[48:49]
    v_exp_f32 v37, v37
    v_add_f32 v12, v12, v36
    v_mfma_f32_32x32x16_bf16 v[96:111], v[176:179], v[48:51], v[96:111]
    ds_read_b128 v[176:179], v3 offset:26624
    v_cmp_ge_i32 s[48:49], v6, 11
    v_cndmask_b32 v38, v8, v38, s[46:47]
    v_exp_f32 v38, v38
    v_add_f32 v13, v13, v37
    v_cvt_pk_bf16_f32 v58, v36, v37
    v_cmp_ge_i32 s[46:47], v6, 16
    v_cndmask_b32 v39, v8, v39, s[48:49]
    v_exp_f32 v39, v39
    v_add_f32 v12, v12, v38
    s_waitcnt lgkmcnt(0)
    v_cmp_ge_i32 s[48:49], v6, 17
    v_cndmask_b32 v40, v8, v40, s[46:47]
    v_exp_f32 v40, v40
    v_add_f32 v13, v13, v39
    v_cvt_pk_bf16_f32 v59, v38, v39
    v_mfma_f32_32x32x16_bf16 v[112:127], v[184:187], v[48:51], v[112:127]
    ds_read_b128 v[184:187], v3 offset:30720
    v_cmp_ge_i32 s[46:47], v6, 18
    v_cndmask_b32 v41, v8, v41, s[48:49]
    v_exp_f32 v41, v41
    v_add_f32 v12, v12, v40
    v_cmp_ge_i32 s[48:49], v6, 19
    v_cndmask_b32 v42, v8, v42, s[46:47]
    v_exp_f32 v42, v42
    v_add_f32 v13, v13, v41
    v_cvt_pk_bf16_f32 v60, v40, v41
    v_cmp_ge_i32 s[46:47], v6, 24
    v_cndmask_b32 v43, v8, v43, s[48:49]
    v_exp_f32 v43, v43
    v_add_f32 v12, v12, v42
    v_mfma_f32_32x32x16_bf16 v[64:79], v[164:167], v[52:55], v[64:79]
    ds_read_b128 v[164:167], v3 offset:19456
    v_cmp_ge_i32 s[48:49], v6, 25
    v_cndmask_b32 v44, v8, v44, s[46:47]
    v_exp_f32 v44, v44
    v_add_f32 v13, v13, v43
    v_cvt_pk_bf16_f32 v61, v42, v43
    v_mfma_f32_32x32x16_bf16 v[80:95], v[172:175], v[52:55], v[80:95]
    ds_read_b128 v[172:175], v3 offset:23552
    v_cmp_ge_i32 s[46:47], v6, 26
    v_cndmask_b32 v45, v8, v45, s[48:49]
    v_exp_f32 v45, v45
    v_add_f32 v12, v12, v44
    v_mfma_f32_32x32x16_bf16 v[96:111], v[180:183], v[52:55], v[96:111]
    ds_read_b128 v[180:183], v3 offset:27648
    v_cmp_ge_i32 s[48:49], v6, 27
    v_cndmask_b32 v46, v8, v46, s[46:47]
    v_exp_f32 v46, v46
    v_add_f32 v13, v13, v45
    v_cvt_pk_bf16_f32 v62, v44, v45
    v_mfma_f32_32x32x16_bf16 v[112:127], v[188:191], v[52:55], v[112:127]
    ds_read_b128 v[188:191], v3 offset:31744
    v_cndmask_b32 v47, v8, v47, s[48:49]
    v_exp_f32 v47, v47
    v_add_f32 v12, v12, v46
    s_nop 0
    v_add_f32 v13, v13, v47
    v_cvt_pk_bf16_f32 v63, v46, v47
    s_waitcnt lgkmcnt(0)
    v_mfma_f32_32x32x16_bf16 v[64:79], v[160:163], v[56:59], v[64:79]
    v_mfma_f32_32x32x16_bf16 v[80:95], v[168:171], v[56:59], v[80:95]
    v_mfma_f32_32x32x16_bf16 v[96:111], v[176:179], v[56:59], v[96:111]
    v_mfma_f32_32x32x16_bf16 v[112:127], v[184:187], v[56:59], v[112:127]
    v_mfma_f32_32x32x16_bf16 v[64:79], v[164:167], v[60:63], v[64:79]
    v_mfma_f32_32x32x16_bf16 v[80:95], v[172:175], v[60:63], v[80:95]
    v_mfma_f32_32x32x16_bf16 v[96:111], v[180:183], v[60:63], v[96:111]
    v_mfma_f32_32x32x16_bf16 v[112:127], v[188:191], v[60:63], v[112:127]
    s_nop 7
    s_nop 7
    v_add_f32 v12, v12, v13
    v_mov_b32 v13, v12
    s_nop 1
    v_permlane32_swap_b32 v12, v13
    s_nop 1
    v_add_f32 v12, v12, v13
    v_cmp_gt_f32 vcc, 0x2b800000, v12
    s_mov_b64 s[46:47], vcc
    v_cmp_nle_f32 vcc, v12, v9
    s_or_b64 s[46:47], s[46:47], vcc
    v_rcp_f32 v12, v12
    v_mov_b32 v13, 0
    v_mul_f32 v64, v64, v12
    v_mul_f32 v65, v65, v12
    v_mul_f32 v66, v66, v12
    v_mul_f32 v67, v67, v12
    v_mul_f32 v68, v68, v12
    v_mul_f32 v69, v69, v12
    v_mul_f32 v70, v70, v12
    v_mul_f32 v71, v71, v12
    v_mul_f32 v72, v72, v12
    v_mul_f32 v73, v73, v12
    v_mul_f32 v74, v74, v12
    v_mul_f32 v75, v75, v12
    v_mul_f32 v76, v76, v12
    v_mul_f32 v77, v77, v12
    v_mul_f32 v78, v78, v12
    v_mul_f32 v79, v79, v12
    v_cvt_pk_bf16_f32 v64, v64, v65
    v_cvt_pk_bf16_f32 v65, v66, v67
    v_cvt_pk_bf16_f32 v66, v68, v69
    v_cvt_pk_bf16_f32 v67, v70, v71
    v_cvt_pk_bf16_f32 v68, v72, v73
    v_cvt_pk_bf16_f32 v69, v74, v75
    v_cvt_pk_bf16_f32 v70, v76, v77
    v_cvt_pk_bf16_f32 v71, v78, v79
    v_dot2c_f32_bf16 v13, v64, v14
    v_dot2c_f32_bf16 v13, v65, v14
    v_dot2c_f32_bf16 v13, v66, v14
    v_dot2c_f32_bf16 v13, v67, v14
    v_dot2c_f32_bf16 v13, v68, v14
    v_dot2c_f32_bf16 v13, v69, v14
    v_dot2c_f32_bf16 v13, v70, v14
    v_dot2c_f32_bf16 v13, v71, v14
    s_add_u32 s38, s37, 0
    buffer_store_dwordx4 v[64:67], v1, s[16:19], s38 offen offset:0 sc0 sc1
    buffer_store_dwordx4 v[68:71], v1, s[16:19], s38 offen offset:1024 sc0 sc1
    v_mul_f32 v80, v80, v12
    v_mul_f32 v81, v81, v12
    v_mul_f32 v82, v82, v12
    v_mul_f32 v83, v83, v12
    v_mul_f32 v84, v84, v12
    v_mul_f32 v85, v85, v12
    v_mul_f32 v86, v86, v12
    v_mul_f32 v87, v87, v12
    v_mul_f32 v88, v88, v12
    v_mul_f32 v89, v89, v12
    v_mul_f32 v90, v90, v12
    v_mul_f32 v91, v91, v12
    v_mul_f32 v92, v92, v12
    v_mul_f32 v93, v93, v12
    v_mul_f32 v94, v94, v12
    v_mul_f32 v95, v95, v12
    v_cvt_pk_bf16_f32 v80, v80, v81
    v_cvt_pk_bf16_f32 v81, v82, v83
    v_cvt_pk_bf16_f32 v82, v84, v85
    v_cvt_pk_bf16_f32 v83, v86, v87
    v_cvt_pk_bf16_f32 v84, v88, v89
    v_cvt_pk_bf16_f32 v85, v90, v91
    v_cvt_pk_bf16_f32 v86, v92, v93
    v_cvt_pk_bf16_f32 v87, v94, v95
    v_dot2c_f32_bf16 v13, v80, v14
    v_dot2c_f32_bf16 v13, v81, v14
    v_dot2c_f32_bf16 v13, v82, v14
    v_dot2c_f32_bf16 v13, v83, v14
    v_dot2c_f32_bf16 v13, v84, v14
    v_dot2c_f32_bf16 v13, v85, v14
    v_dot2c_f32_bf16 v13, v86, v14
    v_dot2c_f32_bf16 v13, v87, v14
    s_add_u32 s38, s37, 2048
    buffer_store_dwordx4 v[80:83], v1, s[16:19], s38 offen offset:0 sc0 sc1
    buffer_store_dwordx4 v[84:87], v1, s[16:19], s38 offen offset:1024 sc0 sc1
    v_mul_f32 v96, v96, v12
    v_mul_f32 v97, v97, v12
    v_mul_f32 v98, v98, v12
    v_mul_f32 v99, v99, v12
    v_mul_f32 v100, v100, v12
    v_mul_f32 v101, v101, v12
    v_mul_f32 v102, v102, v12
    v_mul_f32 v103, v103, v12
    v_mul_f32 v104, v104, v12
    v_mul_f32 v105, v105, v12
    v_mul_f32 v106, v106, v12
    v_mul_f32 v107, v107, v12
    v_mul_f32 v108, v108, v12
    v_mul_f32 v109, v109, v12
    v_mul_f32 v110, v110, v12
    v_mul_f32 v111, v111, v12
    v_cvt_pk_bf16_f32 v96, v96, v97
    v_cvt_pk_bf16_f32 v97, v98, v99
    v_cvt_pk_bf16_f32 v98, v100, v101
    v_cvt_pk_bf16_f32 v99, v102, v103
    v_cvt_pk_bf16_f32 v100, v104, v105
    v_cvt_pk_bf16_f32 v101, v106, v107
    v_cvt_pk_bf16_f32 v102, v108, v109
    v_cvt_pk_bf16_f32 v103, v110, v111
    v_dot2c_f32_bf16 v13, v96, v14
    v_dot2c_f32_bf16 v13, v97, v14
    v_dot2c_f32_bf16 v13, v98, v14
    v_dot2c_f32_bf16 v13, v99, v14
    v_dot2c_f32_bf16 v13, v100, v14
    v_dot2c_f32_bf16 v13, v101, v14
    v_dot2c_f32_bf16 v13, v102, v14
    v_dot2c_f32_bf16 v13, v103, v14
    s_add_u32 s38, s37, 4096
    buffer_store_dwordx4 v[96:99], v1, s[16:19], s38 offen offset:0 sc0 sc1
    buffer_store_dwordx4 v[100:103], v1, s[16:19], s38 offen offset:1024 sc0 sc1
    v_mul_f32 v112, v112, v12
    v_mul_f32 v113, v113, v12
    v_mul_f32 v114, v114, v12
    v_mul_f32 v115, v115, v12
    v_mul_f32 v116, v116, v12
    v_mul_f32 v117, v117, v12
    v_mul_f32 v118, v118, v12
    v_mul_f32 v119, v119, v12
    v_mul_f32 v120, v120, v12
    v_mul_f32 v121, v121, v12
    v_mul_f32 v122, v122, v12
    v_mul_f32 v123, v123, v12
    v_mul_f32 v124, v124, v12
    v_mul_f32 v125, v125, v12
    v_mul_f32 v126, v126, v12
    v_mul_f32 v127, v127, v12
    v_cvt_pk_bf16_f32 v112, v112, v113
    v_cvt_pk_bf16_f32 v113, v114, v115
    v_cvt_pk_bf16_f32 v114, v116, v117
    v_cvt_pk_bf16_f32 v115, v118, v119
    v_cvt_pk_bf16_f32 v116, v120, v121
    v_cvt_pk_bf16_f32 v117, v122, v123
    v_cvt_pk_bf16_f32 v118, v124, v125
    v_cvt_pk_bf16_f32 v119, v126, v127
    v_dot2c_f32_bf16 v13, v112, v14
    v_dot2c_f32_bf16 v13, v113, v14
    v_dot2c_f32_bf16 v13, v114, v14
    v_dot2c_f32_bf16 v13, v115, v14
    v_dot2c_f32_bf16 v13, v116, v14
    v_dot2c_f32_bf16 v13, v117, v14
    v_dot2c_f32_bf16 v13, v118, v14
    v_dot2c_f32_bf16 v13, v119, v14
    s_add_u32 s38, s37, 6144
    buffer_store_dwordx4 v[112:115], v1, s[16:19], s38 offen offset:0 sc0 sc1
    buffer_store_dwordx4 v[116:119], v1, s[16:19], s38 offen offset:1024 sc0 sc1
    s_nop 1
    v_cmp_u_f32 vcc, v13, v13
    s_or_b64 s[46:47], s[46:47], vcc
    s_cmp_eq_u64 s[46:47], 0
    s_cbranch_scc1 attn_kernel_ok2
    s_or_b32 s30, s30, 2
attn_kernel_ok2:
    s_cmp_eq_u32 s30, 0
    s_cbranch_scc1 at_done
    s_waitcnt vmcnt(0)
    s_and_b32 s38, s30, 1
    s_cmp_eq_u32 s38, 0
    s_cbranch_scc1 at_slow_skip0
    v_mov_b32 v15, v8
    v_mov_b32 v10, 0
    v_mov_b32 v64, 0
    v_mov_b32 v65, 0
    v_mov_b32 v66, 0
    v_mov_b32 v67, 0
    v_mov_b32 v68, 0
    v_mov_b32 v69, 0
    v_mov_b32 v70, 0
    v_mov_b32 v71, 0
    v_mov_b32 v72, 0
    v_mov_b32 v73, 0
    v_mov_b32 v74, 0
    v_mov_b32 v75, 0
    v_mov_b32 v76, 0
    v_mov_b32 v77, 0
    v_mov_b32 v78, 0
    v_mov_b32 v79, 0
    v_mov_b32 v80, 0
    v_mov_b32 v81, 0
    v_mov_b32 v82, 0
    v_mov_b32 v83, 0
    v_mov_b32 v84, 0
    v_mov_b32 v85, 0
    v_mov_b32 v86, 0
    v_mov_b32 v87, 0
    v_mov_b32 v88, 0
    v_mov_b32 v89, 0
    v_mov_b32 v90, 0
    v_mov_b32 v91, 0
    v_mov_b32 v92, 0
    v_mov_b32 v93, 0
    v_mov_b32 v94, 0
    v_mov_b32 v95, 0
    v_mov_b32 v96, 0
    v_mov_b32 v97, 0
    v_mov_b32 v98, 0
    v_mov_b32 v99, 0
    v_mov_b32 v100, 0
    v_mov_b32 v101, 0
    v_mov_b32 v102, 0
    v_mov_b32 v103, 0
    v_mov_b32 v104, 0
    v_mov_b32 v105, 0
    v_mov_b32 v106, 0
    v_mov_b32 v107, 0
    v_mov_b32 v108, 0
    v_mov_b32 v109, 0
    v_mov_b32 v110, 0
    v_mov_b32 v111, 0
    v_mov_b32 v112, 0
    v_mov_b32 v113, 0
    v_mov_b32 v114, 0
    v_mov_b32 v115, 0
    v_mov_b32 v116, 0
    v_mov_b32 v117, 0
    v_mov_b32 v118, 0
    v_mov_b32 v119, 0
    v_mov_b32 v120, 0
    v_mov_b32 v121, 0
    v_mov_b32 v122, 0
    v_mov_b32 v123, 0
    v_mov_b32 v124, 0
    v_mov_b32 v125, 0
    v_mov_b32 v126, 0
    v_mov_b32 v127, 0
    s_mov_b32 s29, 0
    s_lshl_b32 s28, s22, 2
    s_add_u32 s28, s28, 4
    s_lshl_b32 s39, s22, 7
    v_add_u32 v6, s39, v7
at_slow_loop0:
    s_lshr_b32 s38, s29, 1
    s_lshl_b32 s38, s38, 15
    s_and_b32 s39, s29, 1
    s_lshl_b32 s46, s39, 13
    s_add_u32 s46, s46, s38
    s_lshl_b32 s47, s39, 11
    s_add_u32 s47, s47, s38
    s_add_u32 s47, s47, 16384
    s_add_u32 s48, s46, 0
    buffer_load_dwordx4 v[128:131], v1, s[12:15], s48 offen
    s_add_u32 s48, s46, 1024
    buffer_load_dwordx4 v[132:135], v1, s[12:15], s48 offen
    s_add_u32 s48, s46, 2048
    buffer_load_dwordx4 v[136:139], v1, s[12:15], s48 offen
    s_add_u32 s48, s46, 3072
    buffer_load_dwordx4 v[140:143], v1, s[12:15], s48 offen
    s_add_u32 s48, s46, 4096
    buffer_load_dwordx4 v[144:147], v1, s[12:15], s48 offen
    s_add_u32 s48, s46, 5120
    buffer_load_dwordx4 v[148:151], v1, s[12:15], s48 offen
    s_add_u32 s48, s46, 6144
    buffer_load_dwordx4 v[152:155], v1, s[12:15], s48 offen
    s_add_u32 s48, s46, 7168
    buffer_load_dwordx4 v[156:159], v1, s[12:15], s48 offen
    s_add_u32 s48, s47, 0
    buffer_load_dwordx4 v[160:163], v1, s[12:15], s48 offen
    s_add_u32 s48, s47, 1024
    buffer_load_dwordx4 v[164:167], v1, s[12:15], s48 offen
    s_add_u32 s48, s47, 4096
    buffer_load_dwordx4 v[168:171], v1, s[12:15], s48 offen
    s_add_u32 s48, s47, 5120
    buffer_load_dwordx4 v[172:175], v1, s[12:15], s48 offen
    s_add_u32 s48, s47, 8192
    buffer_load_dwordx4 v[176:179], v1, s[12:15], s48 offen
    s_add_u32 s48, s47, 9216
    buffer_load_dwordx4 v[180:183], v1, s[12:15], s48 offen
    s_add_u32 s48, s47, 12288
    buffer_load_dwordx4 v[184:187], v1, s[12:15], s48 offen
    s_add_u32 s48, s47, 13312
    buffer_load_dwordx4 v[188:191], v1, s[12:15], s48 offen
    s_waitcnt vmcnt(0)
    v_mfma_f32_32x32x16_bf16 v[16:31], v[128:131], v[192:195], 0
    v_mfma_f32_32x32x16_bf16 v[16:31], v[132:135], v[196:199], v[16:31]
    v_mfma_f32_32x32x16_bf16 v[16:31], v[136:139], v[200:203], v[16:31]
    v_mfma_f32_32x32x16_bf16 v[16:31], v[140:143], v[204:207], v[16:31]
    v_mfma_f32_32x32x16_bf16 v[16:31], v[144:147], v[208:211], v[16:31]
    v_mfma_f32_32x32x16_bf16 v[16:31], v[148:151], v[212:215], v[16:31]
    v_mfma_f32_32x32x16_bf16 v[16:31], v[152:155], v[216:219], v[16:31]
    v_mfma_f32_32x32x16_bf16 v[16:31], v[156:159], v[220:223], v[16:31]
    s_nop 15
    s_nop 3
    v_cmp_ge_i32 vcc, v6, 0
    s_nop 1
    v_cndmask_b32 v16, v8, v16, vcc
    v_cmp_ge_i32 vcc, v6, 1
    s_nop 1
    v_cndmask_b32 v17, v8, v17, vcc
    v_cmp_ge_i32 vcc, v6, 2
    s_nop 1
    v_cndmask_b32 v18, v8, v18, vcc
    v_cmp_ge_i32 vcc, v6, 3
    s_nop 1
    v_cndmask_b32 v19, v8, v19, vcc
    v_cmp_ge_i32 vcc, v6, 8
    s_nop 1
    v_cndmask_b32 v20, v8, v20, vcc
    v_cmp_ge_i32 vcc, v6, 9
    s_nop 1
    v_cndmask_b32 v21, v8, v21, vcc
    v_cmp_ge_i32 vcc, v6, 10
    s_nop 1
    v_cndmask_b32 v22, v8, v22, vcc
    v_cmp_ge_i32 vcc, v6, 11
    s_nop 1
    v_cndmask_b32 v23, v8, v23, vcc
    v_cmp_ge_i32 vcc, v6, 16
    s_nop 1
    v_cndmask_b32 v24, v8, v24, vcc
    v_cmp_ge_i32 vcc, v6, 17
    s_nop 1
    v_cndmask_b32 v25, v8, v25, vcc
    v_cmp_ge_i32 vcc, v6, 18
    s_nop 1
    v_cndmask_b32 v26, v8, v26, vcc
    v_cmp_ge_i32 vcc, v6, 19
    s_nop 1
    v_cndmask_b32 v27, v8, v27, vcc
    v_cmp_ge_i32 vcc, v6, 24
    s_nop 1
    v_cndmask_b32 v28, v8, v28, vcc
    v_cmp_ge_i32 vcc, v6, 25
    s_nop 1
    v_cndmask_b32 v29, v8, v29, vcc
    v_cmp_ge_i32 vcc, v6, 26
    s_nop 1
    v_cndmask_b32 v30, v8, v30, vcc
    v_cmp_ge_i32 vcc, v6, 27
    s_nop 1
    v_cndmask_b32 v31, v8, v31, vcc
    v_mov_b32 v9, v15
    v_max_f32 v9, v9, v16
    v_max_f32 v9, v9, v17
    v_max_f32 v9, v9, v18
    v_max_f32 v9, v9, v19
    v_max_f32 v9, v9, v20
    v_max_f32 v9, v9, v21
    v_max_f32 v9, v9, v22
    v_max_f32 v9, v9, v23
    v_max_f32 v9, v9, v24
    v_max_f32 v9, v9, v25
    v_max_f32 v9, v9, v26
    v_max_f32 v9, v9, v27
    v_max_f32 v9, v9, v28
    v_max_f32 v9, v9, v29
    v_max_f32 v9, v9, v30
    v_max_f32 v9, v9, v31
    v_mov_b32 v14, v9
    s_nop 1
    v_permlane32_swap_b32 v9, v14
    s_nop 1
    v_max_f32 v14, v9, v14
    v_sub_f32 v9, v15, v14
    v_exp_f32 v9, v9
    v_mov_b32 v15, v14
    s_nop 0
    v_mul_f32 v10, v10, v9
    v_sub_f32 v16, v16, v15
    v_exp_f32 v16, v16
    v_sub_f32 v17, v17, v15
    v_exp_f32 v17, v17
    v_sub_f32 v18, v18, v15
    v_exp_f32 v18, v18
    v_sub_f32 v19, v19, v15
    v_exp_f32 v19, v19
    v_sub_f32 v20, v20, v15
    v_exp_f32 v20, v20
    v_sub_f32 v21, v21, v15
    v_exp_f32 v21, v21
    v_sub_f32 v22, v22, v15
    v_exp_f32 v22, v22
    v_sub_f32 v23, v23, v15
    v_exp_f32 v23, v23
    v_sub_f32 v24, v24, v15
    v_exp_f32 v24, v24
    v_sub_f32 v25, v25, v15
    v_exp_f32 v25, v25
    v_sub_f32 v26, v26, v15
    v_exp_f32 v26, v26
    v_sub_f32 v27, v27, v15
    v_exp_f32 v27, v27
    v_sub_f32 v28, v28, v15
    v_exp_f32 v28, v28
    v_sub_f32 v29, v29, v15
    v_exp_f32 v29, v29
    v_sub_f32 v30, v30, v15
    v_exp_f32 v30, v30
    v_sub_f32 v31, v31, v15
    v_exp_f32 v31, v31
    s_nop 0
    v_add_f32 v10, v10, v16
    v_add_f32 v10, v10, v17
    v_add_f32 v10, v10, v18
    v_add_f32 v10, v10, v19
    v_add_f32 v10, v10, v20
    v_add_f32 v10, v10, v21
    v_add_f32 v10, v10, v22
    v_add_f32 v10, v10, v23
    v_add_f32 v10, v10, v24
    v_add_f32 v10, v10, v25
    v_add_f32 v10, v10, v26
    v_add_f32 v10, v10, v27
    v_add_f32 v10, v10, v28
    v_add_f32 v10, v10, v29
    v_add_f32 v10, v10, v30
    v_add_f32 v10, v10, v31
    v_cvt_pk_bf16_f32 v48, v16, v17
    v_cvt_pk_bf16_f32 v49, v18, v19
    v_cvt_pk_bf16_f32 v50, v20, v21
    v_cvt_pk_bf16_f32 v51, v22, v23
    v_cvt_pk_bf16_f32 v52, v24, v25
    v_cvt_pk_bf16_f32 v53, v26, v27
    v_cvt_pk_bf16_f32 v54, v28, v29
    v_cvt_pk_bf16_f32 v55, v30, v31
    v_mul_f32 v64, v64, v9
    v_mul_f32 v65, v65, v9
    v_mul_f32 v66, v66, v9
    v_mul_f32 v67, v67, v9
    v_mul_f32 v68, v68, v9
    v_mul_f32 v69, v69, v9
    v_mul_f32 v70, v70, v9
    v_mul_f32 v71, v71, v9
    v_mul_f32 v72, v72, v9
    v_mul_f32 v73, v73, v9
    v_mul_f32 v74, v74, v9
    v_mul_f32 v75, v75, v9
    v_mul_f32 v76, v76, v9
    v_mul_f32 v77, v77, v9
    v_mul_f32 v78, v78, v9
    v_mul_f32 v79, v79, v9
    v_mul_f32 v80, v80, v9
    v_mul_f32 v81, v81, v9
    v_mul_f32 v82, v82, v9
    v_mul_f32 v83, v83, v9
    v_mul_f32 v84, v84, v9
    v_mul_f32 v85, v85, v9
    v_mul_f32 v86, v86, v9
    v_mul_f32 v87, v87, v9
    v_mul_f32 v88, v88, v9
    v_mul_f32 v89, v89, v9
    v_mul_f32 v90, v90, v9
    v_mul_f32 v91, v91, v9
    v_mul_f32 v92, v92, v9
    v_mul_f32 v93, v93, v9
    v_mul_f32 v94, v94, v9
    v_mul_f32 v95, v95, v9
    v_mul_f32 v96, v96, v9
    v_mul_f32 v97, v97, v9
    v_mul_f32 v98, v98, v9
    v_mul_f32 v99, v99, v9
    v_mul_f32 v100, v100, v9
    v_mul_f32 v101, v101, v9
    v_mul_f32 v102, v102, v9
    v_mul_f32 v103, v103, v9
    v_mul_f32 v104, v104, v9
    v_mul_f32 v105, v105, v9
    v_mul_f32 v106, v106, v9
    v_mul_f32 v107, v107, v9
    v_mul_f32 v108, v108, v9
    v_mul_f32 v109, v109, v9
    v_mul_f32 v110, v110, v9
    v_mul_f32 v111, v111, v9
    v_mul_f32 v112, v112, v9
    v_mul_f32 v113, v113, v9
    v_mul_f32 v114, v114, v9
    v_mul_f32 v115, v115, v9
    v_mul_f32 v116, v116, v9
    v_mul_f32 v117, v117, v9
    v_mul_f32 v118, v118, v9
    v_mul_f32 v119, v119, v9
    v_mul_f32 v120, v120, v9
    v_mul_f32 v121, v121, v9
    v_mul_f32 v122, v122, v9
    v_mul_f32 v123, v123, v9
    v_mul_f32 v124, v124, v9
    v_mul_f32 v125, v125, v9
    v_mul_f32 v126, v126, v9
    v_mul_f32 v127, v127, v9
    s_nop 1
    v_mfma_f32_32x32x16_bf16 v[64:79], v[160:163], v[48:51], v[64:79]
    v_mfma_f32_32x32x16_bf16 v[80:95], v[168:171], v[48:51], v[80:95]
    v_mfma_f32_32x32x16_bf16 v[96:111], v[176:179], v[48:51], v[96:111]
    v_mfma_f32_32x32x16_bf16 v[112:127], v[184:187], v[48:51], v[112:127]
    v_mfma_f32_32x32x16_bf16 v[64:79], v[164:167], v[52:55], v[64:79]
    v_mfma_f32_32x32x16_bf16 v[80:95], v[172:175], v[52:55], v[80:95]
    v_mfma_f32_32x32x16_bf16 v[96:111], v[180:183], v[52:55], v[96:111]
    v_mfma_f32_32x32x16_bf16 v[112:127], v[188:191], v[52:55], v[112:127]
    s_nop 15
    s_nop 3
    v_subrev_u32 v6, 32, v6
    s_add_u32 s29, s29, 1
    s_cmp_lt_u32 s29, s28
    s_cbranch_scc1 at_slow_loop0
    v_mov_b32 v11, v10
    s_nop 1
    v_permlane32_swap_b32 v10, v11
    s_nop 1
    v_add_f32 v10, v10, v11
    v_rcp_f32 v10, v10
    s_nop 0
    v_mul_f32 v64, v64, v10
    v_mul_f32 v65, v65, v10
    v_mul_f32 v66, v66, v10
    v_mul_f32 v67, v67, v10
    v_mul_f32 v68, v68, v10
    v_mul_f32 v69, v69, v10
    v_mul_f32 v70, v70, v10
    v_mul_f32 v71, v71, v10
    v_mul_f32 v72, v72, v10
    v_mul_f32 v73, v73, v10
    v_mul_f32 v74, v74, v10
    v_mul_f32 v75, v75, v10
    v_mul_f32 v76, v76, v10
    v_mul_f32 v77, v77, v10
    v_mul_f32 v78, v78, v10
    v_mul_f32 v79, v79, v10
    v_cvt_pk_bf16_f32 v64, v64, v65
    v_cvt_pk_bf16_f32 v65, v66, v67
    v_cvt_pk_bf16_f32 v66, v68, v69
    v_cvt_pk_bf16_f32 v67, v70, v71
    v_cvt_pk_bf16_f32 v68, v72, v73
    v_cvt_pk_bf16_f32 v69, v74, v75
    v_cvt_pk_bf16_f32 v70, v76, v77
    v_cvt_pk_bf16_f32 v71, v78, v79
    s_add_u32 s38, s36, 0
    buffer_store_dwordx4 v[64:67], v1, s[16:19], s38 offen offset:0 sc0 sc1
    buffer_store_dwordx4 v[68:71], v1, s[16:19], s38 offen offset:1024 sc0 sc1
    v_mul_f32 v80, v80, v10
    v_mul_f32 v81, v81, v10
    v_mul_f32 v82, v82, v10
    v_mul_f32 v83, v83, v10
    v_mul_f32 v84, v84, v10
    v_mul_f32 v85, v85, v10
    v_mul_f32 v86, v86, v10
    v_mul_f32 v87, v87, v10
    v_mul_f32 v88, v88, v10
    v_mul_f32 v89, v89, v10
    v_mul_f32 v90, v90, v10
    v_mul_f32 v91, v91, v10
    v_mul_f32 v92, v92, v10
    v_mul_f32 v93, v93, v10
    v_mul_f32 v94, v94, v10
    v_mul_f32 v95, v95, v10
    v_cvt_pk_bf16_f32 v80, v80, v81
    v_cvt_pk_bf16_f32 v81, v82, v83
    v_cvt_pk_bf16_f32 v82, v84, v85
    v_cvt_pk_bf16_f32 v83, v86, v87
    v_cvt_pk_bf16_f32 v84, v88, v89
    v_cvt_pk_bf16_f32 v85, v90, v91
    v_cvt_pk_bf16_f32 v86, v92, v93
    v_cvt_pk_bf16_f32 v87, v94, v95
    s_add_u32 s38, s36, 2048
    buffer_store_dwordx4 v[80:83], v1, s[16:19], s38 offen offset:0 sc0 sc1
    buffer_store_dwordx4 v[84:87], v1, s[16:19], s38 offen offset:1024 sc0 sc1
    v_mul_f32 v96, v96, v10
    v_mul_f32 v97, v97, v10
    v_mul_f32 v98, v98, v10
    v_mul_f32 v99, v99, v10
    v_mul_f32 v100, v100, v10
    v_mul_f32 v101, v101, v10
    v_mul_f32 v102, v102, v10
    v_mul_f32 v103, v103, v10
    v_mul_f32 v104, v104, v10
    v_mul_f32 v105, v105, v10
    v_mul_f32 v106, v106, v10
    v_mul_f32 v107, v107, v10
    v_mul_f32 v108, v108, v10
    v_mul_f32 v109, v109, v10
    v_mul_f32 v110, v110, v10
    v_mul_f32 v111, v111, v10
    v_cvt_pk_bf16_f32 v96, v96, v97
    v_cvt_pk_bf16_f32 v97, v98, v99
    v_cvt_pk_bf16_f32 v98, v100, v101
    v_cvt_pk_bf16_f32 v99, v102, v103
    v_cvt_pk_bf16_f32 v100, v104, v105
    v_cvt_pk_bf16_f32 v101, v106, v107
    v_cvt_pk_bf16_f32 v102, v108, v109
    v_cvt_pk_bf16_f32 v103, v110, v111
    s_add_u32 s38, s36, 4096
    buffer_store_dwordx4 v[96:99], v1, s[16:19], s38 offen offset:0 sc0 sc1
    buffer_store_dwordx4 v[100:103], v1, s[16:19], s38 offen offset:1024 sc0 sc1
    v_mul_f32 v112, v112, v10
    v_mul_f32 v113, v113, v10
    v_mul_f32 v114, v114, v10
    v_mul_f32 v115, v115, v10
    v_mul_f32 v116, v116, v10
    v_mul_f32 v117, v117, v10
    v_mul_f32 v118, v118, v10
    v_mul_f32 v119, v119, v10
    v_mul_f32 v120, v120, v10
    v_mul_f32 v121, v121, v10
    v_mul_f32 v122, v122, v10
    v_mul_f32 v123, v123, v10
    v_mul_f32 v124, v124, v10
    v_mul_f32 v125, v125, v10
    v_mul_f32 v126, v126, v10
    v_mul_f32 v127, v127, v10
    v_cvt_pk_bf16_f32 v112, v112, v113
    v_cvt_pk_bf16_f32 v113, v114, v115
    v_cvt_pk_bf16_f32 v114, v116, v117
    v_cvt_pk_bf16_f32 v115, v118, v119
    v_cvt_pk_bf16_f32 v116, v120, v121
    v_cvt_pk_bf16_f32 v117, v122, v123
    v_cvt_pk_bf16_f32 v118, v124, v125
    v_cvt_pk_bf16_f32 v119, v126, v127
    s_add_u32 s38, s36, 6144
    buffer_store_dwordx4 v[112:115], v1, s[16:19], s38 offen offset:0 sc0 sc1
    buffer_store_dwordx4 v[116:119], v1, s[16:19], s38 offen offset:1024 sc0 sc1
    s_waitcnt vmcnt(0)
at_slow_skip0:
    s_and_b32 s38, s30, 2
    s_cmp_eq_u32 s38, 0
    s_cbranch_scc1 at_slow_skip1
    v_mov_b32 v15, v8
    v_mov_b32 v10, 0
    v_mov_b32 v64, 0
    v_mov_b32 v65, 0
    v_mov_b32 v66, 0
    v_mov_b32 v67, 0
    v_mov_b32 v68, 0
    v_mov_b32 v69, 0
    v_mov_b32 v70, 0
    v_mov_b32 v71, 0
    v_mov_b32 v72, 0
    v_mov_b32 v73, 0
    v_mov_b32 v74, 0
    v_mov_b32 v75, 0
    v_mov_b32 v76, 0
    v_mov_b32 v77, 0
    v_mov_b32 v78, 0
    v_mov_b32 v79, 0
    v_mov_b32 v80, 0
    v_mov_b32 v81, 0
    v_mov_b32 v82, 0
    v_mov_b32 v83, 0
    v_mov_b32 v84, 0
    v_mov_b32 v85, 0
    v_mov_b32 v86, 0
    v_mov_b32 v87, 0
    v_mov_b32 v88, 0
    v_mov_b32 v89, 0
    v_mov_b32 v90, 0
    v_mov_b32 v91, 0
    v_mov_b32 v92, 0
    v_mov_b32 v93, 0
    v_mov_b32 v94, 0
    v_mov_b32 v95, 0
    v_mov_b32 v96, 0
    v_mov_b32 v97, 0
    v_mov_b32 v98, 0
    v_mov_b32 v99, 0
    v_mov_b32 v100, 0
    v_mov_b32 v101, 0
    v_mov_b32 v102, 0
    v_mov_b32 v103, 0
    v_mov_b32 v104, 0
    v_mov_b32 v105, 0
    v_mov_b32 v106, 0
    v_mov_b32 v107, 0
    v_mov_b32 v108, 0
    v_mov_b32 v109, 0
    v_mov_b32 v110, 0
    v_mov_b32 v111, 0
    v_mov_b32 v112, 0
    v_mov_b32 v113, 0
    v_mov_b32 v114, 0
    v_mov_b32 v115, 0
    v_mov_b32 v116, 0
    v_mov_b32 v117, 0
    v_mov_b32 v118, 0
    v_mov_b32 v119, 0
    v_mov_b32 v120, 0
    v_mov_b32 v121, 0
    v_mov_b32 v122, 0
    v_mov_b32 v123, 0
    v_mov_b32 v124, 0
    v_mov_b32 v125, 0
    v_mov_b32 v126, 0
    v_mov_b32 v127, 0
    s_mov_b32 s29, 0
    s_lshl_b32 s28, s23, 2
    s_add_u32 s28, s28, 4
    s_lshl_b32 s39, s23, 7
    v_add_u32 v6, s39, v7
at_slow_loop1:
    s_lshr_b32 s38, s29, 1
    s_lshl_b32 s38, s38, 15
    s_and_b32 s39, s29, 1
    s_lshl_b32 s46, s39, 13
    s_add_u32 s46, s46, s38
    s_lshl_b32 s47, s39, 11
    s_add_u32 s47, s47, s38
    s_add_u32 s47, s47, 16384
    s_add_u32 s48, s46, 0
    buffer_load_dwordx4 v[128:131], v1, s[12:15], s48 offen
    s_add_u32 s48, s46, 1024
    buffer_load_dwordx4 v[132:135], v1, s[12:15], s48 offen
    s_add_u32 s48, s46, 2048
    buffer_load_dwordx4 v[136:139], v1, s[12:15], s48 offen
    s_add_u32 s48, s46, 3072
    buffer_load_dwordx4 v[140:143], v1, s[12:15], s48 offen
    s_add_u32 s48, s46, 4096
    buffer_load_dwordx4 v[144:147], v1, s[12:15], s48 offen
    s_add_u32 s48, s46, 5120
    buffer_load_dwordx4 v[148:151], v1, s[12:15], s48 offen
    s_add_u32 s48, s46, 6144
    buffer_load_dwordx4 v[152:155], v1, s[12:15], s48 offen
    s_add_u32 s48, s46, 7168
    buffer_load_dwordx4 v[156:159], v1, s[12:15], s48 offen
    s_add_u32 s48, s47, 0
    buffer_load_dwordx4 v[160:163], v1, s[12:15], s48 offen
    s_add_u32 s48, s47, 1024
    buffer_load_dwordx4 v[164:167], v1, s[12:15], s48 offen
    s_add_u32 s48, s47, 4096
    buffer_load_dwordx4 v[168:171], v1, s[12:15], s48 offen
    s_add_u32 s48, s47, 5120
    buffer_load_dwordx4 v[172:175], v1, s[12:15], s48 offen
    s_add_u32 s48, s47, 8192
    buffer_load_dwordx4 v[176:179], v1, s[12:15], s48 offen
    s_add_u32 s48, s47, 9216
    buffer_load_dwordx4 v[180:183], v1, s[12:15], s48 offen
    s_add_u32 s48, s47, 12288
    buffer_load_dwordx4 v[184:187], v1, s[12:15], s48 offen
    s_add_u32 s48, s47, 13312
    buffer_load_dwordx4 v[188:191], v1, s[12:15], s48 offen
    s_waitcnt vmcnt(0)
    v_mfma_f32_32x32x16_bf16 v[16:31], v[128:131], v[224:227], 0
    v_mfma_f32_32x32x16_bf16 v[16:31], v[132:135], v[228:231], v[16:31]
    v_mfma_f32_32x32x16_bf16 v[16:31], v[136:139], v[232:235], v[16:31]
    v_mfma_f32_32x32x16_bf16 v[16:31], v[140:143], v[236:239], v[16:31]
    v_mfma_f32_32x32x16_bf16 v[16:31], v[144:147], v[240:243], v[16:31]
    v_mfma_f32_32x32x16_bf16 v[16:31], v[148:151], v[244:247], v[16:31]
    v_mfma_f32_32x32x16_bf16 v[16:31], v[152:155], v[248:251], v[16:31]
    v_mfma_f32_32x32x16_bf16 v[16:31], v[156:159], v[252:255], v[16:31]
    s_nop 15
    s_nop 3
    v_cmp_ge_i32 vcc, v6, 0
    s_nop 1
    v_cndmask_b32 v16, v8, v16, vcc
    v_cmp_ge_i32 vcc, v6, 1
    s_nop 1
    v_cndmask_b32 v17, v8, v17, vcc
    v_cmp_ge_i32 vcc, v6, 2
    s_nop 1
    v_cndmask_b32 v18, v8, v18, vcc
    v_cmp_ge_i32 vcc, v6, 3
    s_nop 1
    v_cndmask_b32 v19, v8, v19, vcc
    v_cmp_ge_i32 vcc, v6, 8
    s_nop 1
    v_cndmask_b32 v20, v8, v20, vcc
    v_cmp_ge_i32 vcc, v6, 9
    s_nop 1
    v_cndmask_b32 v21, v8, v21, vcc
    v_cmp_ge_i32 vcc, v6, 10
    s_nop 1
    v_cndmask_b32 v22, v8, v22, vcc
    v_cmp_ge_i32 vcc, v6, 11
    s_nop 1
    v_cndmask_b32 v23, v8, v23, vcc
    v_cmp_ge_i32 vcc, v6, 16
    s_nop 1
    v_cndmask_b32 v24, v8, v24, vcc
    v_cmp_ge_i32 vcc, v6, 17
    s_nop 1
    v_cndmask_b32 v25, v8, v25, vcc
    v_cmp_ge_i32 vcc, v6, 18
    s_nop 1
    v_cndmask_b32 v26, v8, v26, vcc
    v_cmp_ge_i32 vcc, v6, 19
    s_nop 1
    v_cndmask_b32 v27, v8, v27, vcc
    v_cmp_ge_i32 vcc, v6, 24
    s_nop 1
    v_cndmask_b32 v28, v8, v28, vcc
    v_cmp_ge_i32 vcc, v6, 25
    s_nop 1
    v_cndmask_b32 v29, v8, v29, vcc
    v_cmp_ge_i32 vcc, v6, 26
    s_nop 1
    v_cndmask_b32 v30, v8, v30, vcc
    v_cmp_ge_i32 vcc, v6, 27
    s_nop 1
    v_cndmask_b32 v31, v8, v31, vcc
    v_mov_b32 v9, v15
    v_max_f32 v9, v9, v16
    v_max_f32 v9, v9, v17
    v_max_f32 v9, v9, v18
    v_max_f32 v9, v9, v19
    v_max_f32 v9, v9, v20
    v_max_f32 v9, v9, v21
    v_max_f32 v9, v9, v22
    v_max_f32 v9, v9, v23
    v_max_f32 v9, v9, v24
    v_max_f32 v9, v9, v25
    v_max_f32 v9, v9, v26
    v_max_f32 v9, v9, v27
    v_max_f32 v9, v9, v28
    v_max_f32 v9, v9, v29
    v_max_f32 v9, v9, v30
    v_max_f32 v9, v9, v31
    v_mov_b32 v14, v9
    s_nop 1
    v_permlane32_swap_b32 v9, v14
    s_nop 1
    v_max_f32 v14, v9, v14
    v_sub_f32 v9, v15, v14
    v_exp_f32 v9, v9
    v_mov_b32 v15, v14
    s_nop 0
    v_mul_f32 v10, v10, v9
    v_sub_f32 v16, v16, v15
    v_exp_f32 v16, v16
    v_sub_f32 v17, v17, v15
    v_exp_f32 v17, v17
    v_sub_f32 v18, v18, v15
    v_exp_f32 v18, v18
    v_sub_f32 v19, v19, v15
    v_exp_f32 v19, v19
    v_sub_f32 v20, v20, v15
    v_exp_f32 v20, v20
    v_sub_f32 v21, v21, v15
    v_exp_f32 v21, v21
    v_sub_f32 v22, v22, v15
    v_exp_f32 v22, v22
    v_sub_f32 v23, v23, v15
    v_exp_f32 v23, v23
    v_sub_f32 v24, v24, v15
    v_exp_f32 v24, v24
    v_sub_f32 v25, v25, v15
    v_exp_f32 v25, v25
    v_sub_f32 v26, v26, v15
    v_exp_f32 v26, v26
    v_sub_f32 v27, v27, v15
    v_exp_f32 v27, v27
    v_sub_f32 v28, v28, v15
    v_exp_f32 v28, v28
    v_sub_f32 v29, v29, v15
    v_exp_f32 v29, v29
    v_sub_f32 v30, v30, v15
    v_exp_f32 v30, v30
    v_sub_f32 v31, v31, v15
    v_exp_f32 v31, v31
    s_nop 0
    v_add_f32 v10, v10, v16
    v_add_f32 v10, v10, v17
    v_add_f32 v10, v10, v18
    v_add_f32 v10, v10, v19
    v_add_f32 v10, v10, v20
    v_add_f32 v10, v10, v21
    v_add_f32 v10, v10, v22
    v_add_f32 v10, v10, v23
    v_add_f32 v10, v10, v24
    v_add_f32 v10, v10, v25
    v_add_f32 v10, v10, v26
    v_add_f32 v10, v10, v27
    v_add_f32 v10, v10, v28
    v_add_f32 v10, v10, v29
    v_add_f32 v10, v10, v30
    v_add_f32 v10, v10, v31
    v_cvt_pk_bf16_f32 v48, v16, v17
    v_cvt_pk_bf16_f32 v49, v18, v19
    v_cvt_pk_bf16_f32 v50, v20, v21
    v_cvt_pk_bf16_f32 v51, v22, v23
    v_cvt_pk_bf16_f32 v52, v24, v25
    v_cvt_pk_bf16_f32 v53, v26, v27
    v_cvt_pk_bf16_f32 v54, v28, v29
    v_cvt_pk_bf16_f32 v55, v30, v31
    v_mul_f32 v64, v64, v9
    v_mul_f32 v65, v65, v9
    v_mul_f32 v66, v66, v9
    v_mul_f32 v67, v67, v9
    v_mul_f32 v68, v68, v9
    v_mul_f32 v69, v69, v9
    v_mul_f32 v70, v70, v9
    v_mul_f32 v71, v71, v9
    v_mul_f32 v72, v72, v9
    v_mul_f32 v73, v73, v9
    v_mul_f32 v74, v74, v9
    v_mul_f32 v75, v75, v9
    v_mul_f32 v76, v76, v9
    v_mul_f32 v77, v77, v9
    v_mul_f32 v78, v78, v9
    v_mul_f32 v79, v79, v9
    v_mul_f32 v80, v80, v9
    v_mul_f32 v81, v81, v9
    v_mul_f32 v82, v82, v9
    v_mul_f32 v83, v83, v9
    v_mul_f32 v84, v84, v9
    v_mul_f32 v85, v85, v9
    v_mul_f32 v86, v86, v9
    v_mul_f32 v87, v87, v9
    v_mul_f32 v88, v88, v9
    v_mul_f32 v89, v89, v9
    v_mul_f32 v90, v90, v9
    v_mul_f32 v91, v91, v9
    v_mul_f32 v92, v92, v9
    v_mul_f32 v93, v93, v9
    v_mul_f32 v94, v94, v9
    v_mul_f32 v95, v95, v9
    v_mul_f32 v96, v96, v9
    v_mul_f32 v97, v97, v9
    v_mul_f32 v98, v98, v9
    v_mul_f32 v99, v99, v9
    v_mul_f32 v100, v100, v9
    v_mul_f32 v101, v101, v9
    v_mul_f32 v102, v102, v9
    v_mul_f32 v103, v103, v9
    v_mul_f32 v104, v104, v9
    v_mul_f32 v105, v105, v9
    v_mul_f32 v106, v106, v9
    v_mul_f32 v107, v107, v9
    v_mul_f32 v108, v108, v9
    v_mul_f32 v109, v109, v9
    v_mul_f32 v110, v110, v9
    v_mul_f32 v111, v111, v9
    v_mul_f32 v112, v112, v9
    v_mul_f32 v113, v113, v9
    v_mul_f32 v114, v114, v9
    v_mul_f32 v115, v115, v9
    v_mul_f32 v116, v116, v9
    v_mul_f32 v117, v117, v9
    v_mul_f32 v118, v118, v9
    v_mul_f32 v119, v119, v9
    v_mul_f32 v120, v120, v9
    v_mul_f32 v121, v121, v9
    v_mul_f32 v122, v122, v9
    v_mul_f32 v123, v123, v9
    v_mul_f32 v124, v124, v9
    v_mul_f32 v125, v125, v9
    v_mul_f32 v126, v126, v9
    v_mul_f32 v127, v127, v9
    s_nop 1
    v_mfma_f32_32x32x16_bf16 v[64:79], v[160:163], v[48:51], v[64:79]
    v_mfma_f32_32x32x16_bf16 v[80:95], v[168:171], v[48:51], v[80:95]
    v_mfma_f32_32x32x16_bf16 v[96:111], v[176:179], v[48:51], v[96:111]
    v_mfma_f32_32x32x16_bf16 v[112:127], v[184:187], v[48:51], v[112:127]
    v_mfma_f32_32x32x16_bf16 v[64:79], v[164:167], v[52:55], v[64:79]
    v_mfma_f32_32x32x16_bf16 v[80:95], v[172:175], v[52:55], v[80:95]
    v_mfma_f32_32x32x16_bf16 v[96:111], v[180:183], v[52:55], v[96:111]
    v_mfma_f32_32x32x16_bf16 v[112:127], v[188:191], v[52:55], v[112:127]
    s_nop 15
    s_nop 3
    v_subrev_u32 v6, 32, v6
    s_add_u32 s29, s29, 1
    s_cmp_lt_u32 s29, s28
    s_cbranch_scc1 at_slow_loop1
    v_mov_b32 v11, v10
    s_nop 1
    v_permlane32_swap_b32 v10, v11
    s_nop 1
    v_add_f32 v10, v10, v11
    v_rcp_f32 v10, v10
    s_nop 0
    v_mul_f32 v64, v64, v10
    v_mul_f32 v65, v65, v10
    v_mul_f32 v66, v66, v10
    v_mul_f32 v67, v67, v10
    v_mul_f32 v68, v68, v10
    v_mul_f32 v69, v69, v10
    v_mul_f32 v70, v70, v10
    v_mul_f32 v71, v71, v10
    v_mul_f32 v72, v72, v10
    v_mul_f32 v73, v73, v10
    v_mul_f32 v74, v74, v10
    v_mul_f32 v75, v75, v10
    v_mul_f32 v76, v76, v10
    v_mul_f32 v77, v77, v10
    v_mul_f32 v78, v78, v10
    v_mul_f32 v79, v79, v10
    v_cvt_pk_bf16_f32 v64, v64, v65
    v_cvt_pk_bf16_f32 v65, v66, v67
    v_cvt_pk_bf16_f32 v66, v68, v69
    v_cvt_pk_bf16_f32 v67, v70, v71
    v_cvt_pk_bf16_f32 v68, v72, v73
    v_cvt_pk_bf16_f32 v69, v74, v75
    v_cvt_pk_bf16_f32 v70, v76, v77
    v_cvt_pk_bf16_f32 v71, v78, v79
    s_add_u32 s38, s37, 0
    buffer_store_dwordx4 v[64:67], v1, s[16:19], s38 offen offset:0 sc0 sc1
    buffer_store_dwordx4 v[68:71], v1, s[16:19], s38 offen offset:1024 sc0 sc1
    v_mul_f32 v80, v80, v10
    v_mul_f32 v81, v81, v10
    v_mul_f32 v82, v82, v10
    v_mul_f32 v83, v83, v10
    v_mul_f32 v84, v84, v10
    v_mul_f32 v85, v85, v10
    v_mul_f32 v86, v86, v10
    v_mul_f32 v87, v87, v10
    v_mul_f32 v88, v88, v10
    v_mul_f32 v89, v89, v10
    v_mul_f32 v90, v90, v10
    v_mul_f32 v91, v91, v10
    v_mul_f32 v92, v92, v10
    v_mul_f32 v93, v93, v10
    v_mul_f32 v94, v94, v10
    v_mul_f32 v95, v95, v10
    v_cvt_pk_bf16_f32 v80, v80, v81
    v_cvt_pk_bf16_f32 v81, v82, v83
    v_cvt_pk_bf16_f32 v82, v84, v85
    v_cvt_pk_bf16_f32 v83, v86, v87
    v_cvt_pk_bf16_f32 v84, v88, v89
    v_cvt_pk_bf16_f32 v85, v90, v91
    v_cvt_pk_bf16_f32 v86, v92, v93
    v_cvt_pk_bf16_f32 v87, v94, v95
    s_add_u32 s38, s37, 2048
    buffer_store_dwordx4 v[80:83], v1, s[16:19], s38 offen offset:0 sc0 sc1
    buffer_store_dwordx4 v[84:87], v1, s[16:19], s38 offen offset:1024 sc0 sc1
    v_mul_f32 v96, v96, v10
    v_mul_f32 v97, v97, v10
    v_mul_f32 v98, v98, v10
    v_mul_f32 v99, v99, v10
    v_mul_f32 v100, v100, v10
    v_mul_f32 v101, v101, v10
    v_mul_f32 v102, v102, v10
    v_mul_f32 v103, v103, v10
    v_mul_f32 v104, v104, v10
    v_mul_f32 v105, v105, v10
    v_mul_f32 v106, v106, v10
    v_mul_f32 v107, v107, v10
    v_mul_f32 v108, v108, v10
    v_mul_f32 v109, v109, v10
    v_mul_f32 v110, v110, v10
    v_mul_f32 v111, v111, v10
    v_cvt_pk_bf16_f32 v96, v96, v97
    v_cvt_pk_bf16_f32 v97, v98, v99
    v_cvt_pk_bf16_f32 v98, v100, v101
    v_cvt_pk_bf16_f32 v99, v102, v103
    v_cvt_pk_bf16_f32 v100, v104, v105
    v_cvt_pk_bf16_f32 v101, v106, v107
    v_cvt_pk_bf16_f32 v102, v108, v109
    v_cvt_pk_bf16_f32 v103, v110, v111
    s_add_u32 s38, s37, 4096
    buffer_store_dwordx4 v[96:99], v1, s[16:19], s38 offen offset:0 sc0 sc1
    buffer_store_dwordx4 v[100:103], v1, s[16:19], s38 offen offset:1024 sc0 sc1
    v_mul_f32 v112, v112, v10
    v_mul_f32 v113, v113, v10
    v_mul_f32 v114, v114, v10
    v_mul_f32 v115, v115, v10
    v_mul_f32 v116, v116, v10
    v_mul_f32 v117, v117, v10
    v_mul_f32 v118, v118, v10
    v_mul_f32 v119, v119, v10
    v_mul_f32 v120, v120, v10
    v_mul_f32 v121, v121, v10
    v_mul_f32 v122, v122, v10
    v_mul_f32 v123, v123, v10
    v_mul_f32 v124, v124, v10
    v_mul_f32 v125, v125, v10
    v_mul_f32 v126, v126, v10
    v_mul_f32 v127, v127, v10
    v_cvt_pk_bf16_f32 v112, v112, v113
    v_cvt_pk_bf16_f32 v113, v114, v115
    v_cvt_pk_bf16_f32 v114, v116, v117
    v_cvt_pk_bf16_f32 v115, v118, v119
    v_cvt_pk_bf16_f32 v116, v120, v121
    v_cvt_pk_bf16_f32 v117, v122, v123
    v_cvt_pk_bf16_f32 v118, v124, v125
    v_cvt_pk_bf16_f32 v119, v126, v127
    s_add_u32 s38, s37, 6144
    buffer_store_dwordx4 v[112:115], v1, s[16:19], s38 offen offset:0 sc0 sc1
    buffer_store_dwordx4 v[116:119], v1, s[16:19], s38 offen offset:1024 sc0 sc1
    s_waitcnt vmcnt(0)
at_slow_skip1:
at_done:
    s_load_dwordx2 s[62:63], s[0:1], 40
    s_load_dwordx2 s[64:65], s[0:1], 56
    s_load_dwordx2 s[66:67], s[0:1], 64
    s_load_dwordx2 s[68:69], s[0:1], 104
    s_load_dwordx2 s[70:71], s[0:1], 88
    s_and_b32 s60, s2, 7
    s_lshl_b32 s60, s60, 1
    s_lshr_b32 s61, s2, 3
    s_and_b32 s38, s61, 1
    s_add_u32 s60, s60, s38
    s_lshr_b32 s61, s61, 1
    s_lshr_b32 s51, s2, 1
    s_and_b32 s51, s51, 3
    s_lshl_b32 s51, s51, 2
    s_lshr_b32 s38, s2, 3
    s_and_b32 s38, s38, 3
    s_add_u32 s51, s51, s38
    s_waitcnt lgkmcnt(0)
    v_lshlrev_b32 v1, 4, v0
    s_waitcnt vmcnt(0)
    s_barrier
    s_barrier
    s_mov_b32 s30, s51
    s_lshr_b32 s31, s2, 5
    s_and_b32 s31, s31, 3
    s_and_b32 s32, s2, 1
    s_lshl_b32 s32, s32, 1
    s_lshr_b32 s38, s2, 7
    s_add_u32 s32, s32, s38
    s_lshl_b32 s32, s32, 10
    v_lshrrev_b32 v9, 4, v0
    v_and_b32 v10, 15, v0
    v_lshrrev_b32 v11, 1, v9
    v_lshrrev_b32 v12, 2, v10
    v_lshl_add_u32 v11, v11, 2, v12
    v_lshlrev_b32 v11, 8, v11
    v_and_b32 v13, 1, v9
    v_lshl_add_u32 v11, v13, 5, v11
    v_and_b32 v13, 3, v10
    v_lshl_add_u32 v11, v13, 3, v11
    s_lshr_b32 s36, s20, 1
    s_lshl_b32 s36, s36, 1
    v_xor_b32 v13, s36, v12
    v_lshl_add_u32 v2, v13, 6, v11
    s_add_u32 s36, s36, 1
    v_xor_b32 v13, s36, v12
    v_lshl_add_u32 v3, v13, 6, v11
    s_and_b32 s36, s20, 1
    s_lshl_b32 s36, s36, 13
    s_add_u32 s36, s36, 16384
    v_add_u32 v4, s36, v1
    s_add_u32 s12, s68, 67108864
    s_addc_u32 s13, s69, 0
    s_mov_b32 s14, 8388608
    s_mov_b32 s15, 0x00020000
    s_barrier
    v_add_u32 v5, 65536, v2
    v_add_u32 v6, 65536, v3
    v_add_u32 v7, 65536, v4
    ds_read_b128 v[32:35], v7 offset:0
    ds_read_b128 v[36:39], v7 offset:4096
    ds_read_b64_tr_b16 v[16:17], v5 offset:0
    ds_read_b64_tr_b16 v[18:19], v5 offset:2048
    ds_read_b64_tr_b16 v[20:21], v6 offset:0
    ds_read_b64_tr_b16 v[22:23], v6 offset:2048
    ds_read_b128 v[40:43], v7 offset:1024
    ds_read_b128 v[44:47], v7 offset:5120
    ds_read_b64_tr_b16 v[24:25], v5 offset:4096
    ds_read_b64_tr_b16 v[26:27], v5 offset:6144
    ds_read_b64_tr_b16 v[28:29], v6 offset:4096
    ds_read_b64_tr_b16 v[30:31], v6 offset:6144
    s_waitcnt lgkmcnt(0)
    v_mfma_f32_32x32x16_bf16 v[48:63], v[16:19], v[32:35], 0
    ds_read_b128 v[128:131], v7 offset:2048
    ds_read_b128 v[132:135], v7 offset:6144
    v_mfma_f32_32x32x16_bf16 v[64:79], v[20:23], v[32:35], 0
    ds_read_b64_tr_b16 v[112:113], v5 offset:8192
    ds_read_b64_tr_b16 v[114:115], v5 offset:10240
    v_mfma_f32_32x32x16_bf16 v[80:95], v[16:19], v[36:39], 0
    ds_read_b64_tr_b16 v[116:117], v6 offset:8192
    ds_read_b64_tr_b16 v[118:119], v6 offset:10240
    v_mfma_f32_32x32x16_bf16 v[96:111], v[20:23], v[36:39], 0
    ds_read_b128 v[136:139], v7 offset:3072
    ds_read_b128 v[140:143], v7 offset:7168
    v_mfma_f32_32x32x16_bf16 v[48:63], v[24:27], v[40:43], v[48:63]
    ds_read_b64_tr_b16 v[120:121], v5 offset:12288
    ds_read_b64_tr_b16 v[122:123], v5 offset:14336
    v_mfma_f32_32x32x16_bf16 v[64:79], v[28:31], v[40:43], v[64:79]
    ds_read_b64_tr_b16 v[124:125], v6 offset:12288
    ds_read_b64_tr_b16 v[126:127], v6 offset:14336
    v_mfma_f32_32x32x16_bf16 v[80:95], v[24:27], v[44:47], v[80:95]
    v_mfma_f32_32x32x16_bf16 v[96:111], v[28:31], v[44:47], v[96:111]
    s_waitcnt lgkmcnt(0)
    s_barrier
    v_mfma_f32_32x32x16_bf16 v[48:63], v[112:115], v[128:131], v[48:63]
    v_add_u32 v5, 98304, v2
    v_add_u32 v6, 98304, v3
    v_add_u32 v7, 98304, v4
    v_mfma_f32_32x32x16_bf16 v[64:79], v[116:119], v[128:131], v[64:79]
    ds_read_b128 v[32:35], v7 offset:0
    ds_read_b128 v[36:39], v7 offset:4096
    ds_read_b64_tr_b16 v[16:17], v5 offset:0
    v_mfma_f32_32x32x16_bf16 v[80:95], v[112:115], v[132:135], v[80:95]
    ds_read_b64_tr_b16 v[18:19], v5 offset:2048
    ds_read_b64_tr_b16 v[20:21], v6 offset:0
    ds_read_b64_tr_b16 v[22:23], v6 offset:2048
    v_mfma_f32_32x32x16_bf16 v[96:111], v[116:119], v[132:135], v[96:111]
    ds_read_b128 v[40:43], v7 offset:1024
    ds_read_b128 v[44:47], v7 offset:5120
    ds_read_b64_tr_b16 v[24:25], v5 offset:4096
    v_mfma_f32_32x32x16_bf16 v[48:63], v[120:123], v[136:139], v[48:63]
    ds_read_b64_tr_b16 v[26:27], v5 offset:6144
    ds_read_b64_tr_b16 v[28:29], v6 offset:4096
    ds_read_b64_tr_b16 v[30:31], v6 offset:6144
    v_mfma_f32_32x32x16_bf16 v[64:79], v[124:127], v[136:139], v[64:79]
    v_mfma_f32_32x32x16_bf16 v[80:95], v[120:123], v[140:143], v[80:95]
    v_mfma_f32_32x32x16_bf16 v[96:111], v[124:127], v[140:143], v[96:111]
    s_waitcnt lgkmcnt(0)
    v_mfma_f32_32x32x16_bf16 v[48:63], v[16:19], v[32:35], v[48:63]
    ds_read_b128 v[128:131], v7 offset:2048
    ds_read_b128 v[132:135], v7 offset:6144
    v_mfma_f32_32x32x16_bf16 v[64:79], v[20:23], v[32:35], v[64:79]
    ds_read_b64_tr_b16 v[112:113], v5 offset:8192
    ds_read_b64_tr_b16 v[114:115], v5 offset:10240
    v_mfma_f32_32x32x16_bf16 v[80:95], v[16:19], v[36:39], v[80:95]
    ds_read_b64_tr_b16 v[116:117], v6 offset:8192
    ds_read_b64_tr_b16 v[118:119], v6 offset:10240
    v_mfma_f32_32x32x16_bf16 v[96:111], v[20:23], v[36:39], v[96:111]
    ds_read_b128 v[136:139], v7 offset:3072
    ds_read_b128 v[140:143], v7 offset:7168
    v_mfma_f32_32x32x16_bf16 v[48:63], v[24:27], v[40:43], v[48:63]
    ds_read_b64_tr_b16 v[120:121], v5 offset:12288
    ds_read_b64_tr_b16 v[122:123], v5 offset:14336
    v_mfma_f32_32x32x16_bf16 v[64:79], v[28:31], v[40:43], v[64:79]
    ds_read_b64_tr_b16 v[124:125], v6 offset:12288
    ds_read_b64_tr_b16 v[126:127], v6 offset:14336
    v_mfma_f32_32x32x16_bf16 v[80:95], v[24:27], v[44:47], v[80:95]
    v_mfma_f32_32x32x16_bf16 v[96:111], v[28:31], v[44:47], v[96:111]
    s_waitcnt lgkmcnt(0)
    s_barrier
    v_mfma_f32_32x32x16_bf16 v[48:63], v[112:115], v[128:131], v[48:63]
    v_add_u32 v5, 131072, v2
    v_add_u32 v6, 131072, v3
    v_add_u32 v7, 131072, v4
    v_mfma_f32_32x32x16_bf16 v[64:79], v[116:119], v[128:131], v[64:79]
    ds_read_b128 v[32:35], v7 offset:0
    ds_read_b128 v[36:39], v7 offset:4096
    ds_read_b64_tr_b16 v[16:17], v5 offset:0
    v_mfma_f32_32x32x16_bf16 v[80:95], v[112:115], v[132:135], v[80:95]
    ds_read_b64_tr_b16 v[18:19], v5 offset:2048
    ds_read_b64_tr_b16 v[20:21], v6 offset:0
    ds_read_b64_tr_b16 v[22:23], v6 offset:2048
    v_mfma_f32_32x32x16_bf16 v[96:111], v[116:119], v[132:135], v[96:111]
    ds_read_b128 v[40:43], v7 offset:1024
    ds_read_b128 v[44:47], v7 offset:5120
    ds_read_b64_tr_b16 v[24:25], v5 offset:4096
    v_mfma_f32_32x32x16_bf16 v[48:63], v[120:123], v[136:139], v[48:63]
    ds_read_b64_tr_b16 v[26:27], v5 offset:6144
    ds_read_b64_tr_b16 v[28:29], v6 offset:4096
    ds_read_b64_tr_b16 v[30:31], v6 offset:6144
    v_mfma_f32_32x32x16_bf16 v[64:79], v[124:127], v[136:139], v[64:79]
    v_mfma_f32_32x32x16_bf16 v[80:95], v[120:123], v[140:143], v[80:95]
    v_mfma_f32_32x32x16_bf16 v[96:111], v[124:127], v[140:143], v[96:111]
    s_waitcnt lgkmcnt(0)
    v_mfma_f32_32x32x16_bf16 v[48:63], v[16:19], v[32:35], v[48:63]
    ds_read_b128 v[128:131], v7 offset:2048
    ds_read_b128 v[132:135], v7 offset:6144
    v_mfma_f32_32x32x16_bf16 v[64:79], v[20:23], v[32:35], v[64:79]
    ds_read_b64_tr_b16 v[112:113], v5 offset:8192
    ds_read_b64_tr_b16 v[114:115], v5 offset:10240
    v_mfma_f32_32x32x16_bf16 v[80:95], v[16:19], v[36:39], v[80:95]
    ds_read_b64_tr_b16 v[116:117], v6 offset:8192
    ds_read_b64_tr_b16 v[118:119], v6 offset:10240
    v_mfma_f32_32x32x16_bf16 v[96:111], v[20:23], v[36:39], v[96:111]
    ds_read_b128 v[136:139], v7 offset:3072
    ds_read_b128 v[140:143], v7 offset:7168
    v_mfma_f32_32x32x16_bf16 v[48:63], v[24:27], v[40:43], v[48:63]
    ds_read_b64_tr_b16 v[120:121], v5 offset:12288
    ds_read_b64_tr_b16 v[122:123], v5 offset:14336
    v_mfma_f32_32x32x16_bf16 v[64:79], v[28:31], v[40:43], v[64:79]
    ds_read_b64_tr_b16 v[124:125], v6 offset:12288
    ds_read_b64_tr_b16 v[126:127], v6 offset:14336
    v_mfma_f32_32x32x16_bf16 v[80:95], v[24:27], v[44:47], v[80:95]
    v_mfma_f32_32x32x16_bf16 v[96:111], v[28:31], v[44:47], v[96:111]
    s_waitcnt lgkmcnt(0)
    s_barrier
    v_mfma_f32_32x32x16_bf16 v[48:63], v[112:115], v[128:131], v[48:63]
    v_add_u32 v5, 0, v2
    v_add_u32 v6, 0, v3
    v_add_u32 v7, 0, v4
    v_mfma_f32_32x32x16_bf16 v[64:79], v[116:119], v[128:131], v[64:79]
    ds_read_b128 v[32:35], v7 offset:0
    ds_read_b128 v[36:39], v7 offset:4096
    ds_read_b64_tr_b16 v[16:17], v5 offset:0
    v_mfma_f32_32x32x16_bf16 v[80:95], v[112:115], v[132:135], v[80:95]
    ds_read_b64_tr_b16 v[18:19], v5 offset:2048
    ds_read_b64_tr_b16 v[20:21], v6 offset:0
    ds_read_b64_tr_b16 v[22:23], v6 offset:2048
    v_mfma_f32_32x32x16_bf16 v[96:111], v[116:119], v[132:135], v[96:111]
    ds_read_b128 v[40:43], v7 offset:1024
    ds_read_b128 v[44:47], v7 offset:5120
    ds_read_b64_tr_b16 v[24:25], v5 offset:4096
    v_mfma_f32_32x32x16_bf16 v[48:63], v[120:123], v[136:139], v[48:63]
    ds_read_b64_tr_b16 v[26:27], v5 offset:6144
    ds_read_b64_tr_b16 v[28:29], v6 offset:4096
    ds_read_b64_tr_b16 v[30:31], v6 offset:6144
    v_mfma_f32_32x32x16_bf16 v[64:79], v[124:127], v[136:139], v[64:79]
    v_mfma_f32_32x32x16_bf16 v[80:95], v[120:123], v[140:143], v[80:95]
    v_mfma_f32_32x32x16_bf16 v[96:111], v[124:127], v[140:143], v[96:111]
    s_waitcnt lgkmcnt(0)
    v_mfma_f32_32x32x16_bf16 v[48:63], v[16:19], v[32:35], v[48:63]
    ds_read_b128 v[128:131], v7 offset:2048
    ds_read_b128 v[132:135], v7 offset:6144
    v_mfma_f32_32x32x16_bf16 v[64:79], v[20:23], v[32:35], v[64:79]
    ds_read_b64_tr_b16 v[112:113], v5 offset:8192
    ds_read_b64_tr_b16 v[114:115], v5 offset:10240
    v_mfma_f32_32x32x16_bf16 v[80:95], v[16:19], v[36:39], v[80:95]
    ds_read_b64_tr_b16 v[116:117], v6 offset:8192
    ds_read_b64_tr_b16 v[118:119], v6 offset:10240
    v_mfma_f32_32x32x16_bf16 v[96:111], v[20:23], v[36:39], v[96:111]
    ds_read_b128 v[136:139], v7 offset:3072
    ds_read_b128 v[140:143], v7 offset:7168
    v_mfma_f32_32x32x16_bf16 v[48:63], v[24:27], v[40:43], v[48:63]
    ds_read_b64_tr_b16 v[120:121], v5 offset:12288
    ds_read_b64_tr_b16 v[122:123], v5 offset:14336
    v_mfma_f32_32x32x16_bf16 v[64:79], v[28:31], v[40:43], v[64:79]
    ds_read_b64_tr_b16 v[124:125], v6 offset:12288
    ds_read_b64_tr_b16 v[126:127], v6 offset:14336
    v_mfma_f32_32x32x16_bf16 v[80:95], v[24:27], v[44:47], v[80:95]
    v_mfma_f32_32x32x16_bf16 v[96:111], v[28:31], v[44:47], v[96:111]
    s_waitcnt lgkmcnt(0)
    s_barrier
    v_mfma_f32_32x32x16_bf16 v[48:63], v[112:115], v[128:131], v[48:63]
    v_add_u32 v5, 32768, v2
    v_add_u32 v6, 32768, v3
    v_add_u32 v7, 32768, v4
    v_mfma_f32_32x32x16_bf16 v[64:79], v[116:119], v[128:131], v[64:79]
    ds_read_b128 v[32:35], v7 offset:0
    ds_read_b128 v[36:39], v7 offset:4096
    ds_read_b64_tr_b16 v[16:17], v5 offset:0
    v_mfma_f32_32x32x16_bf16 v[80:95], v[112:115], v[132:135], v[80:95]
    ds_read_b64_tr_b16 v[18:19], v5 offset:2048
    ds_read_b64_tr_b16 v[20:21], v6 offset:0
    ds_read_b64_tr_b16 v[22:23], v6 offset:2048
    v_mfma_f32_32x32x16_bf16 v[96:111], v[116:119], v[132:135], v[96:111]
    ds_read_b128 v[40:43], v7 offset:1024
    ds_read_b128 v[44:47], v7 offset:5120
    ds_read_b64_tr_b16 v[24:25], v5 offset:4096
    v_mfma_f32_32x32x16_bf16 v[48:63], v[120:123], v[136:139], v[48:63]
    ds_read_b64_tr_b16 v[26:27], v5 offset:6144
    ds_read_b64_tr_b16 v[28:29], v6 offset:4096
    ds_read_b64_tr_b16 v[30:31], v6 offset:6144
    v_mfma_f32_32x32x16_bf16 v[64:79], v[124:127], v[136:139], v[64:79]
    v_mfma_f32_32x32x16_bf16 v[80:95], v[120:123], v[140:143], v[80:95]
    v_mfma_f32_32x32x16_bf16 v[96:111], v[124:127], v[140:143], v[96:111]
    s_waitcnt lgkmcnt(0)
    v_mfma_f32_32x32x16_bf16 v[48:63], v[16:19], v[32:35], v[48:63]
    ds_read_b128 v[128:131], v7 offset:2048
    ds_read_b128 v[132:135], v7 offset:6144
    v_mfma_f32_32x32x16_bf16 v[64:79], v[20:23], v[32:35], v[64:79]
    ds_read_b64_tr_b16 v[112:113], v5 offset:8192
    ds_read_b64_tr_b16 v[114:115], v5 offset:10240
    v_mfma_f32_32x32x16_bf16 v[80:95], v[16:19], v[36:39], v[80:95]
    ds_read_b64_tr_b16 v[116:117], v6 offset:8192
    ds_read_b64_tr_b16 v[118:119], v6 offset:10240
    v_mfma_f32_32x32x16_bf16 v[96:111], v[20:23], v[36:39], v[96:111]
    ds_read_b128 v[136:139], v7 offset:3072
    ds_read_b128 v[140:143], v7 offset:7168
    v_mfma_f32_32x32x16_bf16 v[48:63], v[24:27], v[40:43], v[48:63]
    ds_read_b64_tr_b16 v[120:121], v5 offset:12288
    ds_read_b64_tr_b16 v[122:123], v5 offset:14336
    v_mfma_f32_32x32x16_bf16 v[64:79], v[28:31], v[40:43], v[64:79]
    ds_read_b64_tr_b16 v[124:125], v6 offset:12288
    ds_read_b64_tr_b16 v[126:127], v6 offset:14336
    v_mfma_f32_32x32x16_bf16 v[80:95], v[24:27], v[44:47], v[80:95]
    v_mfma_f32_32x32x16_bf16 v[96:111], v[28:31], v[44:47], v[96:111]
    s_waitcnt lgkmcnt(0)
    s_barrier
    v_mfma_f32_32x32x16_bf16 v[48:63], v[112:115], v[128:131], v[48:63]
    v_add_u32 v5, 65536, v2
    v_add_u32 v6, 65536, v3
    v_add_u32 v7, 65536, v4
    v_mfma_f32_32x32x16_bf16 v[64:79], v[116:119], v[128:131], v[64:79]
    ds_read_b128 v[32:35], v7 offset:0
    ds_read_b128 v[36:39], v7 offset:4096
    ds_read_b64_tr_b16 v[16:17], v5 offset:0
    v_mfma_f32_32x32x16_bf16 v[80:95], v[112:115], v[132:135], v[80:95]
    ds_read_b64_tr_b16 v[18:19], v5 offset:2048
    ds_read_b64_tr_b16 v[20:21], v6 offset:0
    ds_read_b64_tr_b16 v[22:23], v6 offset:2048
    v_mfma_f32_32x32x16_bf16 v[96:111], v[116:119], v[132:135], v[96:111]
    ds_read_b128 v[40:43], v7 offset:1024
    ds_read_b128 v[44:47], v7 offset:5120
    ds_read_b64_tr_b16 v[24:25], v5 offset:4096
    v_mfma_f32_32x32x16_bf16 v[48:63], v[120:123], v[136:139], v[48:63]
    ds_read_b64_tr_b16 v[26:27], v5 offset:6144
    ds_read_b64_tr_b16 v[28:29], v6 offset:4096
    ds_read_b64_tr_b16 v[30:31], v6 offset:6144
    v_mfma_f32_32x32x16_bf16 v[64:79], v[124:127], v[136:139], v[64:79]
    v_mfma_f32_32x32x16_bf16 v[80:95], v[120:123], v[140:143], v[80:95]
    v_mfma_f32_32x32x16_bf16 v[96:111], v[124:127], v[140:143], v[96:111]
    s_waitcnt lgkmcnt(0)
    v_mfma_f32_32x32x16_bf16 v[48:63], v[16:19], v[32:35], v[48:63]
    ds_read_b128 v[128:131], v7 offset:2048
    ds_read_b128 v[132:135], v7 offset:6144
    v_mfma_f32_32x32x16_bf16 v[64:79], v[20:23], v[32:35], v[64:79]
    ds_read_b64_tr_b16 v[112:113], v5 offset:8192
    ds_read_b64_tr_b16 v[114:115], v5 offset:10240
    v_mfma_f32_32x32x16_bf16 v[80:95], v[16:19], v[36:39], v[80:95]
    ds_read_b64_tr_b16 v[116:117], v6 offset:8192
    ds_read_b64_tr_b16 v[118:119], v6 offset:10240
    v_mfma_f32_32x32x16_bf16 v[96:111], v[20:23], v[36:39], v[96:111]
    ds_read_b128 v[136:139], v7 offset:3072
    ds_read_b128 v[140:143], v7 offset:7168
    v_mfma_f32_32x32x16_bf16 v[48:63], v[24:27], v[40:43], v[48:63]
    ds_read_b64_tr_b16 v[120:121], v5 offset:12288
    ds_read_b64_tr_b16 v[122:123], v5 offset:14336
    v_mfma_f32_32x32x16_bf16 v[64:79], v[28:31], v[40:43], v[64:79]
    ds_read_b64_tr_b16 v[124:125], v6 offset:12288
    ds_read_b64_tr_b16 v[126:127], v6 offset:14336
    v_mfma_f32_32x32x16_bf16 v[80:95], v[24:27], v[44:47], v[80:95]
    v_mfma_f32_32x32x16_bf16 v[96:111], v[28:31], v[44:47], v[96:111]
    s_waitcnt lgkmcnt(0)
    s_barrier
    v_mfma_f32_32x32x16_bf16 v[48:63], v[112:115], v[128:131], v[48:63]
    v_add_u32 v5, 98304, v2
    v_add_u32 v6, 98304, v3
    v_add_u32 v7, 98304, v4
    v_mfma_f32_32x32x16_bf16 v[64:79], v[116:119], v[128:131], v[64:79]
    ds_read_b128 v[32:35], v7 offset:0
    ds_read_b128 v[36:39], v7 offset:4096
    ds_read_b64_tr_b16 v[16:17], v5 offset:0
    v_mfma_f32_32x32x16_bf16 v[80:95], v[112:115], v[132:135], v[80:95]
    ds_read_b64_tr_b16 v[18:19], v5 offset:2048
    ds_read_b64_tr_b16 v[20:21], v6 offset:0
    ds_read_b64_tr_b16 v[22:23], v6 offset:2048
    v_mfma_f32_32x32x16_bf16 v[96:111], v[116:119], v[132:135], v[96:111]
    ds_read_b128 v[40:43], v7 offset:1024
    ds_read_b128 v[44:47], v7 offset:5120
    ds_read_b64_tr_b16 v[24:25], v5 offset:4096
    v_mfma_f32_32x32x16_bf16 v[48:63], v[120:123], v[136:139], v[48:63]
    ds_read_b64_tr_b16 v[26:27], v5 offset:6144
    ds_read_b64_tr_b16 v[28:29], v6 offset:4096
    ds_read_b64_tr_b16 v[30:31], v6 offset:6144
    v_mfma_f32_32x32x16_bf16 v[64:79], v[124:127], v[136:139], v[64:79]
    v_mfma_f32_32x32x16_bf16 v[80:95], v[120:123], v[140:143], v[80:95]
    v_mfma_f32_32x32x16_bf16 v[96:111], v[124:127], v[140:143], v[96:111]
    s_waitcnt lgkmcnt(0)
    v_mfma_f32_32x32x16_bf16 v[48:63], v[16:19], v[32:35], v[48:63]
    ds_read_b128 v[128:131], v7 offset:2048
    ds_read_b128 v[132:135], v7 offset:6144
    v_mfma_f32_32x32x16_bf16 v[64:79], v[20:23], v[32:35], v[64:79]
    ds_read_b64_tr_b16 v[112:113], v5 offset:8192
    ds_read_b64_tr_b16 v[114:115], v5 offset:10240
    v_mfma_f32_32x32x16_bf16 v[80:95], v[16:19], v[36:39], v[80:95]
    ds_read_b64_tr_b16 v[116:117], v6 offset:8192
    ds_read_b64_tr_b16 v[118:119], v6 offset:10240
    v_mfma_f32_32x32x16_bf16 v[96:111], v[20:23], v[36:39], v[96:111]
    ds_read_b128 v[136:139], v7 offset:3072
    ds_read_b128 v[140:143], v7 offset:7168
    v_mfma_f32_32x32x16_bf16 v[48:63], v[24:27], v[40:43], v[48:63]
    ds_read_b64_tr_b16 v[120:121], v5 offset:12288
    ds_read_b64_tr_b16 v[122:123], v5 offset:14336
    v_mfma_f32_32x32x16_bf16 v[64:79], v[28:31], v[40:43], v[64:79]
    ds_read_b64_tr_b16 v[124:125], v6 offset:12288
    ds_read_b64_tr_b16 v[126:127], v6 offset:14336
    v_mfma_f32_32x32x16_bf16 v[80:95], v[24:27], v[44:47], v[80:95]
    v_mfma_f32_32x32x16_bf16 v[96:111], v[28:31], v[44:47], v[96:111]
    s_waitcnt lgkmcnt(0)
    s_barrier
    v_mfma_f32_32x32x16_bf16 v[48:63], v[112:115], v[128:131], v[48:63]
    v_add_u32 v5, 131072, v2
    v_add_u32 v6, 131072, v3
    v_add_u32 v7, 131072, v4
    v_mfma_f32_32x32x16_bf16 v[64:79], v[116:119], v[128:131], v[64:79]
    ds_read_b128 v[32:35], v7 offset:0
    ds_read_b128 v[36:39], v7 offset:4096
    ds_read_b64_tr_b16 v[16:17], v5 offset:0
    v_mfma_f32_32x32x16_bf16 v[80:95], v[112:115], v[132:135], v[80:95]
    ds_read_b64_tr_b16 v[18:19], v5 offset:2048
    ds_read_b64_tr_b16 v[20:21], v6 offset:0
    ds_read_b64_tr_b16 v[22:23], v6 offset:2048
    v_mfma_f32_32x32x16_bf16 v[96:111], v[116:119], v[132:135], v[96:111]
    ds_read_b128 v[40:43], v7 offset:1024
    ds_read_b128 v[44:47], v7 offset:5120
    ds_read_b64_tr_b16 v[24:25], v5 offset:4096
    v_mfma_f32_32x32x16_bf16 v[48:63], v[120:123], v[136:139], v[48:63]
    ds_read_b64_tr_b16 v[26:27], v5 offset:6144
    ds_read_b64_tr_b16 v[28:29], v6 offset:4096
    ds_read_b64_tr_b16 v[30:31], v6 offset:6144
    v_mfma_f32_32x32x16_bf16 v[64:79], v[124:127], v[136:139], v[64:79]
    v_mfma_f32_32x32x16_bf16 v[80:95], v[120:123], v[140:143], v[80:95]
    v_mfma_f32_32x32x16_bf16 v[96:111], v[124:127], v[140:143], v[96:111]
    s_waitcnt lgkmcnt(0)
    v_mfma_f32_32x32x16_bf16 v[48:63], v[16:19], v[32:35], v[48:63]
    ds_read_b128 v[128:131], v7 offset:2048
    ds_read_b128 v[132:135], v7 offset:6144
    v_mfma_f32_32x32x16_bf16 v[64:79], v[20:23], v[32:35], v[64:79]
    ds_read_b64_tr_b16 v[112:113], v5 offset:8192
    ds_read_b64_tr_b16 v[114:115], v5 offset:10240
    v_mfma_f32_32x32x16_bf16 v[80:95], v[16:19], v[36:39], v[80:95]
    ds_read_b64_tr_b16 v[116:117], v6 offset:8192
    ds_read_b64_tr_b16 v[118:119], v6 offset:10240
    v_mfma_f32_32x32x16_bf16 v[96:111], v[20:23], v[36:39], v[96:111]
    ds_read_b128 v[136:139], v7 offset:3072
    ds_read_b128 v[140:143], v7 offset:7168
    v_mfma_f32_32x32x16_bf16 v[48:63], v[24:27], v[40:43], v[48:63]
    ds_read_b64_tr_b16 v[120:121], v5 offset:12288
    ds_read_b64_tr_b16 v[122:123], v5 offset:14336
    v_mfma_f32_32x32x16_bf16 v[64:79], v[28:31], v[40:43], v[64:79]
    ds_read_b64_tr_b16 v[124:125], v6 offset:12288
    ds_read_b64_tr_b16 v[126:127], v6 offset:14336
    v_mfma_f32_32x32x16_bf16 v[80:95], v[24:27], v[44:47], v[80:95]
    v_mfma_f32_32x32x16_bf16 v[96:111], v[28:31], v[44:47], v[96:111]
    s_waitcnt lgkmcnt(0)
    s_barrier
    v_mfma_f32_32x32x16_bf16 v[48:63], v[112:115], v[128:131], v[48:63]
    v_add_u32 v5, 0, v2
    v_add_u32 v6, 0, v3
    v_add_u32 v7, 0, v4
    v_mfma_f32_32x32x16_bf16 v[64:79], v[116:119], v[128:131], v[64:79]
    ds_read_b128 v[32:35], v7 offset:0
    ds_read_b128 v[36:39], v7 offset:4096
    ds_read_b64_tr_b16 v[16:17], v5 offset:0
    v_mfma_f32_32x32x16_bf16 v[80:95], v[112:115], v[132:135], v[80:95]
    ds_read_b64_tr_b16 v[18:19], v5 offset:2048
    ds_read_b64_tr_b16 v[20:21], v6 offset:0
    ds_read_b64_tr_b16 v[22:23], v6 offset:2048
    v_mfma_f32_32x32x16_bf16 v[96:111], v[116:119], v[132:135], v[96:111]
    ds_read_b128 v[40:43], v7 offset:1024
    ds_read_b128 v[44:47], v7 offset:5120
    ds_read_b64_tr_b16 v[24:25], v5 offset:4096
    v_mfma_f32_32x32x16_bf16 v[48:63], v[120:123], v[136:139], v[48:63]
    ds_read_b64_tr_b16 v[26:27], v5 offset:6144
    ds_read_b64_tr_b16 v[28:29], v6 offset:4096
    ds_read_b64_tr_b16 v[30:31], v6 offset:6144
    v_mfma_f32_32x32x16_bf16 v[64:79], v[124:127], v[136:139], v[64:79]
    v_mfma_f32_32x32x16_bf16 v[80:95], v[120:123], v[140:143], v[80:95]
    v_mfma_f32_32x32x16_bf16 v[96:111], v[124:127], v[140:143], v[96:111]
    s_waitcnt lgkmcnt(0)
    v_mfma_f32_32x32x16_bf16 v[48:63], v[16:19], v[32:35], v[48:63]
    ds_read_b128 v[128:131], v7 offset:2048
    ds_read_b128 v[132:135], v7 offset:6144
    v_mfma_f32_32x32x16_bf16 v[64:79], v[20:23], v[32:35], v[64:79]
    ds_read_b64_tr_b16 v[112:113], v5 offset:8192
    ds_read_b64_tr_b16 v[114:115], v5 offset:10240
    v_mfma_f32_32x32x16_bf16 v[80:95], v[16:19], v[36:39], v[80:95]
    ds_read_b64_tr_b16 v[116:117], v6 offset:8192
    ds_read_b64_tr_b16 v[118:119], v6 offset:10240
    v_mfma_f32_32x32x16_bf16 v[96:111], v[20:23], v[36:39], v[96:111]
    ds_read_b128 v[136:139], v7 offset:3072
    ds_read_b128 v[140:143], v7 offset:7168
    v_mfma_f32_32x32x16_bf16 v[48:63], v[24:27], v[40:43], v[48:63]
    ds_read_b64_tr_b16 v[120:121], v5 offset:12288
    ds_read_b64_tr_b16 v[122:123], v5 offset:14336
    v_mfma_f32_32x32x16_bf16 v[64:79], v[28:31], v[40:43], v[64:79]
    ds_read_b64_tr_b16 v[124:125], v6 offset:12288
    ds_read_b64_tr_b16 v[126:127], v6 offset:14336
    v_mfma_f32_32x32x16_bf16 v[80:95], v[24:27], v[44:47], v[80:95]
    v_mfma_f32_32x32x16_bf16 v[96:111], v[28:31], v[44:47], v[96:111]
    s_waitcnt lgkmcnt(0)
    s_barrier
    v_mfma_f32_32x32x16_bf16 v[48:63], v[112:115], v[128:131], v[48:63]
    v_add_u32 v5, 32768, v2
    v_add_u32 v6, 32768, v3
    v_add_u32 v7, 32768, v4
    v_mfma_f32_32x32x16_bf16 v[64:79], v[116:119], v[128:131], v[64:79]
    ds_read_b128 v[32:35], v7 offset:0
    ds_read_b128 v[36:39], v7 offset:4096
    ds_read_b64_tr_b16 v[16:17], v5 offset:0
    v_mfma_f32_32x32x16_bf16 v[80:95], v[112:115], v[132:135], v[80:95]
    ds_read_b64_tr_b16 v[18:19], v5 offset:2048
    ds_read_b64_tr_b16 v[20:21], v6 offset:0
    ds_read_b64_tr_b16 v[22:23], v6 offset:2048
    v_mfma_f32_32x32x16_bf16 v[96:111], v[116:119], v[132:135], v[96:111]
    ds_read_b128 v[40:43], v7 offset:1024
    ds_read_b128 v[44:47], v7 offset:5120
    ds_read_b64_tr_b16 v[24:25], v5 offset:4096
    v_mfma_f32_32x32x16_bf16 v[48:63], v[120:123], v[136:139], v[48:63]
    ds_read_b64_tr_b16 v[26:27], v5 offset:6144
    ds_read_b64_tr_b16 v[28:29], v6 offset:4096
    ds_read_b64_tr_b16 v[30:31], v6 offset:6144
    v_mfma_f32_32x32x16_bf16 v[64:79], v[124:127], v[136:139], v[64:79]
    v_mfma_f32_32x32x16_bf16 v[80:95], v[120:123], v[140:143], v[80:95]
    v_mfma_f32_32x32x16_bf16 v[96:111], v[124:127], v[140:143], v[96:111]
    s_waitcnt lgkmcnt(0)
    v_mfma_f32_32x32x16_bf16 v[48:63], v[16:19], v[32:35], v[48:63]
    ds_read_b128 v[128:131], v7 offset:2048
    ds_read_b128 v[132:135], v7 offset:6144
    v_mfma_f32_32x32x16_bf16 v[64:79], v[20:23], v[32:35], v[64:79]
    ds_read_b64_tr_b16 v[112:113], v5 offset:8192
    ds_read_b64_tr_b16 v[114:115], v5 offset:10240
    v_mfma_f32_32x32x16_bf16 v[80:95], v[16:19], v[36:39], v[80:95]
    ds_read_b64_tr_b16 v[116:117], v6 offset:8192
    ds_read_b64_tr_b16 v[118:119], v6 offset:10240
    v_mfma_f32_32x32x16_bf16 v[96:111], v[20:23], v[36:39], v[96:111]
    ds_read_b128 v[136:139], v7 offset:3072
    ds_read_b128 v[140:143], v7 offset:7168
    v_mfma_f32_32x32x16_bf16 v[48:63], v[24:27], v[40:43], v[48:63]
    ds_read_b64_tr_b16 v[120:121], v5 offset:12288
    ds_read_b64_tr_b16 v[122:123], v5 offset:14336
    v_mfma_f32_32x32x16_bf16 v[64:79], v[28:31], v[40:43], v[64:79]
    ds_read_b64_tr_b16 v[124:125], v6 offset:12288
    ds_read_b64_tr_b16 v[126:127], v6 offset:14336
    v_mfma_f32_32x32x16_bf16 v[80:95], v[24:27], v[44:47], v[80:95]
    v_mfma_f32_32x32x16_bf16 v[96:111], v[28:31], v[44:47], v[96:111]
    s_waitcnt lgkmcnt(0)
    s_barrier
    v_mfma_f32_32x32x16_bf16 v[48:63], v[112:115], v[128:131], v[48:63]
    v_add_u32 v5, 65536, v2
    v_add_u32 v6, 65536, v3
    v_add_u32 v7, 65536, v4
    v_mfma_f32_32x32x16_bf16 v[64:79], v[116:119], v[128:131], v[64:79]
    ds_read_b128 v[32:35], v7 offset:0
    ds_read_b128 v[36:39], v7 offset:4096
    ds_read_b64_tr_b16 v[16:17], v5 offset:0
    v_mfma_f32_32x32x16_bf16 v[80:95], v[112:115], v[132:135], v[80:95]
    ds_read_b64_tr_b16 v[18:19], v5 offset:2048
    ds_read_b64_tr_b16 v[20:21], v6 offset:0
    ds_read_b64_tr_b16 v[22:23], v6 offset:2048
    v_mfma_f32_32x32x16_bf16 v[96:111], v[116:119], v[132:135], v[96:111]
    ds_read_b128 v[40:43], v7 offset:1024
    ds_read_b128 v[44:47], v7 offset:5120
    ds_read_b64_tr_b16 v[24:25], v5 offset:4096
    v_mfma_f32_32x32x16_bf16 v[48:63], v[120:123], v[136:139], v[48:63]
    ds_read_b64_tr_b16 v[26:27], v5 offset:6144
    ds_read_b64_tr_b16 v[28:29], v6 offset:4096
    ds_read_b64_tr_b16 v[30:31], v6 offset:6144
    v_mfma_f32_32x32x16_bf16 v[64:79], v[124:127], v[136:139], v[64:79]
    v_mfma_f32_32x32x16_bf16 v[80:95], v[120:123], v[140:143], v[80:95]
    v_mfma_f32_32x32x16_bf16 v[96:111], v[124:127], v[140:143], v[96:111]
    s_waitcnt lgkmcnt(0)
    v_mfma_f32_32x32x16_bf16 v[48:63], v[16:19], v[32:35], v[48:63]
    ds_read_b128 v[128:131], v7 offset:2048
    ds_read_b128 v[132:135], v7 offset:6144
    v_mfma_f32_32x32x16_bf16 v[64:79], v[20:23], v[32:35], v[64:79]
    ds_read_b64_tr_b16 v[112:113], v5 offset:8192
    ds_read_b64_tr_b16 v[114:115], v5 offset:10240
    v_mfma_f32_32x32x16_bf16 v[80:95], v[16:19], v[36:39], v[80:95]
    ds_read_b64_tr_b16 v[116:117], v6 offset:8192
    ds_read_b64_tr_b16 v[118:119], v6 offset:10240
    v_mfma_f32_32x32x16_bf16 v[96:111], v[20:23], v[36:39], v[96:111]
    ds_read_b128 v[136:139], v7 offset:3072
    ds_read_b128 v[140:143], v7 offset:7168
    v_mfma_f32_32x32x16_bf16 v[48:63], v[24:27], v[40:43], v[48:63]
    ds_read_b64_tr_b16 v[120:121], v5 offset:12288
    ds_read_b64_tr_b16 v[122:123], v5 offset:14336
    v_mfma_f32_32x32x16_bf16 v[64:79], v[28:31], v[40:43], v[64:79]
    ds_read_b64_tr_b16 v[124:125], v6 offset:12288
    ds_read_b64_tr_b16 v[126:127], v6 offset:14336
    v_mfma_f32_32x32x16_bf16 v[80:95], v[24:27], v[44:47], v[80:95]
    v_mfma_f32_32x32x16_bf16 v[96:111], v[28:31], v[44:47], v[96:111]
    s_waitcnt lgkmcnt(0)
    s_barrier
    v_mfma_f32_32x32x16_bf16 v[48:63], v[112:115], v[128:131], v[48:63]
    v_add_u32 v5, 98304, v2
    v_add_u32 v6, 98304, v3
    v_add_u32 v7, 98304, v4
    v_mfma_f32_32x32x16_bf16 v[64:79], v[116:119], v[128:131], v[64:79]
    ds_read_b128 v[32:35], v7 offset:0
    ds_read_b128 v[36:39], v7 offset:4096
    ds_read_b64_tr_b16 v[16:17], v5 offset:0
    v_mfma_f32_32x32x16_bf16 v[80:95], v[112:115], v[132:135], v[80:95]
    ds_read_b64_tr_b16 v[18:19], v5 offset:2048
    ds_read_b64_tr_b16 v[20:21], v6 offset:0
    ds_read_b64_tr_b16 v[22:23], v6 offset:2048
    v_mfma_f32_32x32x16_bf16 v[96:111], v[116:119], v[132:135], v[96:111]
    ds_read_b128 v[40:43], v7 offset:1024
    ds_read_b128 v[44:47], v7 offset:5120
    ds_read_b64_tr_b16 v[24:25], v5 offset:4096
    v_mfma_f32_32x32x16_bf16 v[48:63], v[120:123], v[136:139], v[48:63]
    ds_read_b64_tr_b16 v[26:27], v5 offset:6144
    ds_read_b64_tr_b16 v[28:29], v6 offset:4096
    ds_read_b64_tr_b16 v[30:31], v6 offset:6144
    v_mfma_f32_32x32x16_bf16 v[64:79], v[124:127], v[136:139], v[64:79]
    v_mfma_f32_32x32x16_bf16 v[80:95], v[120:123], v[140:143], v[80:95]
    v_mfma_f32_32x32x16_bf16 v[96:111], v[124:127], v[140:143], v[96:111]
    s_waitcnt lgkmcnt(0)
    v_mfma_f32_32x32x16_bf16 v[48:63], v[16:19], v[32:35], v[48:63]
    ds_read_b128 v[128:131], v7 offset:2048
    ds_read_b128 v[132:135], v7 offset:6144
    v_mfma_f32_32x32x16_bf16 v[64:79], v[20:23], v[32:35], v[64:79]
    ds_read_b64_tr_b16 v[112:113], v5 offset:8192
    ds_read_b64_tr_b16 v[114:115], v5 offset:10240
    v_mfma_f32_32x32x16_bf16 v[80:95], v[16:19], v[36:39], v[80:95]
    ds_read_b64_tr_b16 v[116:117], v6 offset:8192
    ds_read_b64_tr_b16 v[118:119], v6 offset:10240
    v_mfma_f32_32x32x16_bf16 v[96:111], v[20:23], v[36:39], v[96:111]
    ds_read_b128 v[136:139], v7 offset:3072
    ds_read_b128 v[140:143], v7 offset:7168
    v_mfma_f32_32x32x16_bf16 v[48:63], v[24:27], v[40:43], v[48:63]
    ds_read_b64_tr_b16 v[120:121], v5 offset:12288
    ds_read_b64_tr_b16 v[122:123], v5 offset:14336
    v_mfma_f32_32x32x16_bf16 v[64:79], v[28:31], v[40:43], v[64:79]
    ds_read_b64_tr_b16 v[124:125], v6 offset:12288
    ds_read_b64_tr_b16 v[126:127], v6 offset:14336
    v_mfma_f32_32x32x16_bf16 v[80:95], v[24:27], v[44:47], v[80:95]
    v_mfma_f32_32x32x16_bf16 v[96:111], v[28:31], v[44:47], v[96:111]
    s_waitcnt lgkmcnt(0)
    s_barrier
    v_mfma_f32_32x32x16_bf16 v[48:63], v[112:115], v[128:131], v[48:63]
    v_add_u32 v5, 131072, v2
    v_add_u32 v6, 131072, v3
    v_add_u32 v7, 131072, v4
    v_mfma_f32_32x32x16_bf16 v[64:79], v[116:119], v[128:131], v[64:79]
    ds_read_b128 v[32:35], v7 offset:0
    ds_read_b128 v[36:39], v7 offset:4096
    ds_read_b64_tr_b16 v[16:17], v5 offset:0
    v_mfma_f32_32x32x16_bf16 v[80:95], v[112:115], v[132:135], v[80:95]
    ds_read_b64_tr_b16 v[18:19], v5 offset:2048
    ds_read_b64_tr_b16 v[20:21], v6 offset:0
    ds_read_b64_tr_b16 v[22:23], v6 offset:2048
    v_mfma_f32_32x32x16_bf16 v[96:111], v[116:119], v[132:135], v[96:111]
    ds_read_b128 v[40:43], v7 offset:1024
    ds_read_b128 v[44:47], v7 offset:5120
    ds_read_b64_tr_b16 v[24:25], v5 offset:4096
    v_mfma_f32_32x32x16_bf16 v[48:63], v[120:123], v[136:139], v[48:63]
    ds_read_b64_tr_b16 v[26:27], v5 offset:6144
    ds_read_b64_tr_b16 v[28:29], v6 offset:4096
    ds_read_b64_tr_b16 v[30:31], v6 offset:6144
    v_mfma_f32_32x32x16_bf16 v[64:79], v[124:127], v[136:139], v[64:79]
    v_mfma_f32_32x32x16_bf16 v[80:95], v[120:123], v[140:143], v[80:95]
    v_mfma_f32_32x32x16_bf16 v[96:111], v[124:127], v[140:143], v[96:111]
    s_waitcnt lgkmcnt(0)
    v_mfma_f32_32x32x16_bf16 v[48:63], v[16:19], v[32:35], v[48:63]
    ds_read_b128 v[128:131], v7 offset:2048
    ds_read_b128 v[132:135], v7 offset:6144
    v_mfma_f32_32x32x16_bf16 v[64:79], v[20:23], v[32:35], v[64:79]
    ds_read_b64_tr_b16 v[112:113], v5 offset:8192
    ds_read_b64_tr_b16 v[114:115], v5 offset:10240
    v_mfma_f32_32x32x16_bf16 v[80:95], v[16:19], v[36:39], v[80:95]
    ds_read_b64_tr_b16 v[116:117], v6 offset:8192
    ds_read_b64_tr_b16 v[118:119], v6 offset:10240
    v_mfma_f32_32x32x16_bf16 v[96:111], v[20:23], v[36:39], v[96:111]
    ds_read_b128 v[136:139], v7 offset:3072
    ds_read_b128 v[140:143], v7 offset:7168
    v_mfma_f32_32x32x16_bf16 v[48:63], v[24:27], v[40:43], v[48:63]
    ds_read_b64_tr_b16 v[120:121], v5 offset:12288
    ds_read_b64_tr_b16 v[122:123], v5 offset:14336
    v_mfma_f32_32x32x16_bf16 v[64:79], v[28:31], v[40:43], v[64:79]
    ds_read_b64_tr_b16 v[124:125], v6 offset:12288
    ds_read_b64_tr_b16 v[126:127], v6 offset:14336
    v_mfma_f32_32x32x16_bf16 v[80:95], v[24:27], v[44:47], v[80:95]
    v_mfma_f32_32x32x16_bf16 v[96:111], v[28:31], v[44:47], v[96:111]
    s_waitcnt lgkmcnt(0)
    s_barrier
    v_mfma_f32_32x32x16_bf16 v[48:63], v[112:115], v[128:131], v[48:63]
    v_add_u32 v5, 0, v2
    v_add_u32 v6, 0, v3
    v_add_u32 v7, 0, v4
    v_mfma_f32_32x32x16_bf16 v[64:79], v[116:119], v[128:131], v[64:79]
    ds_read_b128 v[32:35], v7 offset:0
    ds_read_b128 v[36:39], v7 offset:4096
    ds_read_b64_tr_b16 v[16:17], v5 offset:0
    v_mfma_f32_32x32x16_bf16 v[80:95], v[112:115], v[132:135], v[80:95]
    ds_read_b64_tr_b16 v[18:19], v5 offset:2048
    ds_read_b64_tr_b16 v[20:21], v6 offset:0
    ds_read_b64_tr_b16 v[22:23], v6 offset:2048
    v_mfma_f32_32x32x16_bf16 v[96:111], v[116:119], v[132:135], v[96:111]
    ds_read_b128 v[40:43], v7 offset:1024
    ds_read_b128 v[44:47], v7 offset:5120
    ds_read_b64_tr_b16 v[24:25], v5 offset:4096
    v_mfma_f32_32x32x16_bf16 v[48:63], v[120:123], v[136:139], v[48:63]
    ds_read_b64_tr_b16 v[26:27], v5 offset:6144
    ds_read_b64_tr_b16 v[28:29], v6 offset:4096
    ds_read_b64_tr_b16 v[30:31], v6 offset:6144
    v_mfma_f32_32x32x16_bf16 v[64:79], v[124:127], v[136:139], v[64:79]
    v_mfma_f32_32x32x16_bf16 v[80:95], v[120:123], v[140:143], v[80:95]
    v_mfma_f32_32x32x16_bf16 v[96:111], v[124:127], v[140:143], v[96:111]
    s_waitcnt lgkmcnt(0)
    v_mfma_f32_32x32x16_bf16 v[48:63], v[16:19], v[32:35], v[48:63]
    ds_read_b128 v[128:131], v7 offset:2048
    ds_read_b128 v[132:135], v7 offset:6144
    v_mfma_f32_32x32x16_bf16 v[64:79], v[20:23], v[32:35], v[64:79]
    ds_read_b64_tr_b16 v[112:113], v5 offset:8192
    ds_read_b64_tr_b16 v[114:115], v5 offset:10240
    v_mfma_f32_32x32x16_bf16 v[80:95], v[16:19], v[36:39], v[80:95]
    ds_read_b64_tr_b16 v[116:117], v6 offset:8192
    ds_read_b64_tr_b16 v[118:119], v6 offset:10240
    v_mfma_f32_32x32x16_bf16 v[96:111], v[20:23], v[36:39], v[96:111]
    ds_read_b128 v[136:139], v7 offset:3072
    ds_read_b128 v[140:143], v7 offset:7168
    v_mfma_f32_32x32x16_bf16 v[48:63], v[24:27], v[40:43], v[48:63]
    ds_read_b64_tr_b16 v[120:121], v5 offset:12288
    ds_read_b64_tr_b16 v[122:123], v5 offset:14336
    v_mfma_f32_32x32x16_bf16 v[64:79], v[28:31], v[40:43], v[64:79]
    ds_read_b64_tr_b16 v[124:125], v6 offset:12288
    ds_read_b64_tr_b16 v[126:127], v6 offset:14336
    v_mfma_f32_32x32x16_bf16 v[80:95], v[24:27], v[44:47], v[80:95]
    v_mfma_f32_32x32x16_bf16 v[96:111], v[28:31], v[44:47], v[96:111]
    s_waitcnt lgkmcnt(0)
    s_barrier
    v_mfma_f32_32x32x16_bf16 v[48:63], v[112:115], v[128:131], v[48:63]
    v_add_u32 v5, 32768, v2
    v_add_u32 v6, 32768, v3
    v_add_u32 v7, 32768, v4
    v_mfma_f32_32x32x16_bf16 v[64:79], v[116:119], v[128:131], v[64:79]
    ds_read_b128 v[32:35], v7 offset:0
    ds_read_b128 v[36:39], v7 offset:4096
    ds_read_b64_tr_b16 v[16:17], v5 offset:0
    v_mfma_f32_32x32x16_bf16 v[80:95], v[112:115], v[132:135], v[80:95]
    ds_read_b64_tr_b16 v[18:19], v5 offset:2048
    ds_read_b64_tr_b16 v[20:21], v6 offset:0
    ds_read_b64_tr_b16 v[22:23], v6 offset:2048
    v_mfma_f32_32x32x16_bf16 v[96:111], v[116:119], v[132:135], v[96:111]
    ds_read_b128 v[40:43], v7 offset:1024
    ds_read_b128 v[44:47], v7 offset:5120
    ds_read_b64_tr_b16 v[24:25], v5 offset:4096
    v_mfma_f32_32x32x16_bf16 v[48:63], v[120:123], v[136:139], v[48:63]
    ds_read_b64_tr_b16 v[26:27], v5 offset:6144
    ds_read_b64_tr_b16 v[28:29], v6 offset:4096
    ds_read_b64_tr_b16 v[30:31], v6 offset:6144
    v_mfma_f32_32x32x16_bf16 v[64:79], v[124:127], v[136:139], v[64:79]
    v_mfma_f32_32x32x16_bf16 v[80:95], v[120:123], v[140:143], v[80:95]
    v_mfma_f32_32x32x16_bf16 v[96:111], v[124:127], v[140:143], v[96:111]
    s_waitcnt lgkmcnt(0)
    v_mfma_f32_32x32x16_bf16 v[48:63], v[16:19], v[32:35], v[48:63]
    ds_read_b128 v[128:131], v7 offset:2048
    ds_read_b128 v[132:135], v7 offset:6144
    v_mfma_f32_32x32x16_bf16 v[64:79], v[20:23], v[32:35], v[64:79]
    ds_read_b64_tr_b16 v[112:113], v5 offset:8192
    ds_read_b64_tr_b16 v[114:115], v5 offset:10240
    v_mfma_f32_32x32x16_bf16 v[80:95], v[16:19], v[36:39], v[80:95]
    ds_read_b64_tr_b16 v[116:117], v6 offset:8192
    ds_read_b64_tr_b16 v[118:119], v6 offset:10240
    v_mfma_f32_32x32x16_bf16 v[96:111], v[20:23], v[36:39], v[96:111]
    ds_read_b128 v[136:139], v7 offset:3072
    ds_read_b128 v[140:143], v7 offset:7168
    v_mfma_f32_32x32x16_bf16 v[48:63], v[24:27], v[40:43], v[48:63]
    ds_read_b64_tr_b16 v[120:121], v5 offset:12288
    ds_read_b64_tr_b16 v[122:123], v5 offset:14336
    v_mfma_f32_32x32x16_bf16 v[64:79], v[28:31], v[40:43], v[64:79]
    ds_read_b64_tr_b16 v[124:125], v6 offset:12288
    ds_read_b64_tr_b16 v[126:127], v6 offset:14336
    v_mfma_f32_32x32x16_bf16 v[80:95], v[24:27], v[44:47], v[80:95]
    v_mfma_f32_32x32x16_bf16 v[96:111], v[28:31], v[44:47], v[96:111]
    s_waitcnt lgkmcnt(0)
    s_barrier
    v_mfma_f32_32x32x16_bf16 v[48:63], v[112:115], v[128:131], v[48:63]
    v_add_u32 v5, 65536, v2
    v_add_u32 v6, 65536, v3
    v_add_u32 v7, 65536, v4
    v_mfma_f32_32x32x16_bf16 v[64:79], v[116:119], v[128:131], v[64:79]
    ds_read_b128 v[32:35], v7 offset:0
    ds_read_b128 v[36:39], v7 offset:4096
    ds_read_b64_tr_b16 v[16:17], v5 offset:0
    v_mfma_f32_32x32x16_bf16 v[80:95], v[112:115], v[132:135], v[80:95]
    ds_read_b64_tr_b16 v[18:19], v5 offset:2048
    ds_read_b64_tr_b16 v[20:21], v6 offset:0
    ds_read_b64_tr_b16 v[22:23], v6 offset:2048
    v_mfma_f32_32x32x16_bf16 v[96:111], v[116:119], v[132:135], v[96:111]
    ds_read_b128 v[40:43], v7 offset:1024
    ds_read_b128 v[44:47], v7 offset:5120
    ds_read_b64_tr_b16 v[24:25], v5 offset:4096
    v_mfma_f32_32x32x16_bf16 v[48:63], v[120:123], v[136:139], v[48:63]
    ds_read_b64_tr_b16 v[26:27], v5 offset:6144
    ds_read_b64_tr_b16 v[28:29], v6 offset:4096
    ds_read_b64_tr_b16 v[30:31], v6 offset:6144
    v_mfma_f32_32x32x16_bf16 v[64:79], v[124:127], v[136:139], v[64:79]
    v_mfma_f32_32x32x16_bf16 v[80:95], v[120:123], v[140:143], v[80:95]
    v_mfma_f32_32x32x16_bf16 v[96:111], v[124:127], v[140:143], v[96:111]
    s_waitcnt lgkmcnt(0)
    v_mfma_f32_32x32x16_bf16 v[48:63], v[16:19], v[32:35], v[48:63]
    ds_read_b128 v[128:131], v7 offset:2048
    ds_read_b128 v[132:135], v7 offset:6144
    v_mfma_f32_32x32x16_bf16 v[64:79], v[20:23], v[32:35], v[64:79]
    ds_read_b64_tr_b16 v[112:113], v5 offset:8192
    ds_read_b64_tr_b16 v[114:115], v5 offset:10240
    v_mfma_f32_32x32x16_bf16 v[80:95], v[16:19], v[36:39], v[80:95]
    ds_read_b64_tr_b16 v[116:117], v6 offset:8192
    ds_read_b64_tr_b16 v[118:119], v6 offset:10240
    v_mfma_f32_32x32x16_bf16 v[96:111], v[20:23], v[36:39], v[96:111]
    ds_read_b128 v[136:139], v7 offset:3072
    ds_read_b128 v[140:143], v7 offset:7168
    v_mfma_f32_32x32x16_bf16 v[48:63], v[24:27], v[40:43], v[48:63]
    ds_read_b64_tr_b16 v[120:121], v5 offset:12288
    ds_read_b64_tr_b16 v[122:123], v5 offset:14336
    v_mfma_f32_32x32x16_bf16 v[64:79], v[28:31], v[40:43], v[64:79]
    ds_read_b64_tr_b16 v[124:125], v6 offset:12288
    ds_read_b64_tr_b16 v[126:127], v6 offset:14336
    v_mfma_f32_32x32x16_bf16 v[80:95], v[24:27], v[44:47], v[80:95]
    v_mfma_f32_32x32x16_bf16 v[96:111], v[28:31], v[44:47], v[96:111]
    s_waitcnt lgkmcnt(0)
    v_mfma_f32_32x32x16_bf16 v[48:63], v[112:115], v[128:131], v[48:63]
    v_mfma_f32_32x32x16_bf16 v[64:79], v[116:119], v[128:131], v[64:79]
    v_mfma_f32_32x32x16_bf16 v[80:95], v[112:115], v[132:135], v[80:95]
    v_mfma_f32_32x32x16_bf16 v[96:111], v[116:119], v[132:135], v[96:111]
    v_mfma_f32_32x32x16_bf16 v[48:63], v[120:123], v[136:139], v[48:63]
    v_mfma_f32_32x32x16_bf16 v[64:79], v[124:127], v[136:139], v[64:79]
    v_mfma_f32_32x32x16_bf16 v[80:95], v[120:123], v[140:143], v[80:95]
    v_mfma_f32_32x32x16_bf16 v[96:111], v[124:127], v[140:143], v[96:111]
    s_and_b32 s36, s20, 1
    s_lshl_b32 s36, s36, 1
    s_lshl_b32 s37, s30, 2
    s_add_u32 s36, s36, s37
    s_lshl_b32 s36, s36, 15
    s_lshr_b32 s37, s20, 1
    s_lshl_b32 s37, s37, 1
    s_lshl_b32 s38, s31, 2
    s_add_u32 s37, s37, s38
    s_lshl_b32 s37, s37, 11
    s_add_u32 s36, s36, s37
    s_lshl_b32 s37, s32, 11
    s_add_u32 s36, s36, s37
    s_nop 7
    v_cvt_pk_bf16_f32 v48, v48, v49
    v_cvt_pk_bf16_f32 v49, v50, v51
    v_cvt_pk_bf16_f32 v50, v52, v53
    v_cvt_pk_bf16_f32 v51, v54, v55
    v_cvt_pk_bf16_f32 v52, v56, v57
    v_cvt_pk_bf16_f32 v53, v58, v59
    v_cvt_pk_bf16_f32 v54, v60, v61
    v_cvt_pk_bf16_f32 v55, v62, v63
    s_add_u32 s37, s36, 0
    buffer_store_dwordx4 v[48:51], v1, s[12:15], s37 offen offset:0 sc0 sc1
    buffer_store_dwordx4 v[52:55], v1, s[12:15], s37 offen offset:1024 sc0 sc1
    v_cvt_pk_bf16_f32 v64, v64, v65
    v_cvt_pk_bf16_f32 v65, v66, v67
    v_cvt_pk_bf16_f32 v66, v68, v69
    v_cvt_pk_bf16_f32 v67, v70, v71
    v_cvt_pk_bf16_f32 v68, v72, v73
    v_cvt_pk_bf16_f32 v69, v74, v75
    v_cvt_pk_bf16_f32 v70, v76, v77
    v_cvt_pk_bf16_f32 v71, v78, v79
    s_add_u32 s37, s36, 2048
    buffer_store_dwordx4 v[64:67], v1, s[12:15], s37 offen offset:0 sc0 sc1
    buffer_store_dwordx4 v[68:71], v1, s[12:15], s37 offen offset:1024 sc0 sc1
    v_cvt_pk_bf16_f32 v80, v80, v81
    v_cvt_pk_bf16_f32 v81, v82, v83
    v_cvt_pk_bf16_f32 v82, v84, v85
    v_cvt_pk_bf16_f32 v83, v86, v87
    v_cvt_pk_bf16_f32 v84, v88, v89
    v_cvt_pk_bf16_f32 v85, v90, v91
    v_cvt_pk_bf16_f32 v86, v92, v93
    v_cvt_pk_bf16_f32 v87, v94, v95
    s_add_u32 s37, s36, 32768
    buffer_store_dwordx4 v[80:83], v1, s[12:15], s37 offen offset:0 sc0 sc1
    buffer_store_dwordx4 v[84:87], v1, s[12:15], s37 offen offset:1024 sc0 sc1
    v_cvt_pk_bf16_f32 v96, v96, v97
    v_cvt_pk_bf16_f32 v97, v98, v99
    v_cvt_pk_bf16_f32 v98, v100, v101
    v_cvt_pk_bf16_f32 v99, v102, v103
    v_cvt_pk_bf16_f32 v100, v104, v105
    v_cvt_pk_bf16_f32 v101, v106, v107
    v_cvt_pk_bf16_f32 v102, v108, v109
    v_cvt_pk_bf16_f32 v103, v110, v111
    s_add_u32 s37, s36, 34816
    buffer_store_dwordx4 v[96:99], v1, s[12:15], s37 offen offset:0 sc0 sc1
    buffer_store_dwordx4 v[100:103], v1, s[12:15], s37 offen offset:1024 sc0 sc1
    s_load_dwordx2 s[40:41], s[0:1], 0
    s_waitcnt lgkmcnt(0)
    s_add_u32 s4, s68, 67108864
    s_addc_u32 s5, s69, 0
    s_mov_b32 s6, 8388608
    s_mov_b32 s7, 0x00020000
    s_mov_b32 s8, s40
    s_mov_b32 s9, s41
    s_mov_b32 s10, 2097152
    s_mov_b32 s11, 0x00020000
    s_mov_b32 s12, s68
    s_mov_b32 s13, s69
    s_mov_b32 s14, 16384
    s_mov_b32 s15, 0x00020000
    s_add_u32 s16, s68, 83886080
    s_addc_u32 s17, s69, 0
    s_mov_b32 s18, 2097152
    s_mov_b32 s19, 0x00020000
    s_add_u32 s24, s68, 88080384
    s_addc_u32 s25, s69, 0
    s_mov_b32 s26, 2097152
    s_mov_b32 s27, 0x00020000
    s_lshl_b32 s30, s60, 4
    s_add_u32 s30, s30, s61
    s_lshr_b32 s31, s30, 2
    s_and_b32 s32, s30, 3
    s_lshl_b32 s32, s32, 3
    v_and_b32 v2, 7, v0
    v_lshrrev_b32 v3, 3, v0
    v_and_b32 v4, 3, v3
    v_lshrrev_b32 v5, 2, v3
    v_add_u32 v6, s32, v2
    v_lshl_add_u32 v7, v5, 5, v6
    v_lshlrev_b32 v7, 4, v7
    v_lshrrev_b32 v11, 1, v4
    v_lshl_add_u32 v11, v11, 10, v7
    v_and_b32 v12, 1, v4
    v_lshl_add_u32 v11, v12, 3, v11
    s_lshl_b32 s33, s31, 15
    s_lshl_b32 s34, s20, 13
    s_add_u32 s33, s33, s34
    v_lshlrev_b32 v9, 10, v2
    v_lshl_add_u32 v9, v4, 4, v9
    v_lshl_add_u32 v9, v5, 3, v9
    s_lshl_b32 s35, s30, 13
    s_lshl_b32 s36, s20, 8
    s_add_u32 s35, s35, s36
    buffer_load_dwordx2 v[152:153], v9, s[8:11], s35 offen offset:0
    buffer_load_dwordx2 v[154:155], v9, s[8:11], s35 offen offset:64
    buffer_load_dwordx2 v[156:157], v9, s[8:11], s35 offen offset:128
    buffer_load_dwordx2 v[158:159], v9, s[8:11], s35 offen offset:192
    v_lshlrev_b32 v10, 5, v4
    v_lshl_add_u32 v10, v5, 4, v10
    s_lshl_b32 s36, s20, 9
    s_add_u32 s37, s36, 4096
    buffer_load_dwordx4 v[104:107], v10, s[12:15], s37 offen
    s_add_u32 s37, s36, 4224
    buffer_load_dwordx4 v[108:111], v10, s[12:15], s37 offen
    s_add_u32 s37, s36, 4352
    buffer_load_dwordx4 v[112:115], v10, s[12:15], s37 offen
    s_add_u32 s37, s36, 4480
    buffer_load_dwordx4 v[116:119], v10, s[12:15], s37 offen
    s_add_u32 s37, s36, 6144
    buffer_load_dwordx4 v[120:123], v10, s[12:15], s37 offen
    s_add_u32 s37, s36, 6272
    buffer_load_dwordx4 v[124:127], v10, s[12:15], s37 offen
    s_add_u32 s37, s36, 6400
    buffer_load_dwordx4 v[128:131], v10, s[12:15], s37 offen
    s_add_u32 s37, s36, 6528
    buffer_load_dwordx4 v[132:135], v10, s[12:15], s37 offen
    s_add_u32 s37, s36, 8192
    buffer_load_dwordx4 v[136:139], v10, s[12:15], s37 offen
    s_add_u32 s37, s36, 8320
    buffer_load_dwordx4 v[140:143], v10, s[12:15], s37 offen
    s_add_u32 s37, s36, 8448
    buffer_load_dwordx4 v[144:147], v10, s[12:15], s37 offen
    s_add_u32 s37, s36, 8576
    buffer_load_dwordx4 v[148:151], v10, s[12:15], s37 offen
    s_waitcnt vmcnt(0)
    s_barrier
    s_barrier
    s_add_u32 s37, s33, 0
    buffer_load_dwordx2 v[64:65], v11, s[4:7], s37 offen
    s_add_u32 s37, s33, 2048
    buffer_load_dwordx2 v[66:67], v11, s[4:7], s37 offen
    s_add_u32 s37, s33, 4096
    buffer_load_dwordx2 v[68:69], v11, s[4:7], s37 offen
    s_add_u32 s37, s33, 6144
    buffer_load_dwordx2 v[70:71], v11, s[4:7], s37 offen
    s_add_u32 s37, s33, 2097152
    buffer_load_dwordx2 v[72:73], v11, s[4:7], s37 offen
    s_add_u32 s37, s33, 2099200
    buffer_load_dwordx2 v[74:75], v11, s[4:7], s37 offen
    s_add_u32 s37, s33, 2101248
    buffer_load_dwordx2 v[76:77], v11, s[4:7], s37 offen
    s_add_u32 s37, s33, 2103296
    buffer_load_dwordx2 v[78:79], v11, s[4:7], s37 offen
    s_add_u32 s37, s33, 4194304
    buffer_load_dwordx2 v[80:81], v11, s[4:7], s37 offen
    s_add_u32 s37, s33, 4196352
    buffer_load_dwordx2 v[82:83], v11, s[4:7], s37 offen
    s_add_u32 s37, s33, 4198400
    buffer_load_dwordx2 v[84:85], v11, s[4:7], s37 offen
    s_add_u32 s37, s33, 4200448
    buffer_load_dwordx2 v[86:87], v11, s[4:7], s37 offen
    s_add_u32 s37, s33, 6291456
    buffer_load_dwordx2 v[88:89], v11, s[4:7], s37 offen
    s_add_u32 s37, s33, 6293504
    buffer_load_dwordx2 v[90:91], v11, s[4:7], s37 offen
    s_add_u32 s37, s33, 6295552
    buffer_load_dwordx2 v[92:93], v11, s[4:7], s37 offen
    s_add_u32 s37, s33, 6297600
    buffer_load_dwordx2 v[94:95], v11, s[4:7], s37 offen
    s_waitcnt vmcnt(12)
    v_lshlrev_b32 v32, 16, v64
    v_and_b32 v33, 0xffff0000, v64
    v_lshlrev_b32 v34, 16, v65
    v_and_b32 v35, 0xffff0000, v65
    v_lshlrev_b32 v36, 16, v66
    v_and_b32 v37, 0xffff0000, v66
    v_lshlrev_b32 v38, 16, v67
    v_and_b32 v39, 0xffff0000, v67
    v_lshlrev_b32 v40, 16, v68
    v_and_b32 v41, 0xffff0000, v68
    v_lshlrev_b32 v42, 16, v69
    v_and_b32 v43, 0xffff0000, v69
    v_lshlrev_b32 v44, 16, v70
    v_and_b32 v45, 0xffff0000, v70
    v_lshlrev_b32 v46, 16, v71
    v_and_b32 v47, 0xffff0000, v71
    s_waitcnt vmcnt(8)
    v_lshlrev_b32 v12, 16, v72
    v_and_b32 v13, 0xffff0000, v72
    v_add_f32 v32, v32, v12
    v_add_f32 v33, v33, v13
    v_lshlrev_b32 v12, 16, v73
    v_and_b32 v13, 0xffff0000, v73
    v_add_f32 v34, v34, v12
    v_add_f32 v35, v35, v13
    v_lshlrev_b32 v12, 16, v74
    v_and_b32 v13, 0xffff0000, v74
    v_add_f32 v36, v36, v12
    v_add_f32 v37, v37, v13
    v_lshlrev_b32 v12, 16, v75
    v_and_b32 v13, 0xffff0000, v75
    v_add_f32 v38, v38, v12
    v_add_f32 v39, v39, v13
    v_lshlrev_b32 v12, 16, v76
    v_and_b32 v13, 0xffff0000, v76
    v_add_f32 v40, v40, v12
    v_add_f32 v41, v41, v13
    v_lshlrev_b32 v12, 16, v77
    v_and_b32 v13, 0xffff0000, v77
    v_add_f32 v42, v42, v12
    v_add_f32 v43, v43, v13
    v_lshlrev_b32 v12, 16, v78
    v_and_b32 v13, 0xffff0000, v78
    v_add_f32 v44, v44, v12
    v_add_f32 v45, v45, v13
    v_lshlrev_b32 v12, 16, v79
    v_and_b32 v13, 0xffff0000, v79
    v_add_f32 v46, v46, v12
    v_add_f32 v47, v47, v13
    s_waitcnt vmcnt(4)
    v_lshlrev_b32 v12, 16, v80
    v_and_b32 v13, 0xffff0000, v80
    v_add_f32 v32, v32, v12
    v_add_f32 v33, v33, v13
    v_lshlrev_b32 v12, 16, v81
    v_and_b32 v13, 0xffff0000, v81
    v_add_f32 v34, v34, v12
    v_add_f32 v35, v35, v13
    v_lshlrev_b32 v12, 16, v82
    v_and_b32 v13, 0xffff0000, v82
    v_add_f32 v36, v36, v12
    v_add_f32 v37, v37, v13
    v_lshlrev_b32 v12, 16, v83
    v_and_b32 v13, 0xffff0000, v83
    v_add_f32 v38, v38, v12
    v_add_f32 v39, v39, v13
    v_lshlrev_b32 v12, 16, v84
    v_and_b32 v13, 0xffff0000, v84
    v_add_f32 v40, v40, v12
    v_add_f32 v41, v41, v13
    v_lshlrev_b32 v12, 16, v85
    v_and_b32 v13, 0xffff0000, v85
    v_add_f32 v42, v42, v12
    v_add_f32 v43, v43, v13
    v_lshlrev_b32 v12, 16, v86
    v_and_b32 v13, 0xffff0000, v86
    v_add_f32 v44, v44, v12
    v_add_f32 v45, v45, v13
    v_lshlrev_b32 v12, 16, v87
    v_and_b32 v13, 0xffff0000, v87
    v_add_f32 v46, v46, v12
    v_add_f32 v47, v47, v13
    s_waitcnt vmcnt(0)
    v_lshlrev_b32 v12, 16, v88
    v_and_b32 v13, 0xffff0000, v88
    v_add_f32 v32, v32, v12
    v_add_f32 v33, v33, v13
    v_lshlrev_b32 v12, 16, v89
    v_and_b32 v13, 0xffff0000, v89
    v_add_f32 v34, v34, v12
    v_add_f32 v35, v35, v13
    v_lshlrev_b32 v12, 16, v90
    v_and_b32 v13, 0xffff0000, v90
    v_add_f32 v36, v36, v12
    v_add_f32 v37, v37, v13
    v_lshlrev_b32 v12, 16, v91
    v_and_b32 v13, 0xffff0000, v91
    v_add_f32 v38, v38, v12
    v_add_f32 v39, v39, v13
    v_lshlrev_b32 v12, 16, v92
    v_and_b32 v13, 0xffff0000, v92
    v_add_f32 v40, v40, v12
    v_add_f32 v41, v41, v13
    v_lshlrev_b32 v12, 16, v93
    v_and_b32 v13, 0xffff0000, v93
    v_add_f32 v42, v42, v12
    v_add_f32 v43, v43, v13
    v_lshlrev_b32 v12, 16, v94
    v_and_b32 v13, 0xffff0000, v94
    v_add_f32 v44, v44, v12
    v_add_f32 v45, v45, v13
    v_lshlrev_b32 v12, 16, v95
    v_and_b32 v13, 0xffff0000, v95
    v_add_f32 v46, v46, v12
    v_add_f32 v47, v47, v13
    v_lshlrev_b32 v48, 16, v152
    v_and_b32 v49, 0xffff0000, v152
    v_lshlrev_b32 v50, 16, v153
    v_and_b32 v51, 0xffff0000, v153
    v_lshlrev_b32 v52, 16, v154
    v_and_b32 v53, 0xffff0000, v154
    v_lshlrev_b32 v54, 16, v155
    v_and_b32 v55, 0xffff0000, v155
    v_lshlrev_b32 v56, 16, v156
    v_and_b32 v57, 0xffff0000, v156
    v_lshlrev_b32 v58, 16, v157
    v_and_b32 v59, 0xffff0000, v157
    v_lshlrev_b32 v60, 16, v158
    v_and_b32 v61, 0xffff0000, v158
    v_lshlrev_b32 v62, 16, v159
    v_and_b32 v63, 0xffff0000, v159
    v_cvt_pk_bf16_f32 v12, v32, v33
    v_lshlrev_b32 v13, 16, v12
    v_and_b32 v14, 0xffff0000, v12
    v_mul_f32 v13, v13, v104
    v_mul_f32 v14, v14, v105
    v_cvt_pk_bf16_f32 v12, v13, v14
    v_lshlrev_b32 v13, 16, v12
    v_and_b32 v14, 0xffff0000, v12
    v_add_f32 v13, v13, v48
    v_add_f32 v14, v14, v49
    v_cvt_pk_bf16_f32 v64, v13, v14
    v_lshlrev_b32 v32, 16, v64
    v_and_b32 v33, 0xffff0000, v64
    v_cvt_pk_bf16_f32 v12, v34, v35
    v_lshlrev_b32 v13, 16, v12
    v_and_b32 v14, 0xffff0000, v12
    v_mul_f32 v13, v13, v106
    v_mul_f32 v14, v14, v107
    v_cvt_pk_bf16_f32 v12, v13, v14
    v_lshlrev_b32 v13, 16, v12
    v_and_b32 v14, 0xffff0000, v12
    v_add_f32 v13, v13, v50
    v_add_f32 v14, v14, v51
    v_cvt_pk_bf16_f32 v65, v13, v14
    v_lshlrev_b32 v34, 16, v65
    v_and_b32 v35, 0xffff0000, v65
    v_cvt_pk_bf16_f32 v12, v36, v37
    v_lshlrev_b32 v13, 16, v12
    v_and_b32 v14, 0xffff0000, v12
    v_mul_f32 v13, v13, v108
    v_mul_f32 v14, v14, v109
    v_cvt_pk_bf16_f32 v12, v13, v14
    v_lshlrev_b32 v13, 16, v12
    v_and_b32 v14, 0xffff0000, v12
    v_add_f32 v13, v13, v52
    v_add_f32 v14, v14, v53
    v_cvt_pk_bf16_f32 v66, v13, v14
    v_lshlrev_b32 v36, 16, v66
    v_and_b32 v37, 0xffff0000, v66
    v_cvt_pk_bf16_f32 v12, v38, v39
    v_lshlrev_b32 v13, 16, v12
    v_and_b32 v14, 0xffff0000, v12
    v_mul_f32 v13, v13, v110
    v_mul_f32 v14, v14, v111
    v_cvt_pk_bf16_f32 v12, v13, v14
    v_lshlrev_b32 v13, 16, v12
    v_and_b32 v14, 0xffff0000, v12
    v_add_f32 v13, v13, v54
    v_add_f32 v14, v14, v55
    v_cvt_pk_bf16_f32 v67, v13, v14
    v_lshlrev_b32 v38, 16, v67
    v_and_b32 v39, 0xffff0000, v67
    v_cvt_pk_bf16_f32 v12, v40, v41
    v_lshlrev_b32 v13, 16, v12
    v_and_b32 v14, 0xffff0000, v12
    v_mul_f32 v13, v13, v112
    v_mul_f32 v14, v14, v113
    v_cvt_pk_bf16_f32 v12, v13, v14
    v_lshlrev_b32 v13, 16, v12
    v_and_b32 v14, 0xffff0000, v12
    v_add_f32 v13, v13, v56
    v_add_f32 v14, v14, v57
    v_cvt_pk_bf16_f32 v68, v13, v14
    v_lshlrev_b32 v40, 16, v68
    v_and_b32 v41, 0xffff0000, v68
    v_cvt_pk_bf16_f32 v12, v42, v43
    v_lshlrev_b32 v13, 16, v12
    v_and_b32 v14, 0xffff0000, v12
    v_mul_f32 v13, v13, v114
    v_mul_f32 v14, v14, v115
    v_cvt_pk_bf16_f32 v12, v13, v14
    v_lshlrev_b32 v13, 16, v12
    v_and_b32 v14, 0xffff0000, v12
    v_add_f32 v13, v13, v58
    v_add_f32 v14, v14, v59
    v_cvt_pk_bf16_f32 v69, v13, v14
    v_lshlrev_b32 v42, 16, v69
    v_and_b32 v43, 0xffff0000, v69
    v_cvt_pk_bf16_f32 v12, v44, v45
    v_lshlrev_b32 v13, 16, v12
    v_and_b32 v14, 0xffff0000, v12
    v_mul_f32 v13, v13, v116
    v_mul_f32 v14, v14, v117
    v_cvt_pk_bf16_f32 v12, v13, v14
    v_lshlrev_b32 v13, 16, v12
    v_and_b32 v14, 0xffff0000, v12
    v_add_f32 v13, v13, v60
    v_add_f32 v14, v14, v61
    v_cvt_pk_bf16_f32 v70, v13, v14
    v_lshlrev_b32 v44, 16, v70
    v_and_b32 v45, 0xffff0000, v70
    v_cvt_pk_bf16_f32 v12, v46, v47
    v_lshlrev_b32 v13, 16, v12
    v_and_b32 v14, 0xffff0000, v12
    v_mul_f32 v13, v13, v118
    v_mul_f32 v14, v14, v119
    v_cvt_pk_bf16_f32 v12, v13, v14
    v_lshlrev_b32 v13, 16, v12
    v_and_b32 v14, 0xffff0000, v12
    v_add_f32 v13, v13, v62
    v_add_f32 v14, v14, v63
    v_cvt_pk_bf16_f32 v71, v13, v14
    v_lshlrev_b32 v46, 16, v71
    v_and_b32 v47, 0xffff0000, v71
    s_mov_b32 s35, s33
    s_add_u32 s37, s35, 0
    buffer_store_dwordx2 v[64:65], v11, s[16:19], s37 offen sc0 sc1
    s_add_u32 s37, s35, 2048
    buffer_store_dwordx2 v[66:67], v11, s[16:19], s37 offen sc0 sc1
    s_add_u32 s37, s35, 4096
    buffer_store_dwordx2 v[68:69], v11, s[16:19], s37 offen sc0 sc1
    s_add_u32 s37, s35, 6144
    buffer_store_dwordx2 v[70:71], v11, s[16:19], s37 offen sc0 sc1
    v_add_f32 v12, v32, v33
    v_add_f32 v12, v12, v34
    v_add_f32 v12, v12, v35
    v_add_f32 v12, v12, v36
    v_add_f32 v12, v12, v37
    v_add_f32 v12, v12, v38
    v_add_f32 v12, v12, v39
    v_add_f32 v12, v12, v40
    v_add_f32 v12, v12, v41
    v_add_f32 v12, v12, v42
    v_add_f32 v12, v12, v43
    v_add_f32 v12, v12, v44
    v_add_f32 v12, v12, v45
    v_add_f32 v12, v12, v46
    v_add_f32 v12, v12, v47
    s_nop 1
    v_add_f32_dpp v12, v12, v12 row_ror:8 row_mask:0xf bank_mask:0xf
    v_mov_b32 v13, v12
    s_nop 1
    v_permlane16_swap_b32 v12, v13
    s_nop 1
    v_add_f32 v12, v12, v13
    v_mov_b32 v13, v12
    s_nop 1
    v_permlane32_swap_b32 v12, v13
    s_nop 1
    v_add_f32 v12, v12, v13
    v_lshlrev_b32 v13, 2, v2
    s_lshl_b32 s38, s20, 5
    v_add_u32 v13, 114688, v13
    v_add_u32 v15, s38, v13
    ds_write_b32 v15, v12 offset:0
    s_waitcnt lgkmcnt(0)
    s_barrier
    ds_read_b32 v12, v13 offset:0
    ds_read_b32 v15, v13 offset:32
    ds_read_b32 v16, v13 offset:64
    ds_read_b32 v17, v13 offset:96
    s_waitcnt lgkmcnt(0)
    v_add_f32 v12, v12, v15
    v_add_f32 v16, v16, v17
    v_add_f32 v12, v12, v16
    v_mul_f32 v12, 0x3b000000, v12
    v_sub_f32 v32, v32, v12
    v_sub_f32 v33, v33, v12
    v_sub_f32 v34, v34, v12
    v_sub_f32 v35, v35, v12
    v_sub_f32 v36, v36, v12
    v_sub_f32 v37, v37, v12
    v_sub_f32 v38, v38, v12
    v_sub_f32 v39, v39, v12
    v_sub_f32 v40, v40, v12
    v_sub_f32 v41, v41, v12
    v_sub_f32 v42, v42, v12
    v_sub_f32 v43, v43, v12
    v_sub_f32 v44, v44, v12
    v_sub_f32 v45, v45, v12
    v_sub_f32 v46, v46, v12
    v_sub_f32 v47, v47, v12
    v_mul_f32 v12, v32, v32
    v_fma_f32 v12, v33, v33, v12
    v_fma_f32 v12, v34, v34, v12
    v_fma_f32 v12, v35, v35, v12
    v_fma_f32 v12, v36, v36, v12
    v_fma_f32 v12, v37, v37, v12
    v_fma_f32 v12, v38, v38, v12
    v_fma_f32 v12, v39, v39, v12
    v_fma_f32 v12, v40, v40, v12
    v_fma_f32 v12, v41, v41, v12
    v_fma_f32 v12, v42, v42, v12
    v_fma_f32 v12, v43, v43, v12
    v_fma_f32 v12, v44, v44, v12
    v_fma_f32 v12, v45, v45, v12
    v_fma_f32 v12, v46, v46, v12
    v_fma_f32 v12, v47, v47, v12
    s_nop 1
    v_add_f32_dpp v12, v12, v12 row_ror:8 row_mask:0xf bank_mask:0xf
    v_mov_b32 v13, v12
    s_nop 1
    v_permlane16_swap_b32 v12, v13
    s_nop 1
    v_add_f32 v12, v12, v13
    v_mov_b32 v13, v12
    s_nop 1
    v_permlane32_swap_b32 v12, v13
    s_nop 1
    v_add_f32 v12, v12, v13
    v_lshlrev_b32 v13, 2, v2
    s_lshl_b32 s38, s20, 5
    v_add_u32 v13, 114688, v13
    v_add_u32 v15, s38, v13
    ds_write_b32 v15, v12 offset:128
    s_waitcnt lgkmcnt(0)
    s_barrier
    ds_read_b32 v12, v13 offset:128
    ds_read_b32 v15, v13 offset:160
    ds_read_b32 v16, v13 offset:192
    ds_read_b32 v17, v13 offset:224
    s_waitcnt lgkmcnt(0)
    v_add_f32 v12, v12, v15
    v_add_f32 v16, v16, v17
    v_add_f32 v12, v12, v16
    v_mov_b32 v13, 0x3727c5ac
    s_mov_b32 s38, 0x3b000000
    v_fma_f32 v12, v12, s38, v13
    v_rsq_f32 v12, v12
    s_nop 0
    v_mul_f32 v32, v32, v12
    v_add_f32 v136, 1.0, v136
    v_fma_f32 v32, v32, v136, v120
    v_mul_f32 v33, v33, v12
    v_add_f32 v137, 1.0, v137
    v_fma_f32 v33, v33, v137, v121
    v_mul_f32 v34, v34, v12
    v_add_f32 v138, 1.0, v138
    v_fma_f32 v34, v34, v138, v122
    v_mul_f32 v35, v35, v12
    v_add_f32 v139, 1.0, v139
    v_fma_f32 v35, v35, v139, v123
    v_mul_f32 v36, v36, v12
    v_add_f32 v140, 1.0, v140
    v_fma_f32 v36, v36, v140, v124
    v_mul_f32 v37, v37, v12
    v_add_f32 v141, 1.0, v141
    v_fma_f32 v37, v37, v141, v125
    v_mul_f32 v38, v38, v12
    v_add_f32 v142, 1.0, v142
    v_fma_f32 v38, v38, v142, v126
    v_mul_f32 v39, v39, v12
    v_add_f32 v143, 1.0, v143
    v_fma_f32 v39, v39, v143, v127
    v_mul_f32 v40, v40, v12
    v_add_f32 v144, 1.0, v144
    v_fma_f32 v40, v40, v144, v128
    v_mul_f32 v41, v41, v12
    v_add_f32 v145, 1.0, v145
    v_fma_f32 v41, v41, v145, v129
    v_mul_f32 v42, v42, v12
    v_add_f32 v146, 1.0, v146
    v_fma_f32 v42, v42, v146, v130
    v_mul_f32 v43, v43, v12
    v_add_f32 v147, 1.0, v147
    v_fma_f32 v43, v43, v147, v131
    v_mul_f32 v44, v44, v12
    v_add_f32 v148, 1.0, v148
    v_fma_f32 v44, v44, v148, v132
    v_mul_f32 v45, v45, v12
    v_add_f32 v149, 1.0, v149
    v_fma_f32 v45, v45, v149, v133
    v_mul_f32 v46, v46, v12
    v_add_f32 v150, 1.0, v150
    v_fma_f32 v46, v46, v150, v134
    v_mul_f32 v47, v47, v12
    v_add_f32 v151, 1.0, v151
    v_fma_f32 v47, v47, v151, v135
    v_cvt_pk_bf16_f32 v64, v32, v33
    v_cvt_pk_bf16_f32 v65, v34, v35
    v_cvt_pk_bf16_f32 v66, v36, v37
    v_cvt_pk_bf16_f32 v67, v38, v39
    v_cvt_pk_bf16_f32 v68, v40, v41
    v_cvt_pk_bf16_f32 v69, v42, v43
    v_cvt_pk_bf16_f32 v70, v44, v45
    v_cvt_pk_bf16_f32 v71, v46, v47
    s_add_u32 s37, s35, 0
    buffer_store_dwordx2 v[64:65], v11, s[24:27], s37 offen sc0 sc1
    s_add_u32 s37, s35, 2048
    buffer_store_dwordx2 v[66:67], v11, s[24:27], s37 offen sc0 sc1
    s_add_u32 s37, s35, 4096
    buffer_store_dwordx2 v[68:69], v11, s[24:27], s37 offen sc0 sc1
    s_add_u32 s37, s35, 6144
    buffer_store_dwordx2 v[70:71], v11, s[24:27], s37 offen sc0 sc1
    s_waitcnt vmcnt(0)
    s_barrier
    s_barrier
    s_mov_b32 s30, s60
    s_min_u32 s31, s61, 13
    s_mov_b32 s32, 0
    v_lshrrev_b32 v9, 4, v0
    v_and_b32 v10, 15, v0
    v_lshrrev_b32 v11, 1, v9
    v_lshrrev_b32 v12, 2, v10
    v_lshl_add_u32 v11, v11, 2, v12
    v_lshlrev_b32 v11, 8, v11
    v_and_b32 v13, 1, v9
    v_lshl_add_u32 v11, v13, 5, v11
    v_and_b32 v13, 3, v10
    v_lshl_add_u32 v11, v13, 3, v11
    s_lshr_b32 s36, s20, 1
    s_lshl_b32 s36, s36, 1
    v_xor_b32 v13, s36, v12
    v_lshl_add_u32 v2, v13, 6, v11
    s_add_u32 s36, s36, 1
    v_xor_b32 v13, s36, v12
    v_lshl_add_u32 v3, v13, 6, v11
    s_and_b32 s36, s20, 1
    s_lshl_b32 s36, s36, 13
    s_add_u32 s36, s36, 16384
    v_add_u32 v4, s36, v1
    s_add_u32 s12, s68, 92274688
    s_addc_u32 s13, s69, 0
    s_mov_b32 s14, 7340032
    s_mov_b32 s15, 0x00020000
    s_cmp_ge_u32 s61, 14
    s_cselect_b32 s14, 0, s14
    s_barrier
    v_add_u32 v5, 98304, v2
    v_add_u32 v6, 98304, v3
    v_add_u32 v7, 98304, v4
    ds_read_b128 v[32:35], v7 offset:0
    ds_read_b128 v[36:39], v7 offset:4096
    ds_read_b64_tr_b16 v[16:17], v5 offset:0
    ds_read_b64_tr_b16 v[18:19], v5 offset:2048
    ds_read_b64_tr_b16 v[20:21], v6 offset:0
    ds_read_b64_tr_b16 v[22:23], v6 offset:2048
    ds_read_b128 v[40:43], v7 offset:1024
    ds_read_b128 v[44:47], v7 offset:5120
    ds_read_b64_tr_b16 v[24:25], v5 offset:4096
    ds_read_b64_tr_b16 v[26:27], v5 offset:6144
    ds_read_b64_tr_b16 v[28:29], v6 offset:4096
    ds_read_b64_tr_b16 v[30:31], v6 offset:6144
    s_waitcnt lgkmcnt(0)
    v_mfma_f32_32x32x16_bf16 v[48:63], v[16:19], v[32:35], 0
    ds_read_b128 v[128:131], v7 offset:2048
    ds_read_b128 v[132:135], v7 offset:6144
    v_mfma_f32_32x32x16_bf16 v[64:79], v[20:23], v[32:35], 0
    ds_read_b64_tr_b16 v[112:113], v5 offset:8192
    ds_read_b64_tr_b16 v[114:115], v5 offset:10240
    v_mfma_f32_32x32x16_bf16 v[80:95], v[16:19], v[36:39], 0
    ds_read_b64_tr_b16 v[116:117], v6 offset:8192
    ds_read_b64_tr_b16 v[118:119], v6 offset:10240
    v_mfma_f32_32x32x16_bf16 v[96:111], v[20:23], v[36:39], 0
    ds_read_b128 v[136:139], v7 offset:3072
    ds_read_b128 v[140:143], v7 offset:7168
    v_mfma_f32_32x32x16_bf16 v[48:63], v[24:27], v[40:43], v[48:63]
    ds_read_b64_tr_b16 v[120:121], v5 offset:12288
    ds_read_b64_tr_b16 v[122:123], v5 offset:14336
    v_mfma_f32_32x32x16_bf16 v[64:79], v[28:31], v[40:43], v[64:79]
    ds_read_b64_tr_b16 v[124:125], v6 offset:12288
    ds_read_b64_tr_b16 v[126:127], v6 offset:14336
    v_mfma_f32_32x32x16_bf16 v[80:95], v[24:27], v[44:47], v[80:95]
    v_mfma_f32_32x32x16_bf16 v[96:111], v[28:31], v[44:47], v[96:111]
    s_waitcnt lgkmcnt(0)
    s_barrier
    v_mfma_f32_32x32x16_bf16 v[48:63], v[112:115], v[128:131], v[48:63]
    v_add_u32 v5, 131072, v2
    v_add_u32 v6, 131072, v3
    v_add_u32 v7, 131072, v4
    v_mfma_f32_32x32x16_bf16 v[64:79], v[116:119], v[128:131], v[64:79]
    ds_read_b128 v[32:35], v7 offset:0
    ds_read_b128 v[36:39], v7 offset:4096
    ds_read_b64_tr_b16 v[16:17], v5 offset:0
    v_mfma_f32_32x32x16_bf16 v[80:95], v[112:115], v[132:135], v[80:95]
    ds_read_b64_tr_b16 v[18:19], v5 offset:2048
    ds_read_b64_tr_b16 v[20:21], v6 offset:0
    ds_read_b64_tr_b16 v[22:23], v6 offset:2048
    v_mfma_f32_32x32x16_bf16 v[96:111], v[116:119], v[132:135], v[96:111]
    ds_read_b128 v[40:43], v7 offset:1024
    ds_read_b128 v[44:47], v7 offset:5120
    ds_read_b64_tr_b16 v[24:25], v5 offset:4096
    v_mfma_f32_32x32x16_bf16 v[48:63], v[120:123], v[136:139], v[48:63]
    ds_read_b64_tr_b16 v[26:27], v5 offset:6144
    ds_read_b64_tr_b16 v[28:29], v6 offset:4096
    ds_read_b64_tr_b16 v[30:31], v6 offset:6144
    v_mfma_f32_32x32x16_bf16 v[64:79], v[124:127], v[136:139], v[64:79]
    v_mfma_f32_32x32x16_bf16 v[80:95], v[120:123], v[140:143], v[80:95]
    v_mfma_f32_32x32x16_bf16 v[96:111], v[124:127], v[140:143], v[96:111]
    s_waitcnt lgkmcnt(0)
    v_mfma_f32_32x32x16_bf16 v[48:63], v[16:19], v[32:35], v[48:63]
    ds_read_b128 v[128:131], v7 offset:2048
    ds_read_b128 v[132:135], v7 offset:6144
    v_mfma_f32_32x32x16_bf16 v[64:79], v[20:23], v[32:35], v[64:79]
    ds_read_b64_tr_b16 v[112:113], v5 offset:8192
    ds_read_b64_tr_b16 v[114:115], v5 offset:10240
    v_mfma_f32_32x32x16_bf16 v[80:95], v[16:19], v[36:39], v[80:95]
    ds_read_b64_tr_b16 v[116:117], v6 offset:8192
    ds_read_b64_tr_b16 v[118:119], v6 offset:10240
    v_mfma_f32_32x32x16_bf16 v[96:111], v[20:23], v[36:39], v[96:111]
    ds_read_b128 v[136:139], v7 offset:3072
    ds_read_b128 v[140:143], v7 offset:7168
    v_mfma_f32_32x32x16_bf16 v[48:63], v[24:27], v[40:43], v[48:63]
    ds_read_b64_tr_b16 v[120:121], v5 offset:12288
    ds_read_b64_tr_b16 v[122:123], v5 offset:14336
    v_mfma_f32_32x32x16_bf16 v[64:79], v[28:31], v[40:43], v[64:79]
    ds_read_b64_tr_b16 v[124:125], v6 offset:12288
    ds_read_b64_tr_b16 v[126:127], v6 offset:14336
    v_mfma_f32_32x32x16_bf16 v[80:95], v[24:27], v[44:47], v[80:95]
    v_mfma_f32_32x32x16_bf16 v[96:111], v[28:31], v[44:47], v[96:111]
    s_waitcnt lgkmcnt(0)
    s_barrier
    v_mfma_f32_32x32x16_bf16 v[48:63], v[112:115], v[128:131], v[48:63]
    v_add_u32 v5, 0, v2
    v_add_u32 v6, 0, v3
    v_add_u32 v7, 0, v4
    v_mfma_f32_32x32x16_bf16 v[64:79], v[116:119], v[128:131], v[64:79]
    ds_read_b128 v[32:35], v7 offset:0
    ds_read_b128 v[36:39], v7 offset:4096
    ds_read_b64_tr_b16 v[16:17], v5 offset:0
    v_mfma_f32_32x32x16_bf16 v[80:95], v[112:115], v[132:135], v[80:95]
    ds_read_b64_tr_b16 v[18:19], v5 offset:2048
    ds_read_b64_tr_b16 v[20:21], v6 offset:0
    ds_read_b64_tr_b16 v[22:23], v6 offset:2048
    v_mfma_f32_32x32x16_bf16 v[96:111], v[116:119], v[132:135], v[96:111]
    ds_read_b128 v[40:43], v7 offset:1024
    ds_read_b128 v[44:47], v7 offset:5120
    ds_read_b64_tr_b16 v[24:25], v5 offset:4096
    v_mfma_f32_32x32x16_bf16 v[48:63], v[120:123], v[136:139], v[48:63]
    ds_read_b64_tr_b16 v[26:27], v5 offset:6144
    ds_read_b64_tr_b16 v[28:29], v6 offset:4096
    ds_read_b64_tr_b16 v[30:31], v6 offset:6144
    v_mfma_f32_32x32x16_bf16 v[64:79], v[124:127], v[136:139], v[64:79]
    v_mfma_f32_32x32x16_bf16 v[80:95], v[120:123], v[140:143], v[80:95]
    v_mfma_f32_32x32x16_bf16 v[96:111], v[124:127], v[140:143], v[96:111]
    s_waitcnt lgkmcnt(0)
    v_mfma_f32_32x32x16_bf16 v[48:63], v[16:19], v[32:35], v[48:63]
    ds_read_b128 v[128:131], v7 offset:2048
    ds_read_b128 v[132:135], v7 offset:6144
    v_mfma_f32_32x32x16_bf16 v[64:79], v[20:23], v[32:35], v[64:79]
    ds_read_b64_tr_b16 v[112:113], v5 offset:8192
    ds_read_b64_tr_b16 v[114:115], v5 offset:10240
    v_mfma_f32_32x32x16_bf16 v[80:95], v[16:19], v[36:39], v[80:95]
    ds_read_b64_tr_b16 v[116:117], v6 offset:8192
    ds_read_b64_tr_b16 v[118:119], v6 offset:10240
    v_mfma_f32_32x32x16_bf16 v[96:111], v[20:23], v[36:39], v[96:111]
    ds_read_b128 v[136:139], v7 offset:3072
    ds_read_b128 v[140:143], v7 offset:7168
    v_mfma_f32_32x32x16_bf16 v[48:63], v[24:27], v[40:43], v[48:63]
    ds_read_b64_tr_b16 v[120:121], v5 offset:12288
    ds_read_b64_tr_b16 v[122:123], v5 offset:14336
    v_mfma_f32_32x32x16_bf16 v[64:79], v[28:31], v[40:43], v[64:79]
    ds_read_b64_tr_b16 v[124:125], v6 offset:12288
    ds_read_b64_tr_b16 v[126:127], v6 offset:14336
    v_mfma_f32_32x32x16_bf16 v[80:95], v[24:27], v[44:47], v[80:95]
    v_mfma_f32_32x32x16_bf16 v[96:111], v[28:31], v[44:47], v[96:111]
    s_waitcnt lgkmcnt(0)
    s_barrier
    v_mfma_f32_32x32x16_bf16 v[48:63], v[112:115], v[128:131], v[48:63]
    v_add_u32 v5, 32768, v2
    v_add_u32 v6, 32768, v3
    v_add_u32 v7, 32768, v4
    v_mfma_f32_32x32x16_bf16 v[64:79], v[116:119], v[128:131], v[64:79]
    ds_read_b128 v[32:35], v7 offset:0
    ds_read_b128 v[36:39], v7 offset:4096
    ds_read_b64_tr_b16 v[16:17], v5 offset:0
    v_mfma_f32_32x32x16_bf16 v[80:95], v[112:115], v[132:135], v[80:95]
    ds_read_b64_tr_b16 v[18:19], v5 offset:2048
    ds_read_b64_tr_b16 v[20:21], v6 offset:0
    ds_read_b64_tr_b16 v[22:23], v6 offset:2048
    v_mfma_f32_32x32x16_bf16 v[96:111], v[116:119], v[132:135], v[96:111]
    ds_read_b128 v[40:43], v7 offset:1024
    ds_read_b128 v[44:47], v7 offset:5120
    ds_read_b64_tr_b16 v[24:25], v5 offset:4096
    v_mfma_f32_32x32x16_bf16 v[48:63], v[120:123], v[136:139], v[48:63]
    ds_read_b64_tr_b16 v[26:27], v5 offset:6144
    ds_read_b64_tr_b16 v[28:29], v6 offset:4096
    ds_read_b64_tr_b16 v[30:31], v6 offset:6144
    v_mfma_f32_32x32x16_bf16 v[64:79], v[124:127], v[136:139], v[64:79]
    v_mfma_f32_32x32x16_bf16 v[80:95], v[120:123], v[140:143], v[80:95]
    v_mfma_f32_32x32x16_bf16 v[96:111], v[124:127], v[140:143], v[96:111]
    s_waitcnt lgkmcnt(0)
    v_mfma_f32_32x32x16_bf16 v[48:63], v[16:19], v[32:35], v[48:63]
    ds_read_b128 v[128:131], v7 offset:2048
    ds_read_b128 v[132:135], v7 offset:6144
    v_mfma_f32_32x32x16_bf16 v[64:79], v[20:23], v[32:35], v[64:79]
    ds_read_b64_tr_b16 v[112:113], v5 offset:8192
    ds_read_b64_tr_b16 v[114:115], v5 offset:10240
    v_mfma_f32_32x32x16_bf16 v[80:95], v[16:19], v[36:39], v[80:95]
    ds_read_b64_tr_b16 v[116:117], v6 offset:8192
    ds_read_b64_tr_b16 v[118:119], v6 offset:10240
    v_mfma_f32_32x32x16_bf16 v[96:111], v[20:23], v[36:39], v[96:111]
    ds_read_b128 v[136:139], v7 offset:3072
    ds_read_b128 v[140:143], v7 offset:7168
    v_mfma_f32_32x32x16_bf16 v[48:63], v[24:27], v[40:43], v[48:63]
    ds_read_b64_tr_b16 v[120:121], v5 offset:12288
    ds_read_b64_tr_b16 v[122:123], v5 offset:14336
    v_mfma_f32_32x32x16_bf16 v[64:79], v[28:31], v[40:43], v[64:79]
    ds_read_b64_tr_b16 v[124:125], v6 offset:12288
    ds_read_b64_tr_b16 v[126:127], v6 offset:14336
    v_mfma_f32_32x32x16_bf16 v[80:95], v[24:27], v[44:47], v[80:95]
    v_mfma_f32_32x32x16_bf16 v[96:111], v[28:31], v[44:47], v[96:111]
    s_waitcnt lgkmcnt(0)
    s_barrier
    v_mfma_f32_32x32x16_bf16 v[48:63], v[112:115], v[128:131], v[48:63]
    v_add_u32 v5, 65536, v2
    v_add_u32 v6, 65536, v3
    v_add_u32 v7, 65536, v4
    v_mfma_f32_32x32x16_bf16 v[64:79], v[116:119], v[128:131], v[64:79]
    ds_read_b128 v[32:35], v7 offset:0
    ds_read_b128 v[36:39], v7 offset:4096
    ds_read_b64_tr_b16 v[16:17], v5 offset:0
    v_mfma_f32_32x32x16_bf16 v[80:95], v[112:115], v[132:135], v[80:95]
    ds_read_b64_tr_b16 v[18:19], v5 offset:2048
    ds_read_b64_tr_b16 v[20:21], v6 offset:0
    ds_read_b64_tr_b16 v[22:23], v6 offset:2048
    v_mfma_f32_32x32x16_bf16 v[96:111], v[116:119], v[132:135], v[96:111]
    ds_read_b128 v[40:43], v7 offset:1024
    ds_read_b128 v[44:47], v7 offset:5120
    ds_read_b64_tr_b16 v[24:25], v5 offset:4096
    v_mfma_f32_32x32x16_bf16 v[48:63], v[120:123], v[136:139], v[48:63]
    ds_read_b64_tr_b16 v[26:27], v5 offset:6144
    ds_read_b64_tr_b16 v[28:29], v6 offset:4096
    ds_read_b64_tr_b16 v[30:31], v6 offset:6144
    v_mfma_f32_32x32x16_bf16 v[64:79], v[124:127], v[136:139], v[64:79]
    v_mfma_f32_32x32x16_bf16 v[80:95], v[120:123], v[140:143], v[80:95]
    v_mfma_f32_32x32x16_bf16 v[96:111], v[124:127], v[140:143], v[96:111]
    s_waitcnt lgkmcnt(0)
    v_mfma_f32_32x32x16_bf16 v[48:63], v[16:19], v[32:35], v[48:63]
    ds_read_b128 v[128:131], v7 offset:2048
    ds_read_b128 v[132:135], v7 offset:6144
    v_mfma_f32_32x32x16_bf16 v[64:79], v[20:23], v[32:35], v[64:79]
    ds_read_b64_tr_b16 v[112:113], v5 offset:8192
    ds_read_b64_tr_b16 v[114:115], v5 offset:10240
    v_mfma_f32_32x32x16_bf16 v[80:95], v[16:19], v[36:39], v[80:95]
    ds_read_b64_tr_b16 v[116:117], v6 offset:8192
    ds_read_b64_tr_b16 v[118:119], v6 offset:10240
    v_mfma_f32_32x32x16_bf16 v[96:111], v[20:23], v[36:39], v[96:111]
    ds_read_b128 v[136:139], v7 offset:3072
    ds_read_b128 v[140:143], v7 offset:7168
    v_mfma_f32_32x32x16_bf16 v[48:63], v[24:27], v[40:43], v[48:63]
    ds_read_b64_tr_b16 v[120:121], v5 offset:12288
    ds_read_b64_tr_b16 v[122:123], v5 offset:14336
    v_mfma_f32_32x32x16_bf16 v[64:79], v[28:31], v[40:43], v[64:79]
    ds_read_b64_tr_b16 v[124:125], v6 offset:12288
    ds_read_b64_tr_b16 v[126:127], v6 offset:14336
    v_mfma_f32_32x32x16_bf16 v[80:95], v[24:27], v[44:47], v[80:95]
    v_mfma_f32_32x32x16_bf16 v[96:111], v[28:31], v[44:47], v[96:111]
    s_waitcnt lgkmcnt(0)
    s_barrier
    v_mfma_f32_32x32x16_bf16 v[48:63], v[112:115], v[128:131], v[48:63]
    v_add_u32 v5, 98304, v2
    v_add_u32 v6, 98304, v3
    v_add_u32 v7, 98304, v4
    v_mfma_f32_32x32x16_bf16 v[64:79], v[116:119], v[128:131], v[64:79]
    ds_read_b128 v[32:35], v7 offset:0
    ds_read_b128 v[36:39], v7 offset:4096
    ds_read_b64_tr_b16 v[16:17], v5 offset:0
    v_mfma_f32_32x32x16_bf16 v[80:95], v[112:115], v[132:135], v[80:95]
    ds_read_b64_tr_b16 v[18:19], v5 offset:2048
    ds_read_b64_tr_b16 v[20:21], v6 offset:0
    ds_read_b64_tr_b16 v[22:23], v6 offset:2048
    v_mfma_f32_32x32x16_bf16 v[96:111], v[116:119], v[132:135], v[96:111]
    ds_read_b128 v[40:43], v7 offset:1024
    ds_read_b128 v[44:47], v7 offset:5120
    ds_read_b64_tr_b16 v[24:25], v5 offset:4096
    v_mfma_f32_32x32x16_bf16 v[48:63], v[120:123], v[136:139], v[48:63]
    ds_read_b64_tr_b16 v[26:27], v5 offset:6144
    ds_read_b64_tr_b16 v[28:29], v6 offset:4096
    ds_read_b64_tr_b16 v[30:31], v6 offset:6144
    v_mfma_f32_32x32x16_bf16 v[64:79], v[124:127], v[136:139], v[64:79]
    v_mfma_f32_32x32x16_bf16 v[80:95], v[120:123], v[140:143], v[80:95]
    v_mfma_f32_32x32x16_bf16 v[96:111], v[124:127], v[140:143], v[96:111]
    s_waitcnt lgkmcnt(0)
    v_mfma_f32_32x32x16_bf16 v[48:63], v[16:19], v[32:35], v[48:63]
    ds_read_b128 v[128:131], v7 offset:2048
    ds_read_b128 v[132:135], v7 offset:6144
    v_mfma_f32_32x32x16_bf16 v[64:79], v[20:23], v[32:35], v[64:79]
    ds_read_b64_tr_b16 v[112:113], v5 offset:8192
    ds_read_b64_tr_b16 v[114:115], v5 offset:10240
    v_mfma_f32_32x32x16_bf16 v[80:95], v[16:19], v[36:39], v[80:95]
    ds_read_b64_tr_b16 v[116:117], v6 offset:8192
    ds_read_b64_tr_b16 v[118:119], v6 offset:10240
    v_mfma_f32_32x32x16_bf16 v[96:111], v[20:23], v[36:39], v[96:111]
    ds_read_b128 v[136:139], v7 offset:3072
    ds_read_b128 v[140:143], v7 offset:7168
    v_mfma_f32_32x32x16_bf16 v[48:63], v[24:27], v[40:43], v[48:63]
    ds_read_b64_tr_b16 v[120:121], v5 offset:12288
    ds_read_b64_tr_b16 v[122:123], v5 offset:14336
    v_mfma_f32_32x32x16_bf16 v[64:79], v[28:31], v[40:43], v[64:79]
    ds_read_b64_tr_b16 v[124:125], v6 offset:12288
    ds_read_b64_tr_b16 v[126:127], v6 offset:14336
    v_mfma_f32_32x32x16_bf16 v[80:95], v[24:27], v[44:47], v[80:95]
    v_mfma_f32_32x32x16_bf16 v[96:111], v[28:31], v[44:47], v[96:111]
    s_waitcnt lgkmcnt(0)
    s_barrier
    v_mfma_f32_32x32x16_bf16 v[48:63], v[112:115], v[128:131], v[48:63]
    v_add_u32 v5, 131072, v2
    v_add_u32 v6, 131072, v3
    v_add_u32 v7, 131072, v4
    v_mfma_f32_32x32x16_bf16 v[64:79], v[116:119], v[128:131], v[64:79]
    ds_read_b128 v[32:35], v7 offset:0
    ds_read_b128 v[36:39], v7 offset:4096
    ds_read_b64_tr_b16 v[16:17], v5 offset:0
    v_mfma_f32_32x32x16_bf16 v[80:95], v[112:115], v[132:135], v[80:95]
    ds_read_b64_tr_b16 v[18:19], v5 offset:2048
    ds_read_b64_tr_b16 v[20:21], v6 offset:0
    ds_read_b64_tr_b16 v[22:23], v6 offset:2048
    v_mfma_f32_32x32x16_bf16 v[96:111], v[116:119], v[132:135], v[96:111]
    ds_read_b128 v[40:43], v7 offset:1024
    ds_read_b128 v[44:47], v7 offset:5120
    ds_read_b64_tr_b16 v[24:25], v5 offset:4096
    v_mfma_f32_32x32x16_bf16 v[48:63], v[120:123], v[136:139], v[48:63]
    ds_read_b64_tr_b16 v[26:27], v5 offset:6144
    ds_read_b64_tr_b16 v[28:29], v6 offset:4096
    ds_read_b64_tr_b16 v[30:31], v6 offset:6144
    v_mfma_f32_32x32x16_bf16 v[64:79], v[124:127], v[136:139], v[64:79]
    v_mfma_f32_32x32x16_bf16 v[80:95], v[120:123], v[140:143], v[80:95]
    v_mfma_f32_32x32x16_bf16 v[96:111], v[124:127], v[140:143], v[96:111]
    s_waitcnt lgkmcnt(0)
    v_mfma_f32_32x32x16_bf16 v[48:63], v[16:19], v[32:35], v[48:63]
    ds_read_b128 v[128:131], v7 offset:2048
    ds_read_b128 v[132:135], v7 offset:6144
    v_mfma_f32_32x32x16_bf16 v[64:79], v[20:23], v[32:35], v[64:79]
    ds_read_b64_tr_b16 v[112:113], v5 offset:8192
    ds_read_b64_tr_b16 v[114:115], v5 offset:10240
    v_mfma_f32_32x32x16_bf16 v[80:95], v[16:19], v[36:39], v[80:95]
    ds_read_b64_tr_b16 v[116:117], v6 offset:8192
    ds_read_b64_tr_b16 v[118:119], v6 offset:10240
    v_mfma_f32_32x32x16_bf16 v[96:111], v[20:23], v[36:39], v[96:111]
    ds_read_b128 v[136:139], v7 offset:3072
    ds_read_b128 v[140:143], v7 offset:7168
    v_mfma_f32_32x32x16_bf16 v[48:63], v[24:27], v[40:43], v[48:63]
    ds_read_b64_tr_b16 v[120:121], v5 offset:12288
    ds_read_b64_tr_b16 v[122:123], v5 offset:14336
    v_mfma_f32_32x32x16_bf16 v[64:79], v[28:31], v[40:43], v[64:79]
    ds_read_b64_tr_b16 v[124:125], v6 offset:12288
    ds_read_b64_tr_b16 v[126:127], v6 offset:14336
    v_mfma_f32_32x32x16_bf16 v[80:95], v[24:27], v[44:47], v[80:95]
    v_mfma_f32_32x32x16_bf16 v[96:111], v[28:31], v[44:47], v[96:111]
    s_waitcnt lgkmcnt(0)
    s_barrier
    v_mfma_f32_32x32x16_bf16 v[48:63], v[112:115], v[128:131], v[48:63]
    v_add_u32 v5, 0, v2
    v_add_u32 v6, 0, v3
    v_add_u32 v7, 0, v4
    v_mfma_f32_32x32x16_bf16 v[64:79], v[116:119], v[128:131], v[64:79]
    ds_read_b128 v[32:35], v7 offset:0
    ds_read_b128 v[36:39], v7 offset:4096
    ds_read_b64_tr_b16 v[16:17], v5 offset:0
    v_mfma_f32_32x32x16_bf16 v[80:95], v[112:115], v[132:135], v[80:95]
    ds_read_b64_tr_b16 v[18:19], v5 offset:2048
    ds_read_b64_tr_b16 v[20:21], v6 offset:0
    ds_read_b64_tr_b16 v[22:23], v6 offset:2048
    v_mfma_f32_32x32x16_bf16 v[96:111], v[116:119], v[132:135], v[96:111]
    ds_read_b128 v[40:43], v7 offset:1024
    ds_read_b128 v[44:47], v7 offset:5120
    ds_read_b64_tr_b16 v[24:25], v5 offset:4096
    v_mfma_f32_32x32x16_bf16 v[48:63], v[120:123], v[136:139], v[48:63]
    ds_read_b64_tr_b16 v[26:27], v5 offset:6144
    ds_read_b64_tr_b16 v[28:29], v6 offset:4096
    ds_read_b64_tr_b16 v[30:31], v6 offset:6144
    v_mfma_f32_32x32x16_bf16 v[64:79], v[124:127], v[136:139], v[64:79]
    v_mfma_f32_32x32x16_bf16 v[80:95], v[120:123], v[140:143], v[80:95]
    v_mfma_f32_32x32x16_bf16 v[96:111], v[124:127], v[140:143], v[96:111]
    s_waitcnt lgkmcnt(0)
    v_mfma_f32_32x32x16_bf16 v[48:63], v[16:19], v[32:35], v[48:63]
    ds_read_b128 v[128:131], v7 offset:2048
    ds_read_b128 v[132:135], v7 offset:6144
    v_mfma_f32_32x32x16_bf16 v[64:79], v[20:23], v[32:35], v[64:79]
    ds_read_b64_tr_b16 v[112:113], v5 offset:8192
    ds_read_b64_tr_b16 v[114:115], v5 offset:10240
    v_mfma_f32_32x32x16_bf16 v[80:95], v[16:19], v[36:39], v[80:95]
    ds_read_b64_tr_b16 v[116:117], v6 offset:8192
    ds_read_b64_tr_b16 v[118:119], v6 offset:10240
    v_mfma_f32_32x32x16_bf16 v[96:111], v[20:23], v[36:39], v[96:111]
    ds_read_b128 v[136:139], v7 offset:3072
    ds_read_b128 v[140:143], v7 offset:7168
    v_mfma_f32_32x32x16_bf16 v[48:63], v[24:27], v[40:43], v[48:63]
    ds_read_b64_tr_b16 v[120:121], v5 offset:12288
    ds_read_b64_tr_b16 v[122:123], v5 offset:14336
    v_mfma_f32_32x32x16_bf16 v[64:79], v[28:31], v[40:43], v[64:79]
    ds_read_b64_tr_b16 v[124:125], v6 offset:12288
    ds_read_b64_tr_b16 v[126:127], v6 offset:14336
    v_mfma_f32_32x32x16_bf16 v[80:95], v[24:27], v[44:47], v[80:95]
    v_mfma_f32_32x32x16_bf16 v[96:111], v[28:31], v[44:47], v[96:111]
    s_waitcnt lgkmcnt(0)
    v_mfma_f32_32x32x16_bf16 v[48:63], v[112:115], v[128:131], v[48:63]
    v_mfma_f32_32x32x16_bf16 v[64:79], v[116:119], v[128:131], v[64:79]
    v_mfma_f32_32x32x16_bf16 v[80:95], v[112:115], v[132:135], v[80:95]
    v_mfma_f32_32x32x16_bf16 v[96:111], v[116:119], v[132:135], v[96:111]
    v_mfma_f32_32x32x16_bf16 v[48:63], v[120:123], v[136:139], v[48:63]
    v_mfma_f32_32x32x16_bf16 v[64:79], v[124:127], v[136:139], v[64:79]
    v_mfma_f32_32x32x16_bf16 v[80:95], v[120:123], v[140:143], v[80:95]
    v_mfma_f32_32x32x16_bf16 v[96:111], v[124:127], v[140:143], v[96:111]
    s_and_b32 s36, s20, 1
    s_lshl_b32 s36, s36, 1
    s_lshl_b32 s37, s30, 2
    s_add_u32 s36, s36, s37
    s_mul_i32 s36, s36, 114688
    s_lshr_b32 s37, s20, 1
    s_lshl_b32 s37, s37, 1
    s_lshl_b32 s38, s31, 2
    s_add_u32 s37, s37, s38
    s_lshl_b32 s37, s37, 11
    s_add_u32 s36, s36, s37
    s_nop 7
    v_mul_f32 v16, 0xbfb8aa3b, v48
    v_mul_f32 v17, 0xbfb8aa3b, v49
    v_mul_f32 v18, 0xbfb8aa3b, v50
    v_mul_f32 v19, 0xbfb8aa3b, v51
    v_mul_f32 v20, 0xbfb8aa3b, v52
    v_mul_f32 v21, 0xbfb8aa3b, v53
    v_mul_f32 v22, 0xbfb8aa3b, v54
    v_mul_f32 v23, 0xbfb8aa3b, v55
    v_mul_f32 v24, 0xbfb8aa3b, v56
    v_mul_f32 v25, 0xbfb8aa3b, v57
    v_mul_f32 v26, 0xbfb8aa3b, v58
    v_mul_f32 v27, 0xbfb8aa3b, v59
    v_mul_f32 v28, 0xbfb8aa3b, v60
    v_mul_f32 v29, 0xbfb8aa3b, v61
    v_mul_f32 v30, 0xbfb8aa3b, v62
    v_mul_f32 v31, 0xbfb8aa3b, v63
    v_exp_f32 v16, v16
    v_exp_f32 v17, v17
    v_exp_f32 v18, v18
    v_exp_f32 v19, v19
    v_exp_f32 v20, v20
    v_exp_f32 v21, v21
    v_exp_f32 v22, v22
    v_exp_f32 v23, v23
    v_exp_f32 v24, v24
    v_exp_f32 v25, v25
    v_exp_f32 v26, v26
    v_exp_f32 v27, v27
    v_exp_f32 v28, v28
    v_exp_f32 v29, v29
    v_exp_f32 v30, v30
    v_exp_f32 v31, v31
    v_add_f32 v16, 1.0, v16
    v_add_f32 v17, 1.0, v17
    v_add_f32 v18, 1.0, v18
    v_add_f32 v19, 1.0, v19
    v_add_f32 v20, 1.0, v20
    v_add_f32 v21, 1.0, v21
    v_add_f32 v22, 1.0, v22
    v_add_f32 v23, 1.0, v23
    v_add_f32 v24, 1.0, v24
    v_add_f32 v25, 1.0, v25
    v_add_f32 v26, 1.0, v26
    v_add_f32 v27, 1.0, v27
    v_add_f32 v28, 1.0, v28
    v_add_f32 v29, 1.0, v29
    v_add_f32 v30, 1.0, v30
    v_add_f32 v31, 1.0, v31
    v_rcp_f32 v16, v16
    v_rcp_f32 v17, v17
    v_rcp_f32 v18, v18
    v_rcp_f32 v19, v19
    v_rcp_f32 v20, v20
    v_rcp_f32 v21, v21
    v_rcp_f32 v22, v22
    v_rcp_f32 v23, v23
    v_rcp_f32 v24, v24
    v_rcp_f32 v25, v25
    v_rcp_f32 v26, v26
    v_rcp_f32 v27, v27
    v_rcp_f32 v28, v28
    v_rcp_f32 v29, v29
    v_rcp_f32 v30, v30
    v_rcp_f32 v31, v31
    v_mul_f32 v48, v48, v16
    v_mul_f32 v49, v49, v17
    v_mul_f32 v50, v50, v18
    v_mul_f32 v51, v51, v19
    v_mul_f32 v52, v52, v20
    v_mul_f32 v53, v53, v21
    v_mul_f32 v54, v54, v22
    v_mul_f32 v55, v55, v23
    v_mul_f32 v56, v56, v24
    v_mul_f32 v57, v57, v25
    v_mul_f32 v58, v58, v26
    v_mul_f32 v59, v59, v27
    v_mul_f32 v60, v60, v28
    v_mul_f32 v61, v61, v29
    v_mul_f32 v62, v62, v30
    v_mul_f32 v63, v63, v31
    v_cvt_pk_bf16_f32 v48, v48, v49
    v_cvt_pk_bf16_f32 v49, v50, v51
    v_cvt_pk_bf16_f32 v50, v52, v53
    v_cvt_pk_bf16_f32 v51, v54, v55
    v_cvt_pk_bf16_f32 v52, v56, v57
    v_cvt_pk_bf16_f32 v53, v58, v59
    v_cvt_pk_bf16_f32 v54, v60, v61
    v_cvt_pk_bf16_f32 v55, v62, v63
    s_add_u32 s37, s36, 0
    buffer_store_dwordx4 v[48:51], v1, s[12:15], s37 offen offset:0 sc0 sc1
    buffer_store_dwordx4 v[52:55], v1, s[12:15], s37 offen offset:1024 sc0 sc1
    v_mul_f32 v16, 0xbfb8aa3b, v64
    v_mul_f32 v17, 0xbfb8aa3b, v65
    v_mul_f32 v18, 0xbfb8aa3b, v66
    v_mul_f32 v19, 0xbfb8aa3b, v67
    v_mul_f32 v20, 0xbfb8aa3b, v68
    v_mul_f32 v21, 0xbfb8aa3b, v69
    v_mul_f32 v22, 0xbfb8aa3b, v70
    v_mul_f32 v23, 0xbfb8aa3b, v71
    v_mul_f32 v24, 0xbfb8aa3b, v72
    v_mul_f32 v25, 0xbfb8aa3b, v73
    v_mul_f32 v26, 0xbfb8aa3b, v74
    v_mul_f32 v27, 0xbfb8aa3b, v75
    v_mul_f32 v28, 0xbfb8aa3b, v76
    v_mul_f32 v29, 0xbfb8aa3b, v77
    v_mul_f32 v30, 0xbfb8aa3b, v78
    v_mul_f32 v31, 0xbfb8aa3b, v79
    v_exp_f32 v16, v16
    v_exp_f32 v17, v17
    v_exp_f32 v18, v18
    v_exp_f32 v19, v19
    v_exp_f32 v20, v20
    v_exp_f32 v21, v21
    v_exp_f32 v22, v22
    v_exp_f32 v23, v23
    v_exp_f32 v24, v24
    v_exp_f32 v25, v25
    v_exp_f32 v26, v26
    v_exp_f32 v27, v27
    v_exp_f32 v28, v28
    v_exp_f32 v29, v29
    v_exp_f32 v30, v30
    v_exp_f32 v31, v31
    v_add_f32 v16, 1.0, v16
    v_add_f32 v17, 1.0, v17
    v_add_f32 v18, 1.0, v18
    v_add_f32 v19, 1.0, v19
    v_add_f32 v20, 1.0, v20
    v_add_f32 v21, 1.0, v21
    v_add_f32 v22, 1.0, v22
    v_add_f32 v23, 1.0, v23
    v_add_f32 v24, 1.0, v24
    v_add_f32 v25, 1.0, v25
    v_add_f32 v26, 1.0, v26
    v_add_f32 v27, 1.0, v27
    v_add_f32 v28, 1.0, v28
    v_add_f32 v29, 1.0, v29
    v_add_f32 v30, 1.0, v30
    v_add_f32 v31, 1.0, v31
    v_rcp_f32 v16, v16
    v_rcp_f32 v17, v17
    v_rcp_f32 v18, v18
    v_rcp_f32 v19, v19
    v_rcp_f32 v20, v20
    v_rcp_f32 v21, v21
    v_rcp_f32 v22, v22
    v_rcp_f32 v23, v23
    v_rcp_f32 v24, v24
    v_rcp_f32 v25, v25
    v_rcp_f32 v26, v26
    v_rcp_f32 v27, v27
    v_rcp_f32 v28, v28
    v_rcp_f32 v29, v29
    v_rcp_f32 v30, v30
    v_rcp_f32 v31, v31
    v_mul_f32 v64, v64, v16
    v_mul_f32 v65, v65, v17
    v_mul_f32 v66, v66, v18
    v_mul_f32 v67, v67, v19
    v_mul_f32 v68, v68, v20
    v_mul_f32 v69, v69, v21
    v_mul_f32 v70, v70, v22
    v_mul_f32 v71, v71, v23
    v_mul_f32 v72, v72, v24
    v_mul_f32 v73, v73, v25
    v_mul_f32 v74, v74, v26
    v_mul_f32 v75, v75, v27
    v_mul_f32 v76, v76, v28
    v_mul_f32 v77, v77, v29
    v_mul_f32 v78, v78, v30
    v_mul_f32 v79, v79, v31
    v_cvt_pk_bf16_f32 v64, v64, v65
    v_cvt_pk_bf16_f32 v65, v66, v67
    v_cvt_pk_bf16_f32 v66, v68, v69
    v_cvt_pk_bf16_f32 v67, v70, v71
    v_cvt_pk_bf16_f32 v68, v72, v73
    v_cvt_pk_bf16_f32 v69, v74, v75
    v_cvt_pk_bf16_f32 v70, v76, v77
    v_cvt_pk_bf16_f32 v71, v78, v79
    s_add_u32 s37, s36, 2048
    buffer_store_dwordx4 v[64:67], v1, s[12:15], s37 offen offset:0 sc0 sc1
    buffer_store_dwordx4 v[68:71], v1, s[12:15], s37 offen offset:1024 sc0 sc1
    v_mul_f32 v16, 0xbfb8aa3b, v80
    v_mul_f32 v17, 0xbfb8aa3b, v81
    v_mul_f32 v18, 0xbfb8aa3b, v82
    v_mul_f32 v19, 0xbfb8aa3b, v83
    v_mul_f32 v20, 0xbfb8aa3b, v84
    v_mul_f32 v21, 0xbfb8aa3b, v85
    v_mul_f32 v22, 0xbfb8aa3b, v86
    v_mul_f32 v23, 0xbfb8aa3b, v87
    v_mul_f32 v24, 0xbfb8aa3b, v88
    v_mul_f32 v25, 0xbfb8aa3b, v89
    v_mul_f32 v26, 0xbfb8aa3b, v90
    v_mul_f32 v27, 0xbfb8aa3b, v91
    v_mul_f32 v28, 0xbfb8aa3b, v92
    v_mul_f32 v29, 0xbfb8aa3b, v93
    v_mul_f32 v30, 0xbfb8aa3b, v94
    v_mul_f32 v31, 0xbfb8aa3b, v95
    v_exp_f32 v16, v16
    v_exp_f32 v17, v17
    v_exp_f32 v18, v18
    v_exp_f32 v19, v19
    v_exp_f32 v20, v20
    v_exp_f32 v21, v21
    v_exp_f32 v22, v22
    v_exp_f32 v23, v23
    v_exp_f32 v24, v24
    v_exp_f32 v25, v25
    v_exp_f32 v26, v26
    v_exp_f32 v27, v27
    v_exp_f32 v28, v28
    v_exp_f32 v29, v29
    v_exp_f32 v30, v30
    v_exp_f32 v31, v31
    v_add_f32 v16, 1.0, v16
    v_add_f32 v17, 1.0, v17
    v_add_f32 v18, 1.0, v18
    v_add_f32 v19, 1.0, v19
    v_add_f32 v20, 1.0, v20
    v_add_f32 v21, 1.0, v21
    v_add_f32 v22, 1.0, v22
    v_add_f32 v23, 1.0, v23
    v_add_f32 v24, 1.0, v24
    v_add_f32 v25, 1.0, v25
    v_add_f32 v26, 1.0, v26
    v_add_f32 v27, 1.0, v27
    v_add_f32 v28, 1.0, v28
    v_add_f32 v29, 1.0, v29
    v_add_f32 v30, 1.0, v30
    v_add_f32 v31, 1.0, v31
    v_rcp_f32 v16, v16
    v_rcp_f32 v17, v17
    v_rcp_f32 v18, v18
    v_rcp_f32 v19, v19
    v_rcp_f32 v20, v20
    v_rcp_f32 v21, v21
    v_rcp_f32 v22, v22
    v_rcp_f32 v23, v23
    v_rcp_f32 v24, v24
    v_rcp_f32 v25, v25
    v_rcp_f32 v26, v26
    v_rcp_f32 v27, v27
    v_rcp_f32 v28, v28
    v_rcp_f32 v29, v29
    v_rcp_f32 v30, v30
    v_rcp_f32 v31, v31
    v_mul_f32 v80, v80, v16
    v_mul_f32 v81, v81, v17
    v_mul_f32 v82, v82, v18
    v_mul_f32 v83, v83, v19
    v_mul_f32 v84, v84, v20
    v_mul_f32 v85, v85, v21
    v_mul_f32 v86, v86, v22
    v_mul_f32 v87, v87, v23
    v_mul_f32 v88, v88, v24
    v_mul_f32 v89, v89, v25
    v_mul_f32 v90, v90, v26
    v_mul_f32 v91, v91, v27
    v_mul_f32 v92, v92, v28
    v_mul_f32 v93, v93, v29
    v_mul_f32 v94, v94, v30
    v_mul_f32 v95, v95, v31
    v_cvt_pk_bf16_f32 v80, v80, v81
    v_cvt_pk_bf16_f32 v81, v82, v83
    v_cvt_pk_bf16_f32 v82, v84, v85
    v_cvt_pk_bf16_f32 v83, v86, v87
    v_cvt_pk_bf16_f32 v84, v88, v89
    v_cvt_pk_bf16_f32 v85, v90, v91
    v_cvt_pk_bf16_f32 v86, v92, v93
    v_cvt_pk_bf16_f32 v87, v94, v95
    s_add_u32 s37, s36, 114688
    buffer_store_dwordx4 v[80:83], v1, s[12:15], s37 offen offset:0 sc0 sc1
    buffer_store_dwordx4 v[84:87], v1, s[12:15], s37 offen offset:1024 sc0 sc1
    v_mul_f32 v16, 0xbfb8aa3b, v96
    v_mul_f32 v17, 0xbfb8aa3b, v97
    v_mul_f32 v18, 0xbfb8aa3b, v98
    v_mul_f32 v19, 0xbfb8aa3b, v99
    v_mul_f32 v20, 0xbfb8aa3b, v100
    v_mul_f32 v21, 0xbfb8aa3b, v101
    v_mul_f32 v22, 0xbfb8aa3b, v102
    v_mul_f32 v23, 0xbfb8aa3b, v103
    v_mul_f32 v24, 0xbfb8aa3b, v104
    v_mul_f32 v25, 0xbfb8aa3b, v105
    v_mul_f32 v26, 0xbfb8aa3b, v106
    v_mul_f32 v27, 0xbfb8aa3b, v107
    v_mul_f32 v28, 0xbfb8aa3b, v108
    v_mul_f32 v29, 0xbfb8aa3b, v109
    v_mul_f32 v30, 0xbfb8aa3b, v110
    v_mul_f32 v31, 0xbfb8aa3b, v111
    v_exp_f32 v16, v16
    v_exp_f32 v17, v17
    v_exp_f32 v18, v18
    v_exp_f32 v19, v19
    v_exp_f32 v20, v20
    v_exp_f32 v21, v21
    v_exp_f32 v22, v22
    v_exp_f32 v23, v23
    v_exp_f32 v24, v24
    v_exp_f32 v25, v25
    v_exp_f32 v26, v26
    v_exp_f32 v27, v27
    v_exp_f32 v28, v28
    v_exp_f32 v29, v29
    v_exp_f32 v30, v30
    v_exp_f32 v31, v31
    v_add_f32 v16, 1.0, v16
    v_add_f32 v17, 1.0, v17
    v_add_f32 v18, 1.0, v18
    v_add_f32 v19, 1.0, v19
    v_add_f32 v20, 1.0, v20
    v_add_f32 v21, 1.0, v21
    v_add_f32 v22, 1.0, v22
    v_add_f32 v23, 1.0, v23
    v_add_f32 v24, 1.0, v24
    v_add_f32 v25, 1.0, v25
    v_add_f32 v26, 1.0, v26
    v_add_f32 v27, 1.0, v27
    v_add_f32 v28, 1.0, v28
    v_add_f32 v29, 1.0, v29
    v_add_f32 v30, 1.0, v30
    v_add_f32 v31, 1.0, v31
    v_rcp_f32 v16, v16
    v_rcp_f32 v17, v17
    v_rcp_f32 v18, v18
    v_rcp_f32 v19, v19
    v_rcp_f32 v20, v20
    v_rcp_f32 v21, v21
    v_rcp_f32 v22, v22
    v_rcp_f32 v23, v23
    v_rcp_f32 v24, v24
    v_rcp_f32 v25, v25
    v_rcp_f32 v26, v26
    v_rcp_f32 v27, v27
    v_rcp_f32 v28, v28
    v_rcp_f32 v29, v29
    v_rcp_f32 v30, v30
    v_rcp_f32 v31, v31
    v_mul_f32 v96, v96, v16
    v_mul_f32 v97, v97, v17
    v_mul_f32 v98, v98, v18
    v_mul_f32 v99, v99, v19
    v_mul_f32 v100, v100, v20
    v_mul_f32 v101, v101, v21
    v_mul_f32 v102, v102, v22
    v_mul_f32 v103, v103, v23
    v_mul_f32 v104, v104, v24
    v_mul_f32 v105, v105, v25
    v_mul_f32 v106, v106, v26
    v_mul_f32 v107, v107, v27
    v_mul_f32 v108, v108, v28
    v_mul_f32 v109, v109, v29
    v_mul_f32 v110, v110, v30
    v_mul_f32 v111, v111, v31
    v_cvt_pk_bf16_f32 v96, v96, v97
    v_cvt_pk_bf16_f32 v97, v98, v99
    v_cvt_pk_bf16_f32 v98, v100, v101
    v_cvt_pk_bf16_f32 v99, v102, v103
    v_cvt_pk_bf16_f32 v100, v104, v105
    v_cvt_pk_bf16_f32 v101, v106, v107
    v_cvt_pk_bf16_f32 v102, v108, v109
    v_cvt_pk_bf16_f32 v103, v110, v111
    s_add_u32 s37, s36, 116736
    buffer_store_dwordx4 v[96:99], v1, s[12:15], s37 offen offset:0 sc0 sc1
    buffer_store_dwordx4 v[100:103], v1, s[12:15], s37 offen offset:1024 sc0 sc1
    s_waitcnt vmcnt(0)
    s_barrier
    s_barrier
    s_lshl_b32 s30, s60, 1
    s_and_b32 s31, s61, 1
    s_add_u32 s30, s30, s31
    s_lshr_b32 s31, s61, 1
    s_mov_b32 s32, 0
    v_lshrrev_b32 v9, 4, v0
    v_and_b32 v10, 15, v0
    v_lshrrev_b32 v11, 1, v9
    v_lshrrev_b32 v12, 2, v10
    v_lshl_add_u32 v11, v11, 2, v12
    v_lshlrev_b32 v11, 7, v11
    v_and_b32 v13, 1, v9
    v_lshl_add_u32 v11, v13, 5, v11
    v_and_b32 v13, 3, v10
    v_lshl_add_u32 v11, v13, 3, v11
    v_lshrrev_b32 v12, 3, v10
    v_lshl_add_u32 v2, v12, 6, v11
    v_xor_b32 v13, 1, v12
    v_lshl_add_u32 v3, v13, 6, v11
    s_lshl_b32 s36, s20, 11
    v_add_u32 v2, s36, v2
    v_add_u32 v3, s36, v3
    s_lshl_b32 s36, s20, 10
    s_add_u32 s36, s36, 16384
    v_add_u32 v4, s36, v1
    s_mov_b32 s12, s70
    s_mov_b32 s13, s71
    s_mov_b32 s14, 2097152
    s_mov_b32 s15, 0x00020000
    s_add_u32 s24, s68, 83886080
    s_addc_u32 s25, s69, 0
    s_mov_b32 s26, 2097152
    s_mov_b32 s27, 0x00020000
    s_mov_b32 s16, s68
    s_mov_b32 s17, s69
    s_mov_b32 s18, 16384
    s_mov_b32 s19, 0x00020000
    s_barrier
    v_add_u32 v5, 32768, v2
    v_add_u32 v6, 32768, v3
    v_add_u32 v7, 32768, v4
    ds_read_b128 v[32:35], v7 offset:0
    ds_read_b128 v[36:39], v7 offset:8192
    ds_read_b64_tr_b16 v[16:17], v5 offset:0
    ds_read_b64_tr_b16 v[18:19], v5 offset:1024
    ds_read_b64_tr_b16 v[20:21], v6 offset:0
    ds_read_b64_tr_b16 v[22:23], v6 offset:1024
    ds_read_b128 v[40:43], v7 offset:4096
    ds_read_b128 v[44:47], v7 offset:12288
    ds_read_b64_tr_b16 v[24:25], v5 offset:8192
    ds_read_b64_tr_b16 v[26:27], v5 offset:9216
    ds_read_b64_tr_b16 v[28:29], v6 offset:8192
    ds_read_b64_tr_b16 v[30:31], v6 offset:9216
    s_waitcnt lgkmcnt(0)
    s_barrier
    v_mfma_f32_32x32x16_bf16 v[48:63], v[16:19], v[32:35], 0
    v_add_u32 v5, 65536, v2
    v_add_u32 v6, 65536, v3
    v_add_u32 v7, 65536, v4
    v_mfma_f32_32x32x16_bf16 v[64:79], v[20:23], v[32:35], 0
    ds_read_b128 v[128:131], v7 offset:0
    ds_read_b128 v[132:135], v7 offset:8192
    ds_read_b64_tr_b16 v[112:113], v5 offset:0
    v_mfma_f32_32x32x16_bf16 v[80:95], v[16:19], v[36:39], 0
    ds_read_b64_tr_b16 v[114:115], v5 offset:1024
    ds_read_b64_tr_b16 v[116:117], v6 offset:0
    ds_read_b64_tr_b16 v[118:119], v6 offset:1024
    v_mfma_f32_32x32x16_bf16 v[96:111], v[20:23], v[36:39], 0
    ds_read_b128 v[136:139], v7 offset:4096
    ds_read_b128 v[140:143], v7 offset:12288
    ds_read_b64_tr_b16 v[120:121], v5 offset:8192
    v_mfma_f32_32x32x16_bf16 v[48:63], v[24:27], v[40:43], v[48:63]
    ds_read_b64_tr_b16 v[122:123], v5 offset:9216
    ds_read_b64_tr_b16 v[124:125], v6 offset:8192
    ds_read_b64_tr_b16 v[126:127], v6 offset:9216
    v_mfma_f32_32x32x16_bf16 v[64:79], v[28:31], v[40:43], v[64:79]
    v_mfma_f32_32x32x16_bf16 v[80:95], v[24:27], v[44:47], v[80:95]
    v_mfma_f32_32x32x16_bf16 v[96:111], v[28:31], v[44:47], v[96:111]
    s_waitcnt lgkmcnt(0)
    s_barrier
    v_mfma_f32_32x32x16_bf16 v[48:63], v[112:115], v[128:131], v[48:63]
    v_add_u32 v5, 98304, v2
    v_add_u32 v6, 98304, v3
    v_add_u32 v7, 98304, v4
    v_mfma_f32_32x32x16_bf16 v[64:79], v[116:119], v[128:131], v[64:79]
    ds_read_b128 v[32:35], v7 offset:0
    ds_read_b128 v[36:39], v7 offset:8192
    ds_read_b64_tr_b16 v[16:17], v5 offset:0
    v_mfma_f32_32x32x16_bf16 v[80:95], v[112:115], v[132:135], v[80:95]
    ds_read_b64_tr_b16 v[18:19], v5 offset:1024
    ds_read_b64_tr_b16 v[20:21], v6 offset:0
    ds_read_b64_tr_b16 v[22:23], v6 offset:1024
    v_mfma_f32_32x32x16_bf16 v[96:111], v[116:119], v[132:135], v[96:111]
    ds_read_b128 v[40:43], v7 offset:4096
    ds_read_b128 v[44:47], v7 offset:12288
    ds_read_b64_tr_b16 v[24:25], v5 offset:8192
    v_mfma_f32_32x32x16_bf16 v[48:63], v[120:123], v[136:139], v[48:63]
    ds_read_b64_tr_b16 v[26:27], v5 offset:9216
    ds_read_b64_tr_b16 v[28:29], v6 offset:8192
    ds_read_b64_tr_b16 v[30:31], v6 offset:9216
    v_mfma_f32_32x32x16_bf16 v[64:79], v[124:127], v[136:139], v[64:79]
    v_mfma_f32_32x32x16_bf16 v[80:95], v[120:123], v[140:143], v[80:95]
    v_mfma_f32_32x32x16_bf16 v[96:111], v[124:127], v[140:143], v[96:111]
    s_waitcnt lgkmcnt(0)
    s_barrier
    v_mfma_f32_32x32x16_bf16 v[48:63], v[16:19], v[32:35], v[48:63]
    v_add_u32 v5, 131072, v2
    v_add_u32 v6, 131072, v3
    v_add_u32 v7, 131072, v4
    v_mfma_f32_32x32x16_bf16 v[64:79], v[20:23], v[32:35], v[64:79]
    ds_read_b128 v[128:131], v7 offset:0
    ds_read_b128 v[132:135], v7 offset:8192
    ds_read_b64_tr_b16 v[112:113], v5 offset:0
    v_mfma_f32_32x32x16_bf16 v[80:95], v[16:19], v[36:39], v[80:95]
    ds_read_b64_tr_b16 v[114:115], v5 offset:1024
    ds_read_b64_tr_b16 v[116:117], v6 offset:0
    ds_read_b64_tr_b16 v[118:119], v6 offset:1024
    v_mfma_f32_32x32x16_bf16 v[96:111], v[20:23], v[36:39], v[96:111]
    ds_read_b128 v[136:139], v7 offset:4096
    ds_read_b128 v[140:143], v7 offset:12288
    ds_read_b64_tr_b16 v[120:121], v5 offset:8192
    v_mfma_f32_32x32x16_bf16 v[48:63], v[24:27], v[40:43], v[48:63]
    ds_read_b64_tr_b16 v[122:123], v5 offset:9216
    ds_read_b64_tr_b16 v[124:125], v6 offset:8192
    ds_read_b64_tr_b16 v[126:127], v6 offset:9216
    v_mfma_f32_32x32x16_bf16 v[64:79], v[28:31], v[40:43], v[64:79]
    v_mfma_f32_32x32x16_bf16 v[80:95], v[24:27], v[44:47], v[80:95]
    v_mfma_f32_32x32x16_bf16 v[96:111], v[28:31], v[44:47], v[96:111]
    s_waitcnt lgkmcnt(0)
    s_barrier
    v_mfma_f32_32x32x16_bf16 v[48:63], v[112:115], v[128:131], v[48:63]
    v_add_u32 v5, 0, v2
    v_add_u32 v6, 0, v3
    v_add_u32 v7, 0, v4
    v_mfma_f32_32x32x16_bf16 v[64:79], v[116:119], v[128:131], v[64:79]
    ds_read_b128 v[32:35], v7 offset:0
    ds_read_b128 v[36:39], v7 offset:8192
    ds_read_b64_tr_b16 v[16:17], v5 offset:0
    v_mfma_f32_32x32x16_bf16 v[80:95], v[112:115], v[132:135], v[80:95]
    ds_read_b64_tr_b16 v[18:19], v5 offset:1024
    ds_read_b64_tr_b16 v[20:21], v6 offset:0
    ds_read_b64_tr_b16 v[22:23], v6 offset:1024
    v_mfma_f32_32x32x16_bf16 v[96:111], v[116:119], v[132:135], v[96:111]
    ds_read_b128 v[40:43], v7 offset:4096
    ds_read_b128 v[44:47], v7 offset:12288
    ds_read_b64_tr_b16 v[24:25], v5 offset:8192
    v_mfma_f32_32x32x16_bf16 v[48:63], v[120:123], v[136:139], v[48:63]
    ds_read_b64_tr_b16 v[26:27], v5 offset:9216
    ds_read_b64_tr_b16 v[28:29], v6 offset:8192
    ds_read_b64_tr_b16 v[30:31], v6 offset:9216
    v_mfma_f32_32x32x16_bf16 v[64:79], v[124:127], v[136:139], v[64:79]
    v_mfma_f32_32x32x16_bf16 v[80:95], v[120:123], v[140:143], v[80:95]
    v_mfma_f32_32x32x16_bf16 v[96:111], v[124:127], v[140:143], v[96:111]
    s_waitcnt lgkmcnt(0)
    s_barrier
    v_mfma_f32_32x32x16_bf16 v[48:63], v[16:19], v[32:35], v[48:63]
    v_add_u32 v5, 32768, v2
    v_add_u32 v6, 32768, v3
    v_add_u32 v7, 32768, v4
    v_mfma_f32_32x32x16_bf16 v[64:79], v[20:23], v[32:35], v[64:79]
    ds_read_b128 v[128:131], v7 offset:0
    ds_read_b128 v[132:135], v7 offset:8192
    ds_read_b64_tr_b16 v[112:113], v5 offset:0
    v_mfma_f32_32x32x16_bf16 v[80:95], v[16:19], v[36:39], v[80:95]
    ds_read_b64_tr_b16 v[114:115], v5 offset:1024
    ds_read_b64_tr_b16 v[116:117], v6 offset:0
    ds_read_b64_tr_b16 v[118:119], v6 offset:1024
    v_mfma_f32_32x32x16_bf16 v[96:111], v[20:23], v[36:39], v[96:111]
    ds_read_b128 v[136:139], v7 offset:4096
    ds_read_b128 v[140:143], v7 offset:12288
    ds_read_b64_tr_b16 v[120:121], v5 offset:8192
    v_mfma_f32_32x32x16_bf16 v[48:63], v[24:27], v[40:43], v[48:63]
    ds_read_b64_tr_b16 v[122:123], v5 offset:9216
    ds_read_b64_tr_b16 v[124:125], v6 offset:8192
    ds_read_b64_tr_b16 v[126:127], v6 offset:9216
    v_mfma_f32_32x32x16_bf16 v[64:79], v[28:31], v[40:43], v[64:79]
    v_mfma_f32_32x32x16_bf16 v[80:95], v[24:27], v[44:47], v[80:95]
    v_mfma_f32_32x32x16_bf16 v[96:111], v[28:31], v[44:47], v[96:111]
    s_waitcnt lgkmcnt(0)
    s_barrier
    v_mfma_f32_32x32x16_bf16 v[48:63], v[112:115], v[128:131], v[48:63]
    v_add_u32 v5, 65536, v2
    v_add_u32 v6, 65536, v3
    v_add_u32 v7, 65536, v4
    v_mfma_f32_32x32x16_bf16 v[64:79], v[116:119], v[128:131], v[64:79]
    ds_read_b128 v[32:35], v7 offset:0
    ds_read_b128 v[36:39], v7 offset:8192
    ds_read_b64_tr_b16 v[16:17], v5 offset:0
    v_mfma_f32_32x32x16_bf16 v[80:95], v[112:115], v[132:135], v[80:95]
    ds_read_b64_tr_b16 v[18:19], v5 offset:1024
    ds_read_b64_tr_b16 v[20:21], v6 offset:0
    ds_read_b64_tr_b16 v[22:23], v6 offset:1024
    v_mfma_f32_32x32x16_bf16 v[96:111], v[116:119], v[132:135], v[96:111]
    ds_read_b128 v[40:43], v7 offset:4096
    ds_read_b128 v[44:47], v7 offset:12288
    ds_read_b64_tr_b16 v[24:25], v5 offset:8192
    v_mfma_f32_32x32x16_bf16 v[48:63], v[120:123], v[136:139], v[48:63]
    ds_read_b64_tr_b16 v[26:27], v5 offset:9216
    ds_read_b64_tr_b16 v[28:29], v6 offset:8192
    ds_read_b64_tr_b16 v[30:31], v6 offset:9216
    v_mfma_f32_32x32x16_bf16 v[64:79], v[124:127], v[136:139], v[64:79]
    v_mfma_f32_32x32x16_bf16 v[80:95], v[120:123], v[140:143], v[80:95]
    v_mfma_f32_32x32x16_bf16 v[96:111], v[124:127], v[140:143], v[96:111]
    s_waitcnt lgkmcnt(0)
    s_barrier
    v_mfma_f32_32x32x16_bf16 v[48:63], v[16:19], v[32:35], v[48:63]
    v_add_u32 v5, 98304, v2
    v_add_u32 v6, 98304, v3
    v_add_u32 v7, 98304, v4
    v_mfma_f32_32x32x16_bf16 v[64:79], v[20:23], v[32:35], v[64:79]
    ds_read_b128 v[128:131], v7 offset:0
    ds_read_b128 v[132:135], v7 offset:8192
    ds_read_b64_tr_b16 v[112:113], v5 offset:0
    v_mfma_f32_32x32x16_bf16 v[80:95], v[16:19], v[36:39], v[80:95]
    ds_read_b64_tr_b16 v[114:115], v5 offset:1024
    ds_read_b64_tr_b16 v[116:117], v6 offset:0
    ds_read_b64_tr_b16 v[118:119], v6 offset:1024
    v_mfma_f32_32x32x16_bf16 v[96:111], v[20:23], v[36:39], v[96:111]
    ds_read_b128 v[136:139], v7 offset:4096
    ds_read_b128 v[140:143], v7 offset:12288
    ds_read_b64_tr_b16 v[120:121], v5 offset:8192
    v_mfma_f32_32x32x16_bf16 v[48:63], v[24:27], v[40:43], v[48:63]
    ds_read_b64_tr_b16 v[122:123], v5 offset:9216
    ds_read_b64_tr_b16 v[124:125], v6 offset:8192
    ds_read_b64_tr_b16 v[126:127], v6 offset:9216
    v_mfma_f32_32x32x16_bf16 v[64:79], v[28:31], v[40:43], v[64:79]
    v_mfma_f32_32x32x16_bf16 v[80:95], v[24:27], v[44:47], v[80:95]
    v_mfma_f32_32x32x16_bf16 v[96:111], v[28:31], v[44:47], v[96:111]
    s_waitcnt lgkmcnt(0)
    s_barrier
    v_mfma_f32_32x32x16_bf16 v[48:63], v[112:115], v[128:131], v[48:63]
    v_add_u32 v5, 131072, v2
    v_add_u32 v6, 131072, v3
    v_add_u32 v7, 131072, v4
    v_mfma_f32_32x32x16_bf16 v[64:79], v[116:119], v[128:131], v[64:79]
    ds_read_b128 v[32:35], v7 offset:0
    ds_read_b128 v[36:39], v7 offset:8192
    ds_read_b64_tr_b16 v[16:17], v5 offset:0
    v_mfma_f32_32x32x16_bf16 v[80:95], v[112:115], v[132:135], v[80:95]
    ds_read_b64_tr_b16 v[18:19], v5 offset:1024
    ds_read_b64_tr_b16 v[20:21], v6 offset:0
    ds_read_b64_tr_b16 v[22:23], v6 offset:1024
    v_mfma_f32_32x32x16_bf16 v[96:111], v[116:119], v[132:135], v[96:111]
    ds_read_b128 v[40:43], v7 offset:4096
    ds_read_b128 v[44:47], v7 offset:12288
    ds_read_b64_tr_b16 v[24:25], v5 offset:8192
    v_mfma_f32_32x32x16_bf16 v[48:63], v[120:123], v[136:139], v[48:63]
    ds_read_b64_tr_b16 v[26:27], v5 offset:9216
    ds_read_b64_tr_b16 v[28:29], v6 offset:8192
    ds_read_b64_tr_b16 v[30:31], v6 offset:9216
    v_mfma_f32_32x32x16_bf16 v[64:79], v[124:127], v[136:139], v[64:79]
    v_mfma_f32_32x32x16_bf16 v[80:95], v[120:123], v[140:143], v[80:95]
    v_mfma_f32_32x32x16_bf16 v[96:111], v[124:127], v[140:143], v[96:111]
    s_waitcnt lgkmcnt(0)
    s_barrier
    v_mfma_f32_32x32x16_bf16 v[48:63], v[16:19], v[32:35], v[48:63]
    v_add_u32 v5, 0, v2
    v_add_u32 v6, 0, v3
    v_add_u32 v7, 0, v4
    v_mfma_f32_32x32x16_bf16 v[64:79], v[20:23], v[32:35], v[64:79]
    ds_read_b128 v[128:131], v7 offset:0
    ds_read_b128 v[132:135], v7 offset:8192
    ds_read_b64_tr_b16 v[112:113], v5 offset:0
    v_mfma_f32_32x32x16_bf16 v[80:95], v[16:19], v[36:39], v[80:95]
    ds_read_b64_tr_b16 v[114:115], v5 offset:1024
    ds_read_b64_tr_b16 v[116:117], v6 offset:0
    ds_read_b64_tr_b16 v[118:119], v6 offset:1024
    v_mfma_f32_32x32x16_bf16 v[96:111], v[20:23], v[36:39], v[96:111]
    ds_read_b128 v[136:139], v7 offset:4096
    ds_read_b128 v[140:143], v7 offset:12288
    ds_read_b64_tr_b16 v[120:121], v5 offset:8192
    v_mfma_f32_32x32x16_bf16 v[48:63], v[24:27], v[40:43], v[48:63]
    ds_read_b64_tr_b16 v[122:123], v5 offset:9216
    ds_read_b64_tr_b16 v[124:125], v6 offset:8192
    ds_read_b64_tr_b16 v[126:127], v6 offset:9216
    v_mfma_f32_32x32x16_bf16 v[64:79], v[28:31], v[40:43], v[64:79]
    v_mfma_f32_32x32x16_bf16 v[80:95], v[24:27], v[44:47], v[80:95]
    v_mfma_f32_32x32x16_bf16 v[96:111], v[28:31], v[44:47], v[96:111]
    s_waitcnt lgkmcnt(0)
    s_barrier
    v_mfma_f32_32x32x16_bf16 v[48:63], v[112:115], v[128:131], v[48:63]
    v_add_u32 v5, 32768, v2
    v_add_u32 v6, 32768, v3
    v_add_u32 v7, 32768, v4
    v_mfma_f32_32x32x16_bf16 v[64:79], v[116:119], v[128:131], v[64:79]
    ds_read_b128 v[32:35], v7 offset:0
    ds_read_b128 v[36:39], v7 offset:8192
    ds_read_b64_tr_b16 v[16:17], v5 offset:0
    v_mfma_f32_32x32x16_bf16 v[80:95], v[112:115], v[132:135], v[80:95]
    ds_read_b64_tr_b16 v[18:19], v5 offset:1024
    ds_read_b64_tr_b16 v[20:21], v6 offset:0
    ds_read_b64_tr_b16 v[22:23], v6 offset:1024
    v_mfma_f32_32x32x16_bf16 v[96:111], v[116:119], v[132:135], v[96:111]
    ds_read_b128 v[40:43], v7 offset:4096
    ds_read_b128 v[44:47], v7 offset:12288
    ds_read_b64_tr_b16 v[24:25], v5 offset:8192
    v_mfma_f32_32x32x16_bf16 v[48:63], v[120:123], v[136:139], v[48:63]
    ds_read_b64_tr_b16 v[26:27], v5 offset:9216
    ds_read_b64_tr_b16 v[28:29], v6 offset:8192
    ds_read_b64_tr_b16 v[30:31], v6 offset:9216
    v_mfma_f32_32x32x16_bf16 v[64:79], v[124:127], v[136:139], v[64:79]
    v_mfma_f32_32x32x16_bf16 v[80:95], v[120:123], v[140:143], v[80:95]
    v_mfma_f32_32x32x16_bf16 v[96:111], v[124:127], v[140:143], v[96:111]
    s_waitcnt lgkmcnt(0)
    s_barrier
    v_mfma_f32_32x32x16_bf16 v[48:63], v[16:19], v[32:35], v[48:63]
    v_add_u32 v5, 65536, v2
    v_add_u32 v6, 65536, v3
    v_add_u32 v7, 65536, v4
    v_mfma_f32_32x32x16_bf16 v[64:79], v[20:23], v[32:35], v[64:79]
    ds_read_b128 v[128:131], v7 offset:0
    ds_read_b128 v[132:135], v7 offset:8192
    ds_read_b64_tr_b16 v[112:113], v5 offset:0
    v_mfma_f32_32x32x16_bf16 v[80:95], v[16:19], v[36:39], v[80:95]
    ds_read_b64_tr_b16 v[114:115], v5 offset:1024
    ds_read_b64_tr_b16 v[116:117], v6 offset:0
    ds_read_b64_tr_b16 v[118:119], v6 offset:1024
    v_mfma_f32_32x32x16_bf16 v[96:111], v[20:23], v[36:39], v[96:111]
    ds_read_b128 v[136:139], v7 offset:4096
    ds_read_b128 v[140:143], v7 offset:12288
    ds_read_b64_tr_b16 v[120:121], v5 offset:8192
    v_mfma_f32_32x32x16_bf16 v[48:63], v[24:27], v[40:43], v[48:63]
    ds_read_b64_tr_b16 v[122:123], v5 offset:9216
    ds_read_b64_tr_b16 v[124:125], v6 offset:8192
    ds_read_b64_tr_b16 v[126:127], v6 offset:9216
    v_mfma_f32_32x32x16_bf16 v[64:79], v[28:31], v[40:43], v[64:79]
    v_mfma_f32_32x32x16_bf16 v[80:95], v[24:27], v[44:47], v[80:95]
    v_mfma_f32_32x32x16_bf16 v[96:111], v[28:31], v[44:47], v[96:111]
    s_waitcnt lgkmcnt(0)
    s_barrier
    v_mfma_f32_32x32x16_bf16 v[48:63], v[112:115], v[128:131], v[48:63]
    v_add_u32 v5, 98304, v2
    v_add_u32 v6, 98304, v3
    v_add_u32 v7, 98304, v4
    v_mfma_f32_32x32x16_bf16 v[64:79], v[116:119], v[128:131], v[64:79]
    ds_read_b128 v[32:35], v7 offset:0
    ds_read_b128 v[36:39], v7 offset:8192
    ds_read_b64_tr_b16 v[16:17], v5 offset:0
    v_mfma_f32_32x32x16_bf16 v[80:95], v[112:115], v[132:135], v[80:95]
    ds_read_b64_tr_b16 v[18:19], v5 offset:1024
    ds_read_b64_tr_b16 v[20:21], v6 offset:0
    ds_read_b64_tr_b16 v[22:23], v6 offset:1024
    v_mfma_f32_32x32x16_bf16 v[96:111], v[116:119], v[132:135], v[96:111]
    ds_read_b128 v[40:43], v7 offset:4096
    ds_read_b128 v[44:47], v7 offset:12288
    ds_read_b64_tr_b16 v[24:25], v5 offset:8192
    v_mfma_f32_32x32x16_bf16 v[48:63], v[120:123], v[136:139], v[48:63]
    ds_read_b64_tr_b16 v[26:27], v5 offset:9216
    ds_read_b64_tr_b16 v[28:29], v6 offset:8192
    ds_read_b64_tr_b16 v[30:31], v6 offset:9216
    v_mfma_f32_32x32x16_bf16 v[64:79], v[124:127], v[136:139], v[64:79]
    v_mfma_f32_32x32x16_bf16 v[80:95], v[120:123], v[140:143], v[80:95]
    v_mfma_f32_32x32x16_bf16 v[96:111], v[124:127], v[140:143], v[96:111]
    s_waitcnt lgkmcnt(0)
    s_barrier
    v_mfma_f32_32x32x16_bf16 v[48:63], v[16:19], v[32:35], v[48:63]
    v_add_u32 v5, 131072, v2
    v_add_u32 v6, 131072, v3
    v_add_u32 v7, 131072, v4
    v_mfma_f32_32x32x16_bf16 v[64:79], v[20:23], v[32:35], v[64:79]
    ds_read_b128 v[128:131], v7 offset:0
    ds_read_b128 v[132:135], v7 offset:8192
    ds_read_b64_tr_b16 v[112:113], v5 offset:0
    v_mfma_f32_32x32x16_bf16 v[80:95], v[16:19], v[36:39], v[80:95]
    ds_read_b64_tr_b16 v[114:115], v5 offset:1024
    ds_read_b64_tr_b16 v[116:117], v6 offset:0
    ds_read_b64_tr_b16 v[118:119], v6 offset:1024
    v_mfma_f32_32x32x16_bf16 v[96:111], v[20:23], v[36:39], v[96:111]
    ds_read_b128 v[136:139], v7 offset:4096
    ds_read_b128 v[140:143], v7 offset:12288
    ds_read_b64_tr_b16 v[120:121], v5 offset:8192
    v_mfma_f32_32x32x16_bf16 v[48:63], v[24:27], v[40:43], v[48:63]
    ds_read_b64_tr_b16 v[122:123], v5 offset:9216
    ds_read_b64_tr_b16 v[124:125], v6 offset:8192
    ds_read_b64_tr_b16 v[126:127], v6 offset:9216
    v_mfma_f32_32x32x16_bf16 v[64:79], v[28:31], v[40:43], v[64:79]
    v_mfma_f32_32x32x16_bf16 v[80:95], v[24:27], v[44:47], v[80:95]
    v_mfma_f32_32x32x16_bf16 v[96:111], v[28:31], v[44:47], v[96:111]
    s_waitcnt lgkmcnt(0)
    v_mfma_f32_32x32x16_bf16 v[48:63], v[112:115], v[128:131], v[48:63]
    v_mfma_f32_32x32x16_bf16 v[64:79], v[116:119], v[128:131], v[64:79]
    v_mfma_f32_32x32x16_bf16 v[80:95], v[112:115], v[132:135], v[80:95]
    v_mfma_f32_32x32x16_bf16 v[96:111], v[116:119], v[132:135], v[96:111]
    v_mfma_f32_32x32x16_bf16 v[48:63], v[120:123], v[136:139], v[48:63]
    v_mfma_f32_32x32x16_bf16 v[64:79], v[124:127], v[136:139], v[64:79]
    v_mfma_f32_32x32x16_bf16 v[80:95], v[120:123], v[140:143], v[80:95]
    v_mfma_f32_32x32x16_bf16 v[96:111], v[124:127], v[140:143], v[96:111]
    s_lshr_b32 s36, s20, 1
    s_lshl_b32 s37, s30, 1
    s_add_u32 s36, s36, s37
    s_and_b32 s37, s20, 1
    s_lshl_b32 s38, s31, 1
    s_add_u32 s37, s37, s38
    s_lshl_b32 s38, s36, 15
    s_lshl_b32 s39, s37, 11
    s_add_u32 s38, s38, s39
    buffer_load_dwordx4 v[16:19], v1, s[24:27], s38 offen
    buffer_load_dwordx4 v[20:23], v1, s[24:27], s38 offen offset:1024
    v_lshrrev_b32 v8, 5, v0
    v_lshlrev_b32 v8, 4, v8
    s_lshl_b32 s39, s37, 7
    s_add_u32 s39, s39, 10240
    buffer_load_dwordx4 v[24:27], v8, s[16:19], s39 offen offset:0
    buffer_load_dwordx4 v[28:31], v8, s[16:19], s39 offen offset:32
    buffer_load_dwordx4 v[32:35], v8, s[16:19], s39 offen offset:64
    buffer_load_dwordx4 v[36:39], v8, s[16:19], s39 offen offset:96
    s_barrier
    s_lshl_b32 s46, s20, 14
    v_add_u32 v9, s46, v1
    s_nop 7
    ds_write_b128 v9, v[48:51] offset:0
    ds_write_b128 v9, v[52:55] offset:1024
    ds_write_b128 v9, v[56:59] offset:2048
    ds_write_b128 v9, v[60:63] offset:3072
    ds_write_b128 v9, v[64:67] offset:4096
    ds_write_b128 v9, v[68:71] offset:5120
    ds_write_b128 v9, v[72:75] offset:6144
    ds_write_b128 v9, v[76:79] offset:7168
    ds_write_b128 v9, v[80:83] offset:8192
    ds_write_b128 v9, v[84:87] offset:9216
    ds_write_b128 v9, v[88:91] offset:10240
    ds_write_b128 v9, v[92:95] offset:11264
    ds_write_b128 v9, v[96:99] offset:12288
    ds_write_b128 v9, v[100:103] offset:13312
    ds_write_b128 v9, v[104:107] offset:14336
    ds_write_b128 v9, v[108:111] offset:15360
    s_waitcnt lgkmcnt(0)
    s_barrier
    s_lshl_b32 s46, s20, 12
    v_add_u32 v9, s46, v1
    ds_read_b128 v[48:51], v9 offset:0
    ds_read_b128 v[52:55], v9 offset:1024
    ds_read_b128 v[56:59], v9 offset:2048
    ds_read_b128 v[60:63], v9 offset:3072
    ds_read_b128 v[64:67], v9 offset:16384
    ds_read_b128 v[68:71], v9 offset:17408
    ds_read_b128 v[72:75], v9 offset:18432
    ds_read_b128 v[76:79], v9 offset:19456
    ds_read_b128 v[80:83], v9 offset:32768
    ds_read_b128 v[84:87], v9 offset:33792
    ds_read_b128 v[88:91], v9 offset:34816
    ds_read_b128 v[92:95], v9 offset:35840
    ds_read_b128 v[96:99], v9 offset:49152
    ds_read_b128 v[100:103], v9 offset:50176
    ds_read_b128 v[104:107], v9 offset:51200
    ds_read_b128 v[108:111], v9 offset:52224
    s_waitcnt lgkmcnt(0)
    v_add_f32 v48, v48, v64
    v_add_f32 v80, v80, v96
    v_add_f32 v49, v49, v65
    v_add_f32 v81, v81, v97
    v_add_f32 v50, v50, v66
    v_add_f32 v82, v82, v98
    v_add_f32 v51, v51, v67
    v_add_f32 v83, v83, v99
    v_add_f32 v52, v52, v68
    v_add_f32 v84, v84, v100
    v_add_f32 v53, v53, v69
    v_add_f32 v85, v85, v101
    v_add_f32 v54, v54, v70
    v_add_f32 v86, v86, v102
    v_add_f32 v55, v55, v71
    v_add_f32 v87, v87, v103
    v_add_f32 v56, v56, v72
    v_add_f32 v88, v88, v104
    v_add_f32 v57, v57, v73
    v_add_f32 v89, v89, v105
    v_add_f32 v58, v58, v74
    v_add_f32 v90, v90, v106
    v_add_f32 v59, v59, v75
    v_add_f32 v91, v91, v107
    v_add_f32 v60, v60, v76
    v_add_f32 v92, v92, v108
    v_add_f32 v61, v61, v77
    v_add_f32 v93, v93, v109
    v_add_f32 v62, v62, v78
    v_add_f32 v94, v94, v110
    v_add_f32 v63, v63, v79
    v_add_f32 v95, v95, v111
    v_add_f32 v48, v48, v80
    v_add_f32 v49, v49, v81
    v_add_f32 v50, v50, v82
    v_add_f32 v51, v51, v83
    v_add_f32 v52, v52, v84
    v_add_f32 v53, v53, v85
    v_add_f32 v54, v54, v86
    v_add_f32 v55, v55, v87
    v_add_f32 v56, v56, v88
    v_add_f32 v57, v57, v89
    v_add_f32 v58, v58, v90
    v_add_f32 v59, v59, v91
    v_add_f32 v60, v60, v92
    v_add_f32 v61, v61, v93
    v_add_f32 v62, v62, v94
    v_add_f32 v63, v63, v95
    s_waitcnt vmcnt(0)
    v_lshlrev_b32 v64, 16, v16
    v_and_b32 v65, 0xffff0000, v16
    v_lshlrev_b32 v66, 16, v17
    v_and_b32 v67, 0xffff0000, v17
    v_lshlrev_b32 v68, 16, v18
    v_and_b32 v69, 0xffff0000, v18
    v_lshlrev_b32 v70, 16, v19
    v_and_b32 v71, 0xffff0000, v19
    v_lshlrev_b32 v72, 16, v20
    v_and_b32 v73, 0xffff0000, v20
    v_lshlrev_b32 v74, 16, v21
    v_and_b32 v75, 0xffff0000, v21
    v_lshlrev_b32 v76, 16, v22
    v_and_b32 v77, 0xffff0000, v22
    v_lshlrev_b32 v78, 16, v23
    v_and_b32 v79, 0xffff0000, v23
    v_cvt_pk_bf16_f32 v40, v48, v49
    v_lshlrev_b32 v41, 16, v40
    v_and_b32 v42, 0xffff0000, v40
    v_mul_f32 v41, v41, v24
    v_mul_f32 v42, v42, v25
    v_cvt_pk_bf16_f32 v40, v41, v42
    v_lshlrev_b32 v41, 16, v40
    v_and_b32 v42, 0xffff0000, v40
    v_add_f32 v41, v41, v64
    v_add_f32 v42, v42, v65
    v_cvt_pk_bf16_f32 v80, v41, v42
    v_cvt_pk_bf16_f32 v40, v50, v51
    v_lshlrev_b32 v41, 16, v40
    v_and_b32 v42, 0xffff0000, v40
    v_mul_f32 v41, v41, v26
    v_mul_f32 v42, v42, v27
    v_cvt_pk_bf16_f32 v40, v41, v42
    v_lshlrev_b32 v41, 16, v40
    v_and_b32 v42, 0xffff0000, v40
    v_add_f32 v41, v41, v66
    v_add_f32 v42, v42, v67
    v_cvt_pk_bf16_f32 v81, v41, v42
    v_cvt_pk_bf16_f32 v40, v52, v53
    v_lshlrev_b32 v41, 16, v40
    v_and_b32 v42, 0xffff0000, v40
    v_mul_f32 v41, v41, v28
    v_mul_f32 v42, v42, v29
    v_cvt_pk_bf16_f32 v40, v41, v42
    v_lshlrev_b32 v41, 16, v40
    v_and_b32 v42, 0xffff0000, v40
    v_add_f32 v41, v41, v68
    v_add_f32 v42, v42, v69
    v_cvt_pk_bf16_f32 v82, v41, v42
    v_cvt_pk_bf16_f32 v40, v54, v55
    v_lshlrev_b32 v41, 16, v40
    v_and_b32 v42, 0xffff0000, v40
    v_mul_f32 v41, v41, v30
    v_mul_f32 v42, v42, v31
    v_cvt_pk_bf16_f32 v40, v41, v42
    v_lshlrev_b32 v41, 16, v40
    v_and_b32 v42, 0xffff0000, v40
    v_add_f32 v41, v41, v70
    v_add_f32 v42, v42, v71
    v_cvt_pk_bf16_f32 v83, v41, v42
    v_cvt_pk_bf16_f32 v40, v56, v57
    v_lshlrev_b32 v41, 16, v40
    v_and_b32 v42, 0xffff0000, v40
    v_mul_f32 v41, v41, v32
    v_mul_f32 v42, v42, v33
    v_cvt_pk_bf16_f32 v40, v41, v42
    v_lshlrev_b32 v41, 16, v40
    v_and_b32 v42, 0xffff0000, v40
    v_add_f32 v41, v41, v72
    v_add_f32 v42, v42, v73
    v_cvt_pk_bf16_f32 v84, v41, v42
    v_cvt_pk_bf16_f32 v40, v58, v59
    v_lshlrev_b32 v41, 16, v40
    v_and_b32 v42, 0xffff0000, v40
    v_mul_f32 v41, v41, v34
    v_mul_f32 v42, v42, v35
    v_cvt_pk_bf16_f32 v40, v41, v42
    v_lshlrev_b32 v41, 16, v40
    v_and_b32 v42, 0xffff0000, v40
    v_add_f32 v41, v41, v74
    v_add_f32 v42, v42, v75
    v_cvt_pk_bf16_f32 v85, v41, v42
    v_cvt_pk_bf16_f32 v40, v60, v61
    v_lshlrev_b32 v41, 16, v40
    v_and_b32 v42, 0xffff0000, v40
    v_mul_f32 v41, v41, v36
    v_mul_f32 v42, v42, v37
    v_cvt_pk_bf16_f32 v40, v41, v42
    v_lshlrev_b32 v41, 16, v40
    v_and_b32 v42, 0xffff0000, v40
    v_add_f32 v41, v41, v76
    v_add_f32 v42, v42, v77
    v_cvt_pk_bf16_f32 v86, v41, v42
    v_cvt_pk_bf16_f32 v40, v62, v63
    v_lshlrev_b32 v41, 16, v40
    v_and_b32 v42, 0xffff0000, v40
    v_mul_f32 v41, v41, v38
    v_mul_f32 v42, v42, v39
    v_cvt_pk_bf16_f32 v40, v41, v42
    v_lshlrev_b32 v41, 16, v40
    v_and_b32 v42, 0xffff0000, v40
    v_add_f32 v41, v41, v78
    v_add_f32 v42, v42, v79
    v_cvt_pk_bf16_f32 v87, v41, v42
    s_nop 1
    v_permlane32_swap_b32 v80, v82
    v_permlane32_swap_b32 v81, v83
    v_permlane32_swap_b32 v84, v86
    v_permlane32_swap_b32 v85, v87
    v_and_b32 v8, 31, v0
    v_lshlrev_b32 v8, 10, v8
    v_lshrrev_b32 v9, 5, v0
    v_lshl_add_u32 v8, v9, 4, v8
    s_lshl_b32 s38, s36, 15
    s_lshl_b32 s39, s37, 6
    s_add_u32 s38, s38, s39
    buffer_store_dwordx4 v[80:83], v8, s[12:15], s38 offen
    buffer_store_dwordx4 v[84:87], v8, s[12:15], s38 offen offset:32
    s_branch at_end
at_loader:
    s_mov_b32 s80, s54
    s_mov_b32 s81, s55
    s_mov_b32 s82, 4194304
    s_mov_b32 s83, 0x00020000
    s_mov_b32 s84, s56
    s_mov_b32 s85, s57
    s_mov_b32 s86, 4194304
    s_mov_b32 s87, 0x00020000
    s_mov_b32 s88, s58
    s_mov_b32 s89, s59
    s_mov_b32 s90, 2097152
    s_mov_b32 s91, 0x00020000
    s_add_u32 s72, s42, 100663296
    s_addc_u32 s73, s43, 0
    s_mov_b32 s74, 32768
    s_mov_b32 s75, 0x00020000
    v_lshrrev_b32 v22, 3, v0
    v_and_b32 v23, 7, v0
    v_xor_b32 v23, v23, v9
    v_lshlrev_b32 v22, 10, v22
    v_lshl_add_u32 v24, v23, 4, v22
    v_xor_b32 v25, 64, v24
    v_add_u32 v25, 7168, v25
    v_add_u32 v26, 14336, v24
    v_add_u32 v27, 14336, v25
    s_lshl_b32 s38, s23, 8
    s_lshl_b32 s39, s20, 5
    s_add_u32 s38, s38, s39
    s_lshl_b32 s92, s38, 10
    s_add_u32 s93, s92, 131072
    s_cmp_lg_u32 s2, 0
    s_cbranch_scc1 attn_kernel_nz3
    s_cmp_lg_u32 s20, 0
    s_cbranch_scc1 attn_kernel_nz3
    v_lshlrev_b32 v30, 8, v0
    v_mov_b32 v31, 0
    buffer_store_dword v31, v30, s[72:75], 0 offen sc0 sc1
    v_add_u32 v30, 16384, v30
    buffer_store_dword v31, v30, s[72:75], 0 offen sc0 sc1
attn_kernel_nz3:
    s_lshl_b32 s39, s20, 12
    s_add_u32 m0, s39, 98304
    s_add_u32 s38, s35, 0
    buffer_load_dwordx4 v16, s[80:83], s38 offen offset:0 lds
    buffer_load_dwordx4 v17, s[80:83], s38 offen offset:1024 lds
    buffer_load_dwordx4 v18, s[80:83], s38 offen offset:2048 lds
    buffer_load_dwordx4 v19, s[80:83], s38 offen offset:3072 lds
    s_add_u32 m0, s39, 114688
    s_add_u32 s38, s92, 0
    buffer_load_dwordx4 v24, s[88:91], s38 offen offset:0 lds
    buffer_load_dwordx4 v25, s[88:91], s38 offen offset:1024 lds
    buffer_load_dwordx4 v26, s[88:91], s38 offen offset:2048 lds
    buffer_load_dwordx4 v27, s[88:91], s38 offen offset:3072 lds
    s_add_u32 m0, s39, 131072
    s_add_u32 s38, s93, 0
    buffer_load_dwordx4 v24, s[88:91], s38 offen offset:0 lds
    buffer_load_dwordx4 v25, s[88:91], s38 offen offset:1024 lds
    buffer_load_dwordx4 v26, s[88:91], s38 offen offset:2048 lds
    buffer_load_dwordx4 v27, s[88:91], s38 offen offset:3072 lds
    s_lshl_b32 s39, s20, 12
    s_add_u32 m0, s39, 0
    s_add_u32 s38, s35, 524288
    buffer_load_dwordx4 v16, s[80:83], s38 offen offset:0 lds
    buffer_load_dwordx4 v17, s[80:83], s38 offen offset:1024 lds
    buffer_load_dwordx4 v18, s[80:83], s38 offen offset:2048 lds
    buffer_load_dwordx4 v19, s[80:83], s38 offen offset:3072 lds
    s_add_u32 m0, s39, 16384
    s_add_u32 s38, s92, 128
    buffer_load_dwordx4 v24, s[88:91], s38 offen offset:0 lds
    buffer_load_dwordx4 v25, s[88:91], s38 offen offset:1024 lds
    buffer_load_dwordx4 v26, s[88:91], s38 offen offset:2048 lds
    buffer_load_dwordx4 v27, s[88:91], s38 offen offset:3072 lds
    s_add_u32 m0, s39, 32768
    s_add_u32 s38, s93, 128
    buffer_load_dwordx4 v24, s[88:91], s38 offen offset:0 lds
    buffer_load_dwordx4 v25, s[88:91], s38 offen offset:1024 lds
    buffer_load_dwordx4 v26, s[88:91], s38 offen offset:2048 lds
    buffer_load_dwordx4 v27, s[88:91], s38 offen offset:3072 lds
    s_mov_b32 s76, s66
    s_mov_b32 s77, s67
    s_mov_b32 s78, 256
    s_mov_b32 s79, 0x00020000
    s_mov_b32 s64, s64
    s_mov_b32 s65, s65
    s_mov_b32 s66, 2097152
    s_mov_b32 s67, 0x00020000
    s_mov_b32 s68, s42
    s_mov_b32 s69, s43
    s_mov_b32 s70, 24576
    s_mov_b32 s71, 0x00020000
    s_and_b32 s38, s2, 7
    s_mul_i32 s38, s38, 24
    s_lshr_b32 s39, s2, 3
    s_add_u32 s48, s38, s39
    s_lshl_b32 s38, s2, 3
    s_lshl_b32 s39, s20, 1
    s_add_u32 s50, s38, s39
    s_lshl_b32 s38, s50, 10
    buffer_load_dwordx4 v[104:107], v1, s[64:67], s38 offen
    buffer_load_dwordx4 v[108:111], v1, s[64:67], s38 offen offset:1024
    s_waitcnt vmcnt(14)
    s_barrier
    s_lshl_b32 s39, s20, 12
    s_add_u32 m0, s39, 49152
    s_add_u32 s38, s35, 1048576
    buffer_load_dwordx4 v16, s[80:83], s38 offen offset:0 lds
    buffer_load_dwordx4 v17, s[80:83], s38 offen offset:1024 lds
    buffer_load_dwordx4 v18, s[80:83], s38 offen offset:2048 lds
    buffer_load_dwordx4 v19, s[80:83], s38 offen offset:3072 lds
    s_add_u32 m0, s39, 65536
    s_add_u32 s38, s92, 256
    buffer_load_dwordx4 v24, s[88:91], s38 offen offset:0 lds
    buffer_load_dwordx4 v25, s[88:91], s38 offen offset:1024 lds
    buffer_load_dwordx4 v26, s[88:91], s38 offen offset:2048 lds
    buffer_load_dwordx4 v27, s[88:91], s38 offen offset:3072 lds
    s_add_u32 m0, s39, 81920
    s_add_u32 s38, s93, 256
    buffer_load_dwordx4 v24, s[88:91], s38 offen offset:0 lds
    buffer_load_dwordx4 v25, s[88:91], s38 offen offset:1024 lds
    buffer_load_dwordx4 v26, s[88:91], s38 offen offset:2048 lds
    buffer_load_dwordx4 v27, s[88:91], s38 offen offset:3072 lds
    s_cmp_lg_u32 s20, 0
    s_cbranch_scc1 attn_kernel_w44
    s_mov_b64 exec, 1
    s_mov_b64 exec, 0xffff
    v_lshlrev_b32 v92, 2, v0
    v_add_u32 v93, 147456, v92
    ds_read_b32 v84, v93
    ds_read_b32 v85, v93 offset:64
    ds_read_b32 v86, v93 offset:128
    ds_read_b32 v87, v93 offset:192
    s_waitcnt lgkmcnt(0)
    v_add_f32 v84, v84, v85
    v_add_f32 v86, v86, v87
    v_add_f32 v84, v84, v86
    v_cvt_pk_bf16_f32 v84, v84, v84
    v_lshlrev_b32 v84, 16, v84
    s_lshl_b32 s38, s48, 6
    s_lshl_b32 s39, s48, 7
    s_add_u32 s39, s39, 16384
    s_cmp_lt_u32 s48, 64
    s_cselect_b32 s38, s39, s38
    s_cmp_ge_u32 s2, 192
    s_cselect_b32 s70, 0, 24576
    buffer_store_dword v84, v92, s[68:71], s38 offen sc0 sc1
    s_mov_b32 s70, 24576
    s_mov_b64 exec, -1
attn_kernel_w44:
    s_waitcnt vmcnt(14)
    s_barrier
    s_lshl_b32 s39, s20, 12
    s_add_u32 m0, s39, 98304
    s_add_u32 s38, s35, 1572864
    buffer_load_dwordx4 v16, s[80:83], s38 offen offset:0 lds
    buffer_load_dwordx4 v17, s[80:83], s38 offen offset:1024 lds
    buffer_load_dwordx4 v18, s[80:83], s38 offen offset:2048 lds
    buffer_load_dwordx4 v19, s[80:83], s38 offen offset:3072 lds
    s_add_u32 m0, s39, 114688
    s_add_u32 s38, s92, 384
    buffer_load_dwordx4 v24, s[88:91], s38 offen offset:0 lds
    buffer_load_dwordx4 v25, s[88:91], s38 offen offset:1024 lds
    buffer_load_dwordx4 v26, s[88:91], s38 offen offset:2048 lds
    buffer_load_dwordx4 v27, s[88:91], s38 offen offset:3072 lds
    s_add_u32 m0, s39, 131072
    s_add_u32 s38, s93, 384
    buffer_load_dwordx4 v24, s[88:91], s38 offen offset:0 lds
    buffer_load_dwordx4 v25, s[88:91], s38 offen offset:1024 lds
    buffer_load_dwordx4 v26, s[88:91], s38 offen offset:2048 lds
    buffer_load_dwordx4 v27, s[88:91], s38 offen offset:3072 lds
    s_waitcnt vmcnt(24)
    s_mov_b32 s56, 0x3727c5ac
    s_mov_b32 s57, 0x3b000000
    v_lshlrev_b32 v112, 16, v104
    v_and_b32 v113, 0xffff0000, v104
    v_lshlrev_b32 v114, 16, v105
    v_and_b32 v115, 0xffff0000, v105
    v_lshlrev_b32 v116, 16, v106
    v_and_b32 v117, 0xffff0000, v106
    v_lshlrev_b32 v118, 16, v107
    v_and_b32 v119, 0xffff0000, v107
    v_add_f32 v36, v112, v113
    v_add_f32 v36, v36, v114
    v_add_f32 v36, v36, v115
    v_add_f32 v36, v36, v116
    v_add_f32 v36, v36, v117
    v_add_f32 v36, v36, v118
    v_add_f32 v36, v36, v119
    s_nop 1
    v_add_f32_dpp v36, v36, v36 quad_perm:[1,0,3,2] row_mask:0xf bank_mask:0xf
    s_nop 1
    v_add_f32_dpp v36, v36, v36 quad_perm:[2,3,0,1] row_mask:0xf bank_mask:0xf
    s_nop 1
    v_add_f32_dpp v36, v36, v36 row_ror:4 row_mask:0xf bank_mask:0xf
    s_nop 1
    v_add_f32_dpp v36, v36, v36 row_ror:8 row_mask:0xf bank_mask:0xf
    v_mov_b32 v37, v36
    s_nop 1
    v_permlane16_swap_b32 v36, v37
    s_nop 1
    v_add_f32 v36, v36, v37
    v_mov_b32 v37, v36
    s_nop 1
    v_permlane32_swap_b32 v36, v37
    s_nop 1
    v_add_f32 v36, v36, v37
    v_mul_f32 v36, 0x3b000000, v36
    v_sub_f32 v112, v112, v36
    v_sub_f32 v113, v113, v36
    v_sub_f32 v114, v114, v36
    v_sub_f32 v115, v115, v36
    v_sub_f32 v116, v116, v36
    v_sub_f32 v117, v117, v36
    v_sub_f32 v118, v118, v36
    v_sub_f32 v119, v119, v36
    v_mul_f32 v36, v112, v112
    v_fma_f32 v36, v113, v113, v36
    v_fma_f32 v36, v114, v114, v36
    v_fma_f32 v36, v115, v115, v36
    v_fma_f32 v36, v116, v116, v36
    v_fma_f32 v36, v117, v117, v36
    v_fma_f32 v36, v118, v118, v36
    v_fma_f32 v36, v119, v119, v36
    s_nop 1
    v_add_f32_dpp v36, v36, v36 quad_perm:[1,0,3,2] row_mask:0xf bank_mask:0xf
    s_nop 1
    v_add_f32_dpp v36, v36, v36 quad_perm:[2,3,0,1] row_mask:0xf bank_mask:0xf
    s_nop 1
    v_add_f32_dpp v36, v36, v36 row_ror:4 row_mask:0xf bank_mask:0xf
    s_nop 1
    v_add_f32_dpp v36, v36, v36 row_ror:8 row_mask:0xf bank_mask:0xf
    v_mov_b32 v37, v36
    s_nop 1
    v_permlane16_swap_b32 v36, v37
    s_nop 1
    v_add_f32 v36, v36, v37
    v_mov_b32 v37, v36
    s_nop 1
    v_permlane32_swap_b32 v36, v37
    s_nop 1
    v_add_f32 v36, v36, v37
    v_mov_b32 v37, s56
    v_fma_f32 v36, v36, s57, v37
    v_rsq_f32 v36, v36
    s_nop 0
    v_mul_f32 v112, v112, v36
    v_mul_f32 v113, v113, v36
    v_mul_f32 v114, v114, v36
    v_mul_f32 v115, v115, v36
    v_mul_f32 v116, v116, v36
    v_mul_f32 v117, v117, v36
    v_mul_f32 v118, v118, v36
    v_mul_f32 v119, v119, v36
    s_waitcnt vmcnt(12)
    s_barrier
    s_cmp_lg_u32 s20, 0
    s_cbranch_scc1 attn_kernel_w45
    s_mov_b64 exec, 1
    s_cmp_ge_u32 s2, 192
    s_cbranch_scc1 attn_kernel_na6
    s_cmp_lt_u32 s48, 64
    s_cselect_b32 s38, 0, 128
    v_mov_b32 v30, s38
    v_mov_b32 v31, 1
    buffer_atomic_add v31, v30, s[76:79], 0 offen sc1
attn_kernel_na6:
    s_mov_b64 exec, -1
attn_kernel_w45:
    s_lshl_b32 s39, s20, 12
    s_add_u32 m0, s39, 0
    s_add_u32 s38, s35, 2097152
    buffer_load_dwordx4 v16, s[80:83], s38 offen offset:0 lds
    buffer_load_dwordx4 v17, s[80:83], s38 offen offset:1024 lds
    buffer_load_dwordx4 v18, s[80:83], s38 offen offset:2048 lds
    buffer_load_dwordx4 v19, s[80:83], s38 offen offset:3072 lds
    s_add_u32 m0, s39, 16384
    s_add_u32 s38, s92, 512
    buffer_load_dwordx4 v24, s[88:91], s38 offen offset:0 lds
    buffer_load_dwordx4 v25, s[88:91], s38 offen offset:1024 lds
    buffer_load_dwordx4 v26, s[88:91], s38 offen offset:2048 lds
    buffer_load_dwordx4 v27, s[88:91], s38 offen offset:3072 lds
    s_add_u32 m0, s39, 32768
    s_add_u32 s38, s93, 512
    buffer_load_dwordx4 v24, s[88:91], s38 offen offset:0 lds
    buffer_load_dwordx4 v25, s[88:91], s38 offen offset:1024 lds
    buffer_load_dwordx4 v26, s[88:91], s38 offen offset:2048 lds
    buffer_load_dwordx4 v27, s[88:91], s38 offen offset:3072 lds
    s_waitcnt vmcnt(12)
    s_barrier
    s_lshl_b32 s39, s20, 12
    s_add_u32 m0, s39, 49152
    s_add_u32 s38, s35, 2621440
    buffer_load_dwordx4 v16, s[80:83], s38 offen offset:0 lds
    buffer_load_dwordx4 v17, s[80:83], s38 offen offset:1024 lds
    buffer_load_dwordx4 v18, s[80:83], s38 offen offset:2048 lds
    buffer_load_dwordx4 v19, s[80:83], s38 offen offset:3072 lds
    s_add_u32 m0, s39, 65536
    s_add_u32 s38, s92, 640
    buffer_load_dwordx4 v24, s[88:91], s38 offen offset:0 lds
    buffer_load_dwordx4 v25, s[88:91], s38 offen offset:1024 lds
    buffer_load_dwordx4 v26, s[88:91], s38 offen offset:2048 lds
    buffer_load_dwordx4 v27, s[88:91], s38 offen offset:3072 lds
    s_add_u32 m0, s39, 81920
    s_add_u32 s38, s93, 640
    buffer_load_dwordx4 v24, s[88:91], s38 offen offset:0 lds
    buffer_load_dwordx4 v25, s[88:91], s38 offen offset:1024 lds
    buffer_load_dwordx4 v26, s[88:91], s38 offen offset:2048 lds
    buffer_load_dwordx4 v27, s[88:91], s38 offen offset:3072 lds
    s_mov_b32 s56, 0x3727c5ac
    s_mov_b32 s57, 0x3b000000
    v_lshlrev_b32 v120, 16, v108
    v_and_b32 v121, 0xffff0000, v108
    v_lshlrev_b32 v122, 16, v109
    v_and_b32 v123, 0xffff0000, v109
    v_lshlrev_b32 v124, 16, v110
    v_and_b32 v125, 0xffff0000, v110
    v_lshlrev_b32 v126, 16, v111
    v_and_b32 v127, 0xffff0000, v111
    v_add_f32 v36, v120, v121
    v_add_f32 v36, v36, v122
    v_add_f32 v36, v36, v123
    v_add_f32 v36, v36, v124
    v_add_f32 v36, v36, v125
    v_add_f32 v36, v36, v126
    v_add_f32 v36, v36, v127
    s_nop 1
    v_add_f32_dpp v36, v36, v36 quad_perm:[1,0,3,2] row_mask:0xf bank_mask:0xf
    s_nop 1
    v_add_f32_dpp v36, v36, v36 quad_perm:[2,3,0,1] row_mask:0xf bank_mask:0xf
    s_nop 1
    v_add_f32_dpp v36, v36, v36 row_ror:4 row_mask:0xf bank_mask:0xf
    s_nop 1
    v_add_f32_dpp v36, v36, v36 row_ror:8 row_mask:0xf bank_mask:0xf
    v_mov_b32 v37, v36
    s_nop 1
    v_permlane16_swap_b32 v36, v37
    s_nop 1
    v_add_f32 v36, v36, v37
    v_mov_b32 v37, v36
    s_nop 1
    v_permlane32_swap_b32 v36, v37
    s_nop 1
    v_add_f32 v36, v36, v37
    v_mul_f32 v36, 0x3b000000, v36
    v_sub_f32 v120, v120, v36
    v_sub_f32 v121, v121, v36
    v_sub_f32 v122, v122, v36
    v_sub_f32 v123, v123, v36
    v_sub_f32 v124, v124, v36
    v_sub_f32 v125, v125, v36
    v_sub_f32 v126, v126, v36
    v_sub_f32 v127, v127, v36
    v_mul_f32 v36, v120, v120
    v_fma_f32 v36, v121, v121, v36
    v_fma_f32 v36, v122, v122, v36
    v_fma_f32 v36, v123, v123, v36
    v_fma_f32 v36, v124, v124, v36
    v_fma_f32 v36, v125, v125, v36
    v_fma_f32 v36, v126, v126, v36
    v_fma_f32 v36, v127, v127, v36
    s_nop 1
    v_add_f32_dpp v36, v36, v36 quad_perm:[1,0,3,2] row_mask:0xf bank_mask:0xf
    s_nop 1
    v_add_f32_dpp v36, v36, v36 quad_perm:[2,3,0,1] row_mask:0xf bank_mask:0xf
    s_nop 1
    v_add_f32_dpp v36, v36, v36 row_ror:4 row_mask:0xf bank_mask:0xf
    s_nop 1
    v_add_f32_dpp v36, v36, v36 row_ror:8 row_mask:0xf bank_mask:0xf
    v_mov_b32 v37, v36
    s_nop 1
    v_permlane16_swap_b32 v36, v37
    s_nop 1
    v_add_f32 v36, v36, v37
    v_mov_b32 v37, v36
    s_nop 1
    v_permlane32_swap_b32 v36, v37
    s_nop 1
    v_add_f32 v36, v36, v37
    v_mov_b32 v37, s56
    v_fma_f32 v36, v36, s57, v37
    v_rsq_f32 v36, v36
    s_nop 0
    v_mul_f32 v120, v120, v36
    v_mul_f32 v121, v121, v36
    v_mul_f32 v122, v122, v36
    v_mul_f32 v123, v123, v36
    v_mul_f32 v124, v124, v36
    v_mul_f32 v125, v125, v36
    v_mul_f32 v126, v126, v36
    v_mul_f32 v127, v127, v36
    s_waitcnt vmcnt(12)
    s_barrier
    s_cmp_lg_u32 s20, 0
    s_cbranch_scc1 attn_kernel_w47
    s_mov_b64 exec, 1
    v_mov_b32 v30, 0
    buffer_load_dword v40, v30, s[76:79], 0 offen sc0 sc1
    s_mov_b64 exec, -1
attn_kernel_w47:
    s_lshl_b32 s39, s20, 12
    s_add_u32 m0, s39, 98304
    s_add_u32 s38, s35, 3145728
    buffer_load_dwordx4 v16, s[80:83], s38 offen offset:0 lds
    buffer_load_dwordx4 v17, s[80:83], s38 offen offset:1024 lds
    buffer_load_dwordx4 v18, s[80:83], s38 offen offset:2048 lds
    buffer_load_dwordx4 v19, s[80:83], s38 offen offset:3072 lds
    s_add_u32 m0, s39, 114688
    s_add_u32 s38, s92, 768
    buffer_load_dwordx4 v24, s[88:91], s38 offen offset:0 lds
    buffer_load_dwordx4 v25, s[88:91], s38 offen offset:1024 lds
    buffer_load_dwordx4 v26, s[88:91], s38 offen offset:2048 lds
    buffer_load_dwordx4 v27, s[88:91], s38 offen offset:3072 lds
    s_add_u32 m0, s39, 131072
    s_add_u32 s38, s93, 768
    buffer_load_dwordx4 v24, s[88:91], s38 offen offset:0 lds
    buffer_load_dwordx4 v25, s[88:91], s38 offen offset:1024 lds
    buffer_load_dwordx4 v26, s[88:91], s38 offen offset:2048 lds
    buffer_load_dwordx4 v27, s[88:91], s38 offen offset:3072 lds
    s_waitcnt vmcnt(12)
    s_barrier
    s_cmp_lg_u32 s20, 0
    s_cbranch_scc1 attn_kernel_w48
    s_mov_b64 exec, 1
    s_waitcnt vmcnt(12)
    s_mov_b32 s39, 0
attn_kernel_pp9:
    v_readfirstlane_b32 s38, v40
    s_cmp_ge_u32 s38, 64
    s_cbranch_scc1 attn_kernel_pd10
    s_add_u32 s39, s39, 1
    s_cmp_gt_u32 s39, 60000
    s_cbranch_scc1 attn_kernel_pd10
    s_sleep 8
    v_mov_b32 v30, 0
    buffer_load_dword v40, v30, s[76:79], 0 offen sc0 sc1
    s_waitcnt vmcnt(0)
    s_branch attn_kernel_pp9
attn_kernel_pd10:
    s_mov_b64 exec, -1
attn_kernel_w48:
    s_lshl_b32 s39, s20, 12
    s_add_u32 m0, s39, 0
    s_add_u32 s38, s35, 3670016
    buffer_load_dwordx4 v16, s[80:83], s38 offen offset:0 lds
    buffer_load_dwordx4 v17, s[80:83], s38 offen offset:1024 lds
    buffer_load_dwordx4 v18, s[80:83], s38 offen offset:2048 lds
    buffer_load_dwordx4 v19, s[80:83], s38 offen offset:3072 lds
    s_add_u32 m0, s39, 16384
    s_add_u32 s38, s92, 896
    buffer_load_dwordx4 v24, s[88:91], s38 offen offset:0 lds
    buffer_load_dwordx4 v25, s[88:91], s38 offen offset:1024 lds
    buffer_load_dwordx4 v26, s[88:91], s38 offen offset:2048 lds
    buffer_load_dwordx4 v27, s[88:91], s38 offen offset:3072 lds
    s_add_u32 m0, s39, 32768
    s_add_u32 s38, s93, 896
    buffer_load_dwordx4 v24, s[88:91], s38 offen offset:0 lds
    buffer_load_dwordx4 v25, s[88:91], s38 offen offset:1024 lds
    buffer_load_dwordx4 v26, s[88:91], s38 offen offset:2048 lds
    buffer_load_dwordx4 v27, s[88:91], s38 offen offset:3072 lds
    s_waitcnt vmcnt(12)
    s_barrier
    v_lshrrev_b32 v38, 1, v0
    v_lshlrev_b32 v38, 7, v38
    v_and_b32 v39, 1, v0
    v_lshl_add_u32 v38, v39, 5, v38
    s_mov_b32 s38, 16384
    s_mov_b32 s39, 20480
    buffer_load_dwordx4 v[64:67], v38, s[68:71], s38 offen offset:0
    buffer_load_dwordx4 v[68:71], v38, s[68:71], s38 offen offset:16
    buffer_load_dwordx4 v[72:75], v38, s[68:71], s39 offen offset:0
    buffer_load_dwordx4 v[76:79], v38, s[68:71], s39 offen offset:16
    s_lshl_b32 s39, s20, 12
    s_add_u32 m0, s39, 49152
    s_add_u32 s38, s35, 0
    buffer_load_dwordx4 v16, s[84:87], s38 offen offset:0 lds
    buffer_load_dwordx4 v17, s[84:87], s38 offen offset:1024 lds
    buffer_load_dwordx4 v18, s[84:87], s38 offen offset:2048 lds
    buffer_load_dwordx4 v19, s[84:87], s38 offen offset:3072 lds
    s_add_u32 m0, s39, 65536
    s_add_u32 s38, s92, 0
    buffer_load_dwordx4 v24, s[88:91], s38 offen offset:0 lds
    buffer_load_dwordx4 v25, s[88:91], s38 offen offset:1024 lds
    buffer_load_dwordx4 v26, s[88:91], s38 offen offset:2048 lds
    buffer_load_dwordx4 v27, s[88:91], s38 offen offset:3072 lds
    s_add_u32 m0, s39, 81920
    s_add_u32 s38, s93, 0
    buffer_load_dwordx4 v24, s[88:91], s38 offen offset:0 lds
    buffer_load_dwordx4 v25, s[88:91], s38 offen offset:1024 lds
    buffer_load_dwordx4 v26, s[88:91], s38 offen offset:2048 lds
    buffer_load_dwordx4 v27, s[88:91], s38 offen offset:3072 lds
    s_waitcnt vmcnt(16)
    s_barrier
    s_waitcnt vmcnt(12)
    v_add_f32 v72, 1.0, v72
    v_mul_f32 v72, 0x3e0293ee, v72
    v_mul_f32 v64, 0x3e0293ee, v64
    v_add_f32 v73, 1.0, v73
    v_mul_f32 v73, 0x3e0293ee, v73
    v_mul_f32 v65, 0x3e0293ee, v65
    v_add_f32 v74, 1.0, v74
    v_mul_f32 v74, 0x3e0293ee, v74
    v_mul_f32 v66, 0x3e0293ee, v66
    v_add_f32 v75, 1.0, v75
    v_mul_f32 v75, 0x3e0293ee, v75
    v_mul_f32 v67, 0x3e0293ee, v67
    v_add_f32 v76, 1.0, v76
    v_mul_f32 v76, 0x3e0293ee, v76
    v_mul_f32 v68, 0x3e0293ee, v68
    v_add_f32 v77, 1.0, v77
    v_mul_f32 v77, 0x3e0293ee, v77
    v_mul_f32 v69, 0x3e0293ee, v69
    v_add_f32 v78, 1.0, v78
    v_mul_f32 v78, 0x3e0293ee, v78
    v_mul_f32 v70, 0x3e0293ee, v70
    v_add_f32 v79, 1.0, v79
    v_mul_f32 v79, 0x3e0293ee, v79
    v_mul_f32 v71, 0x3e0293ee, v71
    v_lshrrev_b32 v38, 1, v0
    v_lshlrev_b32 v38, 10, v38
    v_and_b32 v39, 1, v0
    v_lshl_add_u32 v38, v39, 9, v38
    s_lshr_b32 s38, s50, 5
    s_lshl_b32 s38, s38, 15
    s_and_b32 s39, s50, 31
    s_lshl_b32 s39, s39, 4
    s_add_u32 s49, s38, s39
    v_fma_f32 v112, v112, v72, v64
    v_fma_f32 v113, v113, v73, v65
    v_fma_f32 v114, v114, v74, v66
    v_fma_f32 v115, v115, v75, v67
    v_fma_f32 v116, v116, v76, v68
    v_fma_f32 v117, v117, v77, v69
    v_fma_f32 v118, v118, v78, v70
    v_fma_f32 v119, v119, v79, v71
    v_cvt_pk_bf16_f32 v112, v112, v113
    v_cvt_pk_bf16_f32 v113, v114, v115
    v_cvt_pk_bf16_f32 v114, v116, v117
    v_cvt_pk_bf16_f32 v115, v118, v119
    v_fma_f32 v120, v120, v72, v64
    v_fma_f32 v121, v121, v73, v65
    v_fma_f32 v122, v122, v74, v66
    v_fma_f32 v123, v123, v75, v67
    v_fma_f32 v124, v124, v76, v68
    v_fma_f32 v125, v125, v77, v69
    v_fma_f32 v126, v126, v78, v70
    v_fma_f32 v127, v127, v79, v71
    v_cvt_pk_bf16_f32 v120, v120, v121
    v_cvt_pk_bf16_f32 v121, v122, v123
    v_cvt_pk_bf16_f32 v122, v124, v125
    v_cvt_pk_bf16_f32 v123, v126, v127
    buffer_store_dwordx4 v[112:115], v38, s[4:7], s49 offen offset:0 sc0 sc1
    buffer_store_dwordx4 v[120:123], v38, s[4:7], s49 offen offset:16 sc0 sc1
    s_lshl_b32 s39, s20, 12
    s_add_u32 m0, s39, 98304
    s_add_u32 s38, s35, 524288
    buffer_load_dwordx4 v16, s[84:87], s38 offen offset:0 lds
    buffer_load_dwordx4 v17, s[84:87], s38 offen offset:1024 lds
    buffer_load_dwordx4 v18, s[84:87], s38 offen offset:2048 lds
    buffer_load_dwordx4 v19, s[84:87], s38 offen offset:3072 lds
    s_add_u32 m0, s39, 114688
    s_add_u32 s38, s92, 128
    buffer_load_dwordx4 v24, s[88:91], s38 offen offset:0 lds
    buffer_load_dwordx4 v25, s[88:91], s38 offen offset:1024 lds
    buffer_load_dwordx4 v26, s[88:91], s38 offen offset:2048 lds
    buffer_load_dwordx4 v27, s[88:91], s38 offen offset:3072 lds
    s_add_u32 m0, s39, 131072
    s_add_u32 s38, s93, 128
    buffer_load_dwordx4 v24, s[88:91], s38 offen offset:0 lds
    buffer_load_dwordx4 v25, s[88:91], s38 offen offset:1024 lds
    buffer_load_dwordx4 v26, s[88:91], s38 offen offset:2048 lds
    buffer_load_dwordx4 v27, s[88:91], s38 offen offset:3072 lds
    s_waitcnt vmcnt(14)
    s_barrier
    s_lshl_b32 s39, s20, 12
    s_add_u32 m0, s39, 0
    s_add_u32 s38, s35, 1048576
    buffer_load_dwordx4 v16, s[84:87], s38 offen offset:0 lds
    buffer_load_dwordx4 v17, s[84:87], s38 offen offset:1024 lds
    buffer_load_dwordx4 v18, s[84:87], s38 offen offset:2048 lds
    buffer_load_dwordx4 v19, s[84:87], s38 offen offset:3072 lds
    s_add_u32 m0, s39, 16384
    s_add_u32 s38, s92, 256
    buffer_load_dwordx4 v24, s[88:91], s38 offen offset:0 lds
    buffer_load_dwordx4 v25, s[88:91], s38 offen offset:1024 lds
    buffer_load_dwordx4 v26, s[88:91], s38 offen offset:2048 lds
    buffer_load_dwordx4 v27, s[88:91], s38 offen offset:3072 lds
    s_add_u32 m0, s39, 32768
    s_add_u32 s38, s93, 256
    buffer_load_dwordx4 v24, s[88:91], s38 offen offset:0 lds
    buffer_load_dwordx4 v25, s[88:91], s38 offen offset:1024 lds
    buffer_load_dwordx4 v26, s[88:91], s38 offen offset:2048 lds
    buffer_load_dwordx4 v27, s[88:91], s38 offen offset:3072 lds
    s_waitcnt vmcnt(24)
    s_waitcnt vmcnt(12)
    s_barrier
    s_cmp_lg_u32 s20, 0
    s_cbranch_scc1 attn_kernel_w411
    s_mov_b64 exec, 1
    s_lshr_b32 s49, s2, 4
    s_lshl_b32 s38, s49, 8
    s_add_u32 s38, s38, 16640
    v_mov_b32 v30, s38
    v_mov_b32 v31, 1
    buffer_atomic_add v31, v30, s[72:75], 0 offen sc1
    s_mov_b64 exec, -1
attn_kernel_w411:
    s_lshl_b32 s39, s20, 12
    s_add_u32 m0, s39, 49152
    s_add_u32 s38, s35, 1572864
    buffer_load_dwordx4 v16, s[84:87], s38 offen offset:0 lds
    buffer_load_dwordx4 v17, s[84:87], s38 offen offset:1024 lds
    buffer_load_dwordx4 v18, s[84:87], s38 offen offset:2048 lds
    buffer_load_dwordx4 v19, s[84:87], s38 offen offset:3072 lds
    s_add_u32 m0, s39, 65536
    s_add_u32 s38, s92, 384
    buffer_load_dwordx4 v24, s[88:91], s38 offen offset:0 lds
    buffer_load_dwordx4 v25, s[88:91], s38 offen offset:1024 lds
    buffer_load_dwordx4 v26, s[88:91], s38 offen offset:2048 lds
    buffer_load_dwordx4 v27, s[88:91], s38 offen offset:3072 lds
    s_add_u32 m0, s39, 81920
    s_add_u32 s38, s93, 384
    buffer_load_dwordx4 v24, s[88:91], s38 offen offset:0 lds
    buffer_load_dwordx4 v25, s[88:91], s38 offen offset:1024 lds
    buffer_load_dwordx4 v26, s[88:91], s38 offen offset:2048 lds
    buffer_load_dwordx4 v27, s[88:91], s38 offen offset:3072 lds
    s_waitcnt vmcnt(12)
    s_barrier
    s_lshl_b32 s39, s20, 12
    s_add_u32 m0, s39, 98304
    s_add_u32 s38, s35, 2097152
    buffer_load_dwordx4 v16, s[84:87], s38 offen offset:0 lds
    buffer_load_dwordx4 v17, s[84:87], s38 offen offset:1024 lds
    buffer_load_dwordx4 v18, s[84:87], s38 offen offset:2048 lds
    buffer_load_dwordx4 v19, s[84:87], s38 offen offset:3072 lds
    s_add_u32 m0, s39, 114688
    s_add_u32 s38, s92, 512
    buffer_load_dwordx4 v24, s[88:91], s38 offen offset:0 lds
    buffer_load_dwordx4 v25, s[88:91], s38 offen offset:1024 lds
    buffer_load_dwordx4 v26, s[88:91], s38 offen offset:2048 lds
    buffer_load_dwordx4 v27, s[88:91], s38 offen offset:3072 lds
    s_add_u32 m0, s39, 131072
    s_add_u32 s38, s93, 512
    buffer_load_dwordx4 v24, s[88:91], s38 offen offset:0 lds
    buffer_load_dwordx4 v25, s[88:91], s38 offen offset:1024 lds
    buffer_load_dwordx4 v26, s[88:91], s38 offen offset:2048 lds
    buffer_load_dwordx4 v27, s[88:91], s38 offen offset:3072 lds
    s_waitcnt vmcnt(12)
    s_barrier
    s_cmp_lg_u32 s20, 0
    s_cbranch_scc1 attn_kernel_w412
    s_mov_b64 exec, 1
    s_lshl_b32 s38, s22, 8
    s_add_u32 s38, s38, 16640
    v_mov_b32 v30, s38
    buffer_load_dword v40, v30, s[72:75], 0 offen sc0 sc1
    s_lshl_b32 s38, s23, 8
    s_add_u32 s38, s38, 16640
    v_mov_b32 v30, s38
    buffer_load_dword v41, v30, s[72:75], 0 offen sc0 sc1
    s_mov_b64 exec, -1
attn_kernel_w412:
    s_lshl_b32 s39, s20, 12
    s_add_u32 m0, s39, 0
    s_add_u32 s38, s35, 2621440
    buffer_load_dwordx4 v16, s[84:87], s38 offen offset:0 lds
    buffer_load_dwordx4 v17, s[84:87], s38 offen offset:1024 lds
    buffer_load_dwordx4 v18, s[84:87], s38 offen offset:2048 lds
    buffer_load_dwordx4 v19, s[84:87], s38 offen offset:3072 lds
    s_add_u32 m0, s39, 16384
    s_add_u32 s38, s92, 640
    buffer_load_dwordx4 v24, s[88:91], s38 offen offset:0 lds
    buffer_load_dwordx4 v25, s[88:91], s38 offen offset:1024 lds
    buffer_load_dwordx4 v26, s[88:91], s38 offen offset:2048 lds
    buffer_load_dwordx4 v27, s[88:91], s38 offen offset:3072 lds
    s_add_u32 m0, s39, 32768
    s_add_u32 s38, s93, 640
    buffer_load_dwordx4 v24, s[88:91], s38 offen offset:0 lds
    buffer_load_dwordx4 v25, s[88:91], s38 offen offset:1024 lds
    buffer_load_dwordx4 v26, s[88:91], s38 offen offset:2048 lds
    buffer_load_dwordx4 v27, s[88:91], s38 offen offset:3072 lds
    s_waitcnt vmcnt(12)
    s_barrier
    s_cmp_lg_u32 s20, 0
    s_cbranch_scc1 attn_kernel_w413
    s_mov_b64 exec, 1
    s_waitcnt vmcnt(12)
    s_mov_b32 s39, 0
attn_kernel_pp14:
    v_readfirstlane_b32 s38, v40
    s_cmp_ge_u32 s38, 16
    s_cbranch_scc1 attn_kernel_pd15
    s_add_u32 s39, s39, 1
    s_cmp_gt_u32 s39, 60000
    s_cbranch_scc1 attn_kernel_pd15
    s_sleep 8
    s_lshl_b32 s38, s22, 8
    s_add_u32 s38, s38, 16640
    v_mov_b32 v30, s38
    buffer_load_dword v40, v30, s[72:75], 0 offen sc0 sc1
    s_waitcnt vmcnt(0)
    s_branch attn_kernel_pp14
attn_kernel_pd15:
    s_mov_b32 s39, 0
attn_kernel_pp16:
    v_readfirstlane_b32 s38, v41
    s_cmp_ge_u32 s38, 16
    s_cbranch_scc1 attn_kernel_pd17
    s_add_u32 s39, s39, 1
    s_cmp_gt_u32 s39, 60000
    s_cbranch_scc1 attn_kernel_pd17
    s_sleep 8
    s_lshl_b32 s38, s23, 8
    s_add_u32 s38, s38, 16640
    v_mov_b32 v30, s38
    buffer_load_dword v41, v30, s[72:75], 0 offen sc0 sc1
    s_waitcnt vmcnt(0)
    s_branch attn_kernel_pp16
attn_kernel_pd17:
    s_mov_b64 exec, -1
attn_kernel_w413:
    s_lshl_b32 s39, s20, 12
    s_add_u32 m0, s39, 49152
    s_add_u32 s38, s35, 3145728
    buffer_load_dwordx4 v16, s[84:87], s38 offen offset:0 lds
    buffer_load_dwordx4 v17, s[84:87], s38 offen offset:1024 lds
    buffer_load_dwordx4 v18, s[84:87], s38 offen offset:2048 lds
    buffer_load_dwordx4 v19, s[84:87], s38 offen offset:3072 lds
    s_add_u32 m0, s39, 65536
    s_add_u32 s38, s92, 768
    buffer_load_dwordx4 v24, s[88:91], s38 offen offset:0 lds
    buffer_load_dwordx4 v25, s[88:91], s38 offen offset:1024 lds
    buffer_load_dwordx4 v26, s[88:91], s38 offen offset:2048 lds
    buffer_load_dwordx4 v27, s[88:91], s38 offen offset:3072 lds
    s_add_u32 m0, s39, 81920
    s_add_u32 s38, s93, 768
    buffer_load_dwordx4 v24, s[88:91], s38 offen offset:0 lds
    buffer_load_dwordx4 v25, s[88:91], s38 offen offset:1024 lds
    buffer_load_dwordx4 v26, s[88:91], s38 offen offset:2048 lds
    buffer_load_dwordx4 v27, s[88:91], s38 offen offset:3072 lds
    s_waitcnt vmcnt(12)
    s_barrier
    s_lshl_b32 s39, s20, 12
    s_add_u32 m0, s39, 98304
    s_add_u32 s38, s35, 3670016
    buffer_load_dwordx4 v16, s[84:87], s38 offen offset:0 lds
    buffer_load_dwordx4 v17, s[84:87], s38 offen offset:1024 lds
    buffer_load_dwordx4 v18, s[84:87], s38 offen offset:2048 lds
    buffer_load_dwordx4 v19, s[84:87], s38 offen offset:3072 lds
    s_add_u32 m0, s39, 114688
    s_add_u32 s38, s92, 896
    buffer_load_dwordx4 v24, s[88:91], s38 offen offset:0 lds
    buffer_load_dwordx4 v25, s[88:91], s38 offen offset:1024 lds
    buffer_load_dwordx4 v26, s[88:91], s38 offen offset:2048 lds
    buffer_load_dwordx4 v27, s[88:91], s38 offen offset:3072 lds
    s_add_u32 m0, s39, 131072
    s_add_u32 s38, s93, 896
    buffer_load_dwordx4 v24, s[88:91], s38 offen offset:0 lds
    buffer_load_dwordx4 v25, s[88:91], s38 offen offset:1024 lds
    buffer_load_dwordx4 v26, s[88:91], s38 offen offset:2048 lds
    buffer_load_dwordx4 v27, s[88:91], s38 offen offset:3072 lds
    s_waitcnt vmcnt(12)
    s_barrier
    s_lshl_b32 s39, s20, 12
    s_add_u32 m0, s39, 0
    s_add_u32 s38, s35, 0
    buffer_load_dwordx4 v16, s[8:11], s38 offen offset:0 lds
    buffer_load_dwordx4 v17, s[8:11], s38 offen offset:1024 lds
    buffer_load_dwordx4 v18, s[8:11], s38 offen offset:2048 lds
    buffer_load_dwordx4 v19, s[8:11], s38 offen offset:3072 lds
    s_add_u32 m0, s39, 16384
    s_add_u32 s38, s33, 0
    buffer_load_dwordx4 v1, s[4:7], s38 offen offset:0 lds
    buffer_load_dwordx4 v1, s[4:7], s38 offen offset:1024 lds
    buffer_load_dwordx4 v1, s[4:7], s38 offen offset:2048 lds
    buffer_load_dwordx4 v1, s[4:7], s38 offen offset:3072 lds
    s_add_u32 m0, s39, 32768
    s_add_u32 s38, s34, 0
    buffer_load_dwordx4 v1, s[4:7], s38 offen offset:0 lds
    buffer_load_dwordx4 v1, s[4:7], s38 offen offset:1024 lds
    buffer_load_dwordx4 v1, s[4:7], s38 offen offset:2048 lds
    buffer_load_dwordx4 v1, s[4:7], s38 offen offset:3072 lds
    s_waitcnt vmcnt(12)
    s_barrier
    s_lshl_b32 s39, s20, 12
    s_add_u32 m0, s39, 49152
    s_add_u32 s38, s35, 524288
    buffer_load_dwordx4 v16, s[8:11], s38 offen offset:0 lds
    buffer_load_dwordx4 v17, s[8:11], s38 offen offset:1024 lds
    buffer_load_dwordx4 v18, s[8:11], s38 offen offset:2048 lds
    buffer_load_dwordx4 v19, s[8:11], s38 offen offset:3072 lds
    s_add_u32 m0, s39, 65536
    s_add_u32 s38, s33, 4096
    buffer_load_dwordx4 v1, s[4:7], s38 offen offset:0 lds
    buffer_load_dwordx4 v1, s[4:7], s38 offen offset:1024 lds
    buffer_load_dwordx4 v1, s[4:7], s38 offen offset:2048 lds
    buffer_load_dwordx4 v1, s[4:7], s38 offen offset:3072 lds
    s_add_u32 m0, s39, 81920
    s_add_u32 s38, s34, 4096
    buffer_load_dwordx4 v1, s[4:7], s38 offen offset:0 lds
    buffer_load_dwordx4 v1, s[4:7], s38 offen offset:1024 lds
    buffer_load_dwordx4 v1, s[4:7], s38 offen offset:2048 lds
    buffer_load_dwordx4 v1, s[4:7], s38 offen offset:3072 lds
    s_waitcnt vmcnt(12)
    s_barrier
    s_lshl_b32 s39, s20, 12
    s_add_u32 m0, s39, 98304
    s_add_u32 s38, s35, 1048576
    buffer_load_dwordx4 v16, s[8:11], s38 offen offset:0 lds
    buffer_load_dwordx4 v17, s[8:11], s38 offen offset:1024 lds
    buffer_load_dwordx4 v18, s[8:11], s38 offen offset:2048 lds
    buffer_load_dwordx4 v19, s[8:11], s38 offen offset:3072 lds
    s_add_u32 m0, s39, 114688
    s_add_u32 s38, s33, 8192
    buffer_load_dwordx4 v1, s[4:7], s38 offen offset:0 lds
    buffer_load_dwordx4 v1, s[4:7], s38 offen offset:1024 lds
    buffer_load_dwordx4 v1, s[4:7], s38 offen offset:2048 lds
    buffer_load_dwordx4 v1, s[4:7], s38 offen offset:3072 lds
    s_add_u32 m0, s39, 131072
    s_add_u32 s38, s34, 8192
    buffer_load_dwordx4 v1, s[4:7], s38 offen offset:0 lds
    buffer_load_dwordx4 v1, s[4:7], s38 offen offset:1024 lds
    buffer_load_dwordx4 v1, s[4:7], s38 offen offset:2048 lds
    buffer_load_dwordx4 v1, s[4:7], s38 offen offset:3072 lds
    s_waitcnt vmcnt(12)
    s_barrier
    s_lshl_b32 s39, s20, 12
    s_add_u32 m0, s39, 0
    s_add_u32 s38, s35, 1572864
    buffer_load_dwordx4 v16, s[8:11], s38 offen offset:0 lds
    buffer_load_dwordx4 v17, s[8:11], s38 offen offset:1024 lds
    buffer_load_dwordx4 v18, s[8:11], s38 offen offset:2048 lds
    buffer_load_dwordx4 v19, s[8:11], s38 offen offset:3072 lds
    s_add_u32 m0, s39, 16384
    s_add_u32 s38, s33, 12288
    buffer_load_dwordx4 v1, s[4:7], s38 offen offset:0 lds
    buffer_load_dwordx4 v1, s[4:7], s38 offen offset:1024 lds
    buffer_load_dwordx4 v1, s[4:7], s38 offen offset:2048 lds
    buffer_load_dwordx4 v1, s[4:7], s38 offen offset:3072 lds
    s_add_u32 m0, s39, 32768
    s_add_u32 s38, s34, 12288
    buffer_load_dwordx4 v1, s[4:7], s38 offen offset:0 lds
    buffer_load_dwordx4 v1, s[4:7], s38 offen offset:1024 lds
    buffer_load_dwordx4 v1, s[4:7], s38 offen offset:2048 lds
    buffer_load_dwordx4 v1, s[4:7], s38 offen offset:3072 lds
    s_waitcnt vmcnt(12)
    s_barrier
    s_lshl_b32 s39, s20, 12
    s_add_u32 m0, s39, 49152
    s_add_u32 s38, s35, 2097152
    buffer_load_dwordx4 v16, s[8:11], s38 offen offset:0 lds
    buffer_load_dwordx4 v17, s[8:11], s38 offen offset:1024 lds
    buffer_load_dwordx4 v18, s[8:11], s38 offen offset:2048 lds
    buffer_load_dwordx4 v19, s[8:11], s38 offen offset:3072 lds
    s_add_u32 m0, s39, 65536
    s_add_u32 s38, s33, 16384
    buffer_load_dwordx4 v1, s[4:7], s38 offen offset:0 lds
    buffer_load_dwordx4 v1, s[4:7], s38 offen offset:1024 lds
    buffer_load_dwordx4 v1, s[4:7], s38 offen offset:2048 lds
    buffer_load_dwordx4 v1, s[4:7], s38 offen offset:3072 lds
    s_add_u32 m0, s39, 81920
    s_add_u32 s38, s34, 16384
    buffer_load_dwordx4 v1, s[4:7], s38 offen offset:0 lds
    buffer_load_dwordx4 v1, s[4:7], s38 offen offset:1024 lds
    buffer_load_dwordx4 v1, s[4:7], s38 offen offset:2048 lds
    buffer_load_dwordx4 v1, s[4:7], s38 offen offset:3072 lds
    s_waitcnt vmcnt(12)
    s_barrier
    s_lshl_b32 s39, s20, 12
    s_add_u32 m0, s39, 98304
    s_add_u32 s38, s35, 2621440
    buffer_load_dwordx4 v16, s[8:11], s38 offen offset:0 lds
    buffer_load_dwordx4 v17, s[8:11], s38 offen offset:1024 lds
    buffer_load_dwordx4 v18, s[8:11], s38 offen offset:2048 lds
    buffer_load_dwordx4 v19, s[8:11], s38 offen offset:3072 lds
    s_add_u32 m0, s39, 114688
    s_add_u32 s38, s33, 20480
    buffer_load_dwordx4 v1, s[4:7], s38 offen offset:0 lds
    buffer_load_dwordx4 v1, s[4:7], s38 offen offset:1024 lds
    buffer_load_dwordx4 v1, s[4:7], s38 offen offset:2048 lds
    buffer_load_dwordx4 v1, s[4:7], s38 offen offset:3072 lds
    s_add_u32 m0, s39, 131072
    s_add_u32 s38, s34, 20480
    buffer_load_dwordx4 v1, s[4:7], s38 offen offset:0 lds
    buffer_load_dwordx4 v1, s[4:7], s38 offen offset:1024 lds
    buffer_load_dwordx4 v1, s[4:7], s38 offen offset:2048 lds
    buffer_load_dwordx4 v1, s[4:7], s38 offen offset:3072 lds
    s_waitcnt vmcnt(12)
    s_barrier
    s_lshl_b32 s39, s20, 12
    s_add_u32 m0, s39, 0
    s_add_u32 s38, s35, 3145728
    buffer_load_dwordx4 v16, s[8:11], s38 offen offset:0 lds
    buffer_load_dwordx4 v17, s[8:11], s38 offen offset:1024 lds
    buffer_load_dwordx4 v18, s[8:11], s38 offen offset:2048 lds
    buffer_load_dwordx4 v19, s[8:11], s38 offen offset:3072 lds
    s_add_u32 m0, s39, 16384
    s_add_u32 s38, s33, 24576
    buffer_load_dwordx4 v1, s[4:7], s38 offen offset:0 lds
    buffer_load_dwordx4 v1, s[4:7], s38 offen offset:1024 lds
    buffer_load_dwordx4 v1, s[4:7], s38 offen offset:2048 lds
    buffer_load_dwordx4 v1, s[4:7], s38 offen offset:3072 lds
    s_add_u32 m0, s39, 32768
    s_add_u32 s38, s34, 24576
    buffer_load_dwordx4 v1, s[4:7], s38 offen offset:0 lds
    buffer_load_dwordx4 v1, s[4:7], s38 offen offset:1024 lds
    buffer_load_dwordx4 v1, s[4:7], s38 offen offset:2048 lds
    buffer_load_dwordx4 v1, s[4:7], s38 offen offset:3072 lds
    s_waitcnt vmcnt(12)
    s_barrier
    s_cmp_lg_u32 s20, 0
    s_cbranch_scc1 attn_kernel_w418
    s_mov_b64 exec, 1
    s_lshl_b32 s38, s21, 8
    s_add_u32 s38, s38, 20736
    v_mov_b32 v30, s38
    v_mov_b32 v31, 1
    buffer_atomic_add v31, v30, s[72:75], 0 offen sc1
    s_mov_b64 exec, -1
attn_kernel_w418:
    s_lshl_b32 s39, s20, 12
    s_add_u32 m0, s39, 49152
    s_add_u32 s38, s35, 3670016
    buffer_load_dwordx4 v16, s[8:11], s38 offen offset:0 lds
    buffer_load_dwordx4 v17, s[8:11], s38 offen offset:1024 lds
    buffer_load_dwordx4 v18, s[8:11], s38 offen offset:2048 lds
    buffer_load_dwordx4 v19, s[8:11], s38 offen offset:3072 lds
    s_add_u32 m0, s39, 65536
    s_add_u32 s38, s33, 28672
    buffer_load_dwordx4 v1, s[4:7], s38 offen offset:0 lds
    buffer_load_dwordx4 v1, s[4:7], s38 offen offset:1024 lds
    buffer_load_dwordx4 v1, s[4:7], s38 offen offset:2048 lds
    buffer_load_dwordx4 v1, s[4:7], s38 offen offset:3072 lds
    s_add_u32 m0, s39, 81920
    s_add_u32 s38, s34, 28672
    buffer_load_dwordx4 v1, s[4:7], s38 offen offset:0 lds
    buffer_load_dwordx4 v1, s[4:7], s38 offen offset:1024 lds
    buffer_load_dwordx4 v1, s[4:7], s38 offen offset:2048 lds
    buffer_load_dwordx4 v1, s[4:7], s38 offen offset:3072 lds
    s_waitcnt vmcnt(12)
    s_barrier
    s_cmp_lg_u32 s20, 0
    s_cbranch_scc1 attn_kernel_w419
    s_mov_b64 exec, 1
    s_lshl_b32 s38, s21, 8
    s_add_u32 s38, s38, 20736
    v_mov_b32 v30, s38
    buffer_load_dword v40, v30, s[72:75], 0 offen sc0 sc1
    s_waitcnt vmcnt(0)
    s_mov_b32 s39, 0
attn_kernel_pp20:
    v_readfirstlane_b32 s38, v40
    s_cmp_ge_u32 s38, 8
    s_cbranch_scc1 attn_kernel_pd21
    s_add_u32 s39, s39, 1
    s_cmp_gt_u32 s39, 60000
    s_cbranch_scc1 attn_kernel_pd21
    s_sleep 8
    s_lshl_b32 s38, s21, 8
    s_add_u32 s38, s38, 20736
    v_mov_b32 v30, s38
    buffer_load_dword v40, v30, s[72:75], 0 offen sc0 sc1
    s_waitcnt vmcnt(0)
    s_branch attn_kernel_pp20
attn_kernel_pd21:
    s_mov_b64 exec, -1
attn_kernel_w419:
    s_add_u32 s38, s25, s32
    s_add_u32 m0, s38, 0
    s_nop 0
    buffer_load_dwordx4 v4, s[12:15], s24 offen offset:0 lds
    buffer_load_dwordx4 v4, s[12:15], s24 offen offset:1024 lds
    buffer_load_dwordx4 v4, s[12:15], s24 offen offset:2048 lds
    buffer_load_dwordx4 v4, s[12:15], s24 offen offset:3072 lds
    s_add_u32 s38, s25, s32
    s_add_u32 m0, s38, 4096
    s_nop 0
    buffer_load_dwordx4 v5, s[12:15], s24 offen offset:0 lds
    buffer_load_dwordx4 v5, s[12:15], s24 offen offset:1024 lds
    buffer_load_dwordx4 v5, s[12:15], s24 offen offset:2048 lds
    buffer_load_dwordx4 v5, s[12:15], s24 offen offset:3072 lds
    s_add_u32 s24, s24, 32768
    s_sub_u32 s28, s28, 1
    s_cmp_eq_u32 s28, 0
    s_cselect_b32 s24, 0, s24
    s_add_u32 s25, s25, 32768
    s_cmp_eq_u32 s25, 163840
    s_cselect_b32 s25, 0, s25
    s_add_u32 s38, s25, s32
    s_add_u32 m0, s38, 0
    s_nop 0
    buffer_load_dwordx4 v4, s[12:15], s24 offen offset:0 lds
    buffer_load_dwordx4 v4, s[12:15], s24 offen offset:1024 lds
    buffer_load_dwordx4 v4, s[12:15], s24 offen offset:2048 lds
    buffer_load_dwordx4 v4, s[12:15], s24 offen offset:3072 lds
    s_add_u32 s38, s25, s32
    s_add_u32 m0, s38, 4096
    s_nop 0
    buffer_load_dwordx4 v5, s[12:15], s24 offen offset:0 lds
    buffer_load_dwordx4 v5, s[12:15], s24 offen offset:1024 lds
    buffer_load_dwordx4 v5, s[12:15], s24 offen offset:2048 lds
    buffer_load_dwordx4 v5, s[12:15], s24 offen offset:3072 lds
    s_add_u32 s24, s24, 32768
    s_sub_u32 s28, s28, 1
    s_cmp_eq_u32 s28, 0
    s_cselect_b32 s24, 0, s24
    s_add_u32 s25, s25, 32768
    s_cmp_eq_u32 s25, 163840
    s_cselect_b32 s25, 0, s25
    s_waitcnt vmcnt(16)
    s_barrier
    s_add_u32 s38, s25, s32
    s_add_u32 m0, s38, 0
    s_nop 0
    buffer_load_dwordx4 v4, s[12:15], s24 offen offset:0 lds
    buffer_load_dwordx4 v4, s[12:15], s24 offen offset:1024 lds
    buffer_load_dwordx4 v4, s[12:15], s24 offen offset:2048 lds
    buffer_load_dwordx4 v4, s[12:15], s24 offen offset:3072 lds
    s_add_u32 s38, s25, s32
    s_add_u32 m0, s38, 4096
    s_nop 0
    buffer_load_dwordx4 v5, s[12:15], s24 offen offset:0 lds
    buffer_load_dwordx4 v5, s[12:15], s24 offen offset:1024 lds
    buffer_load_dwordx4 v5, s[12:15], s24 offen offset:2048 lds
    buffer_load_dwordx4 v5, s[12:15], s24 offen offset:3072 lds
    s_add_u32 s24, s24, 32768
    s_sub_u32 s28, s28, 1
    s_cmp_eq_u32 s28, 0
    s_cselect_b32 s24, 0, s24
    s_add_u32 s25, s25, 32768
    s_cmp_eq_u32 s25, 163840
    s_cselect_b32 s25, 0, s25
    s_waitcnt vmcnt(16)
    s_barrier
    s_mov_b32 s29, 24
    s_waitcnt vmcnt(8)
    s_barrier
    s_add_u32 s38, s25, s32
    s_add_u32 m0, s38, 0
    s_nop 0
    buffer_load_dwordx4 v4, s[12:15], s24 offen offset:0 lds
    buffer_load_dwordx4 v4, s[12:15], s24 offen offset:1024 lds
    buffer_load_dwordx4 v4, s[12:15], s24 offen offset:2048 lds
    buffer_load_dwordx4 v4, s[12:15], s24 offen offset:3072 lds
    s_add_u32 s38, s25, s32
    s_add_u32 m0, s38, 4096
    s_nop 0
    buffer_load_dwordx4 v5, s[12:15], s24 offen offset:0 lds
    buffer_load_dwordx4 v5, s[12:15], s24 offen offset:1024 lds
    buffer_load_dwordx4 v5, s[12:15], s24 offen offset:2048 lds
    buffer_load_dwordx4 v5, s[12:15], s24 offen offset:3072 lds
    s_add_u32 s24, s24, 32768
    s_sub_u32 s28, s28, 1
    s_cmp_eq_u32 s28, 0
    s_cselect_b32 s24, 0, s24
    s_add_u32 s25, s25, 32768
    s_cmp_eq_u32 s25, 163840
    s_cselect_b32 s25, 0, s25
    s_load_dwordx2 s[62:63], s[0:1], 40
    s_load_dwordx2 s[64:65], s[0:1], 56
    s_load_dwordx2 s[66:67], s[0:1], 64
    s_load_dwordx2 s[68:69], s[0:1], 104
    s_load_dwordx2 s[70:71], s[0:1], 88
    s_and_b32 s60, s2, 7
    s_lshl_b32 s60, s60, 1
    s_lshr_b32 s61, s2, 3
    s_and_b32 s38, s61, 1
    s_add_u32 s60, s60, s38
    s_lshr_b32 s61, s61, 1
    s_lshr_b32 s51, s2, 1
    s_and_b32 s51, s51, 3
    s_lshl_b32 s51, s51, 2
    s_lshr_b32 s38, s2, 3
    s_and_b32 s38, s38, 3
    s_add_u32 s51, s51, s38
    s_waitcnt lgkmcnt(0)
    s_waitcnt vmcnt(8)
    s_barrier
    s_lshl_b32 s39, s2, 2
    s_add_u32 s39, s39, s20
    s_lshl_b32 s49, s39, 12
    s_mov_b32 s44, s62
    s_mov_b32 s45, s63
    s_mov_b32 s46, 4194304
    s_mov_b32 s47, 0x00020000
    v_mul_u32_u24 v28, 64, v0
    s_add_u32 s38, s49, 0
    buffer_load_dword v29, v28, s[44:47], s38 offen
    s_mul_i32 s49, s39, 1792
    s_mov_b32 s44, s64
    s_mov_b32 s45, s65
    s_mov_b32 s46, 1835008
    s_mov_b32 s47, 0x00020000
    v_mul_u32_u24 v28, 64, v0
    s_add_u32 s38, s49, 0
    buffer_load_dword v29, v28, s[44:47], s38 offen
    s_mov_b32 s44, s66
    s_mov_b32 s45, s67
    s_mov_b32 s46, 1835008
    s_mov_b32 s47, 0x00020000
    v_mul_u32_u24 v28, 64, v0
    s_add_u32 s38, s49, 0
    buffer_load_dword v29, v28, s[44:47], s38 offen
    s_add_u32 s38, s25, s32
    s_add_u32 m0, s38, 0
    s_nop 0
    buffer_load_dwordx4 v4, s[12:15], s24 offen offset:0 lds
    buffer_load_dwordx4 v4, s[12:15], s24 offen offset:1024 lds
    buffer_load_dwordx4 v4, s[12:15], s24 offen offset:2048 lds
    buffer_load_dwordx4 v4, s[12:15], s24 offen offset:3072 lds
    s_add_u32 s38, s25, s32
    s_add_u32 m0, s38, 4096
    s_nop 0
    buffer_load_dwordx4 v5, s[12:15], s24 offen offset:0 lds
    buffer_load_dwordx4 v5, s[12:15], s24 offen offset:1024 lds
    buffer_load_dwordx4 v5, s[12:15], s24 offen offset:2048 lds
    buffer_load_dwordx4 v5, s[12:15], s24 offen offset:3072 lds
    s_add_u32 s24, s24, 32768
    s_sub_u32 s28, s28, 1
    s_cmp_eq_u32 s28, 0
    s_cselect_b32 s24, 0, s24
    s_add_u32 s25, s25, 32768
    s_cmp_eq_u32 s25, 163840
    s_cselect_b32 s25, 0, s25
    s_waitcnt vmcnt(11)
    s_barrier
    s_add_u32 s38, s25, s32
    s_add_u32 m0, s38, 0
    s_nop 0
    buffer_load_dwordx4 v4, s[12:15], s24 offen offset:0 lds
    buffer_load_dwordx4 v4, s[12:15], s24 offen offset:1024 lds
    buffer_load_dwordx4 v4, s[12:15], s24 offen offset:2048 lds
    buffer_load_dwordx4 v4, s[12:15], s24 offen offset:3072 lds
    s_add_u32 s38, s25, s32
    s_add_u32 m0, s38, 4096
    s_nop 0
    buffer_load_dwordx4 v5, s[12:15], s24 offen offset:0 lds
    buffer_load_dwordx4 v5, s[12:15], s24 offen offset:1024 lds
    buffer_load_dwordx4 v5, s[12:15], s24 offen offset:2048 lds
    buffer_load_dwordx4 v5, s[12:15], s24 offen offset:3072 lds
    s_add_u32 s24, s24, 32768
    s_sub_u32 s28, s28, 1
    s_cmp_eq_u32 s28, 0
    s_cselect_b32 s24, 0, s24
    s_add_u32 s25, s25, 32768
    s_cmp_eq_u32 s25, 163840
    s_cselect_b32 s25, 0, s25
    s_add_u32 s72, s68, 100663296
    s_addc_u32 s73, s69, 0
    s_mov_b32 s74, 16384
    s_mov_b32 s75, 0x00020000
    s_lshl_b32 s52, s20, 12
    s_mov_b32 s4, s62
    s_mov_b32 s5, s63
    s_mov_b32 s6, 4194304
    s_mov_b32 s7, 0x00020000
    s_add_u32 s8, s68, 50331648
    s_addc_u32 s9, s69, 0
    s_mov_b32 s10, 16777216
    s_mov_b32 s11, 0x00020000
    s_mov_b32 s46, s51
    s_lshr_b32 s47, s2, 5
    s_and_b32 s47, s47, 3
    s_and_b32 s48, s2, 1
    s_lshl_b32 s48, s48, 1
    s_lshr_b32 s38, s2, 7
    s_add_u32 s48, s48, s38
    s_lshl_b32 s48, s48, 10
    v_lshrrev_b32 v9, 4, v0
    v_and_b32 v10, 15, v0
    v_lshlrev_b32 v11, 2, v9
    v_xor_b32 v11, v11, v10
    v_lshlrev_b32 v11, 4, v11
    s_mov_b32 s36, 1024
    v_mul_lo_u32 v12, v9, s36
    v_add_u32 v16, v11, v12
    v_add_u32 v17, 3072, v16
    v_add_u32 v18, 6144, v16
    v_add_u32 v19, 9216, v16
    s_lshl_b32 s37, s20, 4
    s_add_u32 s37, s37, s48
    s_mul_i32 s54, s37, 1024
    s_lshl_b32 s37, s47, 8
    s_add_u32 s54, s54, s37
    s_lshl_b32 s37, s46, 2
    s_add_u32 s37, s37, s20
    s_mul_i32 s55, s37, 262144
    s_lshl_b32 s37, s48, 6
    s_add_u32 s55, s55, s37
at_ld_loop:
    s_waitcnt vmcnt(8)
    s_barrier
    s_add_u32 s38, s25, s32
    s_add_u32 m0, s38, 0
    s_nop 0
    buffer_load_dwordx4 v4, s[12:15], s24 offen offset:0 lds
    buffer_load_dwordx4 v4, s[12:15], s24 offen offset:1024 lds
    buffer_load_dwordx4 v4, s[12:15], s24 offen offset:2048 lds
    buffer_load_dwordx4 v4, s[12:15], s24 offen offset:3072 lds
    s_add_u32 s38, s25, s32
    s_add_u32 m0, s38, 4096
    s_nop 0
    buffer_load_dwordx4 v5, s[12:15], s24 offen offset:0 lds
    buffer_load_dwordx4 v5, s[12:15], s24 offen offset:1024 lds
    buffer_load_dwordx4 v5, s[12:15], s24 offen offset:2048 lds
    buffer_load_dwordx4 v5, s[12:15], s24 offen offset:3072 lds
    s_add_u32 s24, s24, 32768
    s_sub_u32 s28, s28, 1
    s_cmp_eq_u32 s28, 0
    s_cselect_b32 s24, 0, s24
    s_add_u32 s25, s25, 32768
    s_cmp_eq_u32 s25, 163840
    s_cselect_b32 s25, 0, s25
    s_sub_u32 s29, s29, 1
    s_cmp_lg_u32 s29, 0
    s_cbranch_scc1 at_ld_loop
    s_waitcnt vmcnt(8)
    s_barrier
    s_cmp_lg_u32 s20, 0
    s_cbranch_scc1 attn_kernel_w422
    s_mov_b64 exec, 1
    v_mov_b32 v30, 128
    buffer_load_dword v40, v30, s[76:79], 0 offen sc0 sc1
    s_waitcnt vmcnt(0)
    s_mov_b32 s39, 0
attn_kernel_pp23:
    v_readfirstlane_b32 s38, v40
    s_cmp_ge_u32 s38, 128
    s_cbranch_scc1 attn_kernel_pd24
    s_add_u32 s39, s39, 1
    s_cmp_gt_u32 s39, 60000
    s_cbranch_scc1 attn_kernel_pd24
    s_sleep 8
    v_mov_b32 v30, 128
    buffer_load_dword v40, v30, s[76:79], 0 offen sc0 sc1
    s_waitcnt vmcnt(0)
    s_branch attn_kernel_pp23
attn_kernel_pd24:
    s_mov_b64 exec, -1
attn_kernel_w422:
    s_and_b32 s49, s2, 1
    s_lshl_b32 s49, s49, 21
    s_lshr_b32 s39, s2, 3
    s_lshl_b32 s39, s39, 16
    s_add_u32 s49, s49, s39
    s_lshl_b32 s39, s20, 14
    s_add_u32 s49, s49, s39
    s_mov_b32 s44, s62
    s_mov_b32 s45, s63
    s_mov_b32 s46, 4194304
    s_mov_b32 s47, 0x00020000
    v_mul_u32_u24 v28, 64, v0
    s_add_u32 s38, s49, 0
    buffer_load_dword v29, v28, s[44:47], s38 offen
    s_add_u32 s38, s49, 4096
    buffer_load_dword v29, v28, s[44:47], s38 offen
    s_add_u32 s38, s49, 8192
    buffer_load_dword v29, v28, s[44:47], s38 offen
    s_add_u32 s38, s49, 12288
    buffer_load_dword v29, v28, s[44:47], s38 offen
    s_add_u32 s38, s25, s32
    s_add_u32 m0, s38, 0
    s_nop 0
    buffer_load_dwordx4 v4, s[12:15], s24 offen offset:0 lds
    buffer_load_dwordx4 v4, s[12:15], s24 offen offset:1024 lds
    buffer_load_dwordx4 v4, s[12:15], s24 offen offset:2048 lds
    buffer_load_dwordx4 v4, s[12:15], s24 offen offset:3072 lds
    s_add_u32 s38, s25, s32
    s_add_u32 m0, s38, 4096
    s_nop 0
    buffer_load_dwordx4 v5, s[12:15], s24 offen offset:0 lds
    buffer_load_dwordx4 v5, s[12:15], s24 offen offset:1024 lds
    buffer_load_dwordx4 v5, s[12:15], s24 offen offset:2048 lds
    buffer_load_dwordx4 v5, s[12:15], s24 offen offset:3072 lds
    s_add_u32 s24, s24, 32768
    s_sub_u32 s28, s28, 1
    s_cmp_eq_u32 s28, 0
    s_cselect_b32 s24, 0, s24
    s_add_u32 s25, s25, 32768
    s_cmp_eq_u32 s25, 163840
    s_cselect_b32 s25, 0, s25
    s_waitcnt vmcnt(12)
    s_barrier
    s_add_u32 s38, s25, s32
    s_add_u32 m0, s38, 0
    s_nop 0
    buffer_load_dwordx4 v4, s[12:15], s24 offen offset:0 lds
    buffer_load_dwordx4 v4, s[12:15], s24 offen offset:1024 lds
    buffer_load_dwordx4 v4, s[12:15], s24 offen offset:2048 lds
    buffer_load_dwordx4 v4, s[12:15], s24 offen offset:3072 lds
    s_add_u32 s38, s25, s32
    s_add_u32 m0, s38, 4096
    s_nop 0
    buffer_load_dwordx4 v5, s[12:15], s24 offen offset:0 lds
    buffer_load_dwordx4 v5, s[12:15], s24 offen offset:1024 lds
    buffer_load_dwordx4 v5, s[12:15], s24 offen offset:2048 lds
    buffer_load_dwordx4 v5, s[12:15], s24 offen offset:3072 lds
    s_add_u32 s24, s24, 32768
    s_sub_u32 s28, s28, 1
    s_cmp_eq_u32 s28, 0
    s_cselect_b32 s24, 0, s24
    s_add_u32 s25, s25, 32768
    s_cmp_eq_u32 s25, 163840
    s_cselect_b32 s25, 0, s25
    s_waitcnt vmcnt(8)
    s_barrier
    s_add_u32 s38, s25, s32
    s_add_u32 m0, s38, 0
    s_nop 0
    buffer_load_dwordx4 v4, s[12:15], s24 offen offset:0 lds
    buffer_load_dwordx4 v4, s[12:15], s24 offen offset:1024 lds
    buffer_load_dwordx4 v4, s[12:15], s24 offen offset:2048 lds
    buffer_load_dwordx4 v4, s[12:15], s24 offen offset:3072 lds
    s_add_u32 s38, s25, s32
    s_add_u32 m0, s38, 4096
    s_nop 0
    buffer_load_dwordx4 v5, s[12:15], s24 offen offset:0 lds
    buffer_load_dwordx4 v5, s[12:15], s24 offen offset:1024 lds
    buffer_load_dwordx4 v5, s[12:15], s24 offen offset:2048 lds
    buffer_load_dwordx4 v5, s[12:15], s24 offen offset:3072 lds
    s_add_u32 s24, s24, 32768
    s_sub_u32 s28, s28, 1
    s_cmp_eq_u32 s28, 0
    s_cselect_b32 s24, 0, s24
    s_add_u32 s25, s25, 32768
    s_cmp_eq_u32 s25, 163840
    s_cselect_b32 s25, 0, s25
    s_waitcnt vmcnt(8)
    s_barrier
    s_add_u32 s38, s25, s32
    s_add_u32 m0, s38, 0
    s_nop 0
    buffer_load_dwordx4 v4, s[12:15], s24 offen offset:0 lds
    buffer_load_dwordx4 v4, s[12:15], s24 offen offset:1024 lds
    buffer_load_dwordx4 v4, s[12:15], s24 offen offset:2048 lds
    buffer_load_dwordx4 v4, s[12:15], s24 offen offset:3072 lds
    s_add_u32 s38, s25, s32
    s_add_u32 m0, s38, 4096
    s_nop 0
    buffer_load_dwordx4 v5, s[12:15], s24 offen offset:0 lds
    buffer_load_dwordx4 v5, s[12:15], s24 offen offset:1024 lds
    buffer_load_dwordx4 v5, s[12:15], s24 offen offset:2048 lds
    buffer_load_dwordx4 v5, s[12:15], s24 offen offset:3072 lds
    s_add_u32 s24, s24, 32768
    s_sub_u32 s28, s28, 1
    s_cmp_eq_u32 s28, 0
    s_cselect_b32 s24, 0, s24
    s_add_u32 s25, s25, 32768
    s_cmp_eq_u32 s25, 163840
    s_cselect_b32 s25, 0, s25
    s_waitcnt vmcnt(8)
    s_barrier
    s_add_u32 m0, s52, 65536
    s_nop 0
    buffer_load_dwordx4 v16, s[4:7], s54 offen offset:0 lds
    buffer_load_dwordx4 v17, s[4:7], s54 offen offset:1024 lds
    buffer_load_dwordx4 v18, s[4:7], s54 offen offset:2048 lds
    buffer_load_dwordx4 v19, s[4:7], s54 offen offset:3072 lds
    s_add_u32 s54, s54, 65536
    s_waitcnt vmcnt(4)
    s_barrier
    s_add_u32 m0, s52, 98304
    s_nop 0
    buffer_load_dwordx4 v16, s[4:7], s54 offen offset:0 lds
    buffer_load_dwordx4 v17, s[4:7], s54 offen offset:1024 lds
    buffer_load_dwordx4 v18, s[4:7], s54 offen offset:2048 lds
    buffer_load_dwordx4 v19, s[4:7], s54 offen offset:3072 lds
    s_add_u32 s54, s54, 65536
    s_barrier
    s_add_u32 m0, s52, 131072
    s_nop 0
    buffer_load_dwordx4 v16, s[4:7], s54 offen offset:0 lds
    buffer_load_dwordx4 v17, s[4:7], s54 offen offset:1024 lds
    buffer_load_dwordx4 v18, s[4:7], s54 offen offset:2048 lds
    buffer_load_dwordx4 v19, s[4:7], s54 offen offset:3072 lds
    s_add_u32 s54, s54, 65536
    s_barrier
    s_add_u32 m0, s52, 0
    s_nop 0
    buffer_load_dwordx4 v16, s[4:7], s54 offen offset:0 lds
    buffer_load_dwordx4 v17, s[4:7], s54 offen offset:1024 lds
    buffer_load_dwordx4 v18, s[4:7], s54 offen offset:2048 lds
    buffer_load_dwordx4 v19, s[4:7], s54 offen offset:3072 lds
    s_add_u32 s54, s54, 65536
    s_cmp_lg_u32 s20, 0
    s_cbranch_scc1 attn_kernel_sy25
    s_mov_b64 exec, 1
    v_mov_b32 v31, 1
    s_lshl_b32 s38, s22, 8
    s_add_u32 s38, s38, 0
    v_mov_b32 v30, s38
    buffer_atomic_add v31, v30, s[72:75], 0 offen sc1
    s_lshl_b32 s38, s23, 8
    s_add_u32 s38, s38, 0
    v_mov_b32 v30, s38
    buffer_atomic_add v31, v30, s[72:75], 0 offen sc1
attn_kernel_na28:
    s_lshl_b32 s38, s51, 8
    s_add_u32 s38, s38, 0
    v_mov_b32 v30, s38
    s_mov_b32 s39, 0
attn_kernel_po26:
    buffer_load_dword v29, v30, s[72:75], 0 offen sc0 sc1
    s_add_u32 s39, s39, 1
    s_waitcnt vmcnt(0)
    v_readfirstlane_b32 s38, v29
    s_cmp_ge_u32 s38, 32
    s_cbranch_scc1 attn_kernel_dn27
    s_cmp_lt_u32 s39, 60000
    s_cbranch_scc1 attn_kernel_po26
attn_kernel_dn27:
    s_mov_b64 exec, -1
attn_kernel_sy25:
    s_barrier
    s_mov_b32 s80, s64
    s_mov_b32 s81, s65
    s_mov_b32 s82, 1835008
    s_mov_b32 s83, 0x00020000
    s_add_u32 s84, s68, 88080384
    s_addc_u32 s85, s69, 0
    s_mov_b32 s86, 2097152
    s_mov_b32 s87, 0x00020000
    s_mov_b32 s46, s60
    s_min_u32 s47, s61, 13
    s_mov_b32 s48, 0
    v_lshrrev_b32 v9, 4, v0
    v_and_b32 v10, 15, v0
    v_lshlrev_b32 v11, 2, v9
    v_xor_b32 v11, v11, v10
    v_lshlrev_b32 v11, 4, v11
    s_mov_b32 s36, 3584
    v_mul_lo_u32 v12, v9, s36
    v_add_u32 v20, v11, v12
    v_add_u32 v21, 13312, v20
    v_add_u32 v22, 26624, v20
    v_add_u32 v23, 39936, v20
    s_lshl_b32 s37, s20, 4
    s_add_u32 s37, s37, s48
    s_mul_i32 s56, s37, 3584
    s_lshl_b32 s37, s47, 8
    s_add_u32 s56, s56, s37
    s_lshl_b32 s37, s46, 2
    s_add_u32 s37, s37, s20
    s_mul_i32 s57, s37, 32768
    s_lshl_b32 s37, s48, 6
    s_add_u32 s57, s57, s37
    s_add_u32 m0, s52, 81920
    s_nop 0
    buffer_load_dwordx4 v1, s[8:11], s55 offen offset:0 lds
    buffer_load_dwordx4 v1, s[8:11], s55 offen offset:1024 lds
    buffer_load_dwordx4 v1, s[8:11], s55 offen offset:2048 lds
    buffer_load_dwordx4 v1, s[8:11], s55 offen offset:3072 lds
    s_add_u32 s55, s55, 4096
    s_add_u32 m0, s52, 114688
    s_nop 0
    buffer_load_dwordx4 v1, s[8:11], s55 offen offset:0 lds
    buffer_load_dwordx4 v1, s[8:11], s55 offen offset:1024 lds
    buffer_load_dwordx4 v1, s[8:11], s55 offen offset:2048 lds
    buffer_load_dwordx4 v1, s[8:11], s55 offen offset:3072 lds
    s_add_u32 s55, s55, 4096
    s_add_u32 m0, s52, 147456
    s_nop 0
    buffer_load_dwordx4 v1, s[8:11], s55 offen offset:0 lds
    buffer_load_dwordx4 v1, s[8:11], s55 offen offset:1024 lds
    buffer_load_dwordx4 v1, s[8:11], s55 offen offset:2048 lds
    buffer_load_dwordx4 v1, s[8:11], s55 offen offset:3072 lds
    s_add_u32 s55, s55, 4096
    s_add_u32 m0, s52, 16384
    s_nop 0
    buffer_load_dwordx4 v1, s[8:11], s55 offen offset:0 lds
    buffer_load_dwordx4 v1, s[8:11], s55 offen offset:1024 lds
    buffer_load_dwordx4 v1, s[8:11], s55 offen offset:2048 lds
    buffer_load_dwordx4 v1, s[8:11], s55 offen offset:3072 lds
    s_add_u32 s55, s55, 4096
    s_waitcnt vmcnt(12)
    s_barrier
    s_waitcnt vmcnt(8)
    s_barrier
    s_add_u32 m0, s52, 32768
    s_nop 0
    buffer_load_dwordx4 v16, s[4:7], s54 offen offset:0 lds
    buffer_load_dwordx4 v17, s[4:7], s54 offen offset:1024 lds
    buffer_load_dwordx4 v18, s[4:7], s54 offen offset:2048 lds
    buffer_load_dwordx4 v19, s[4:7], s54 offen offset:3072 lds
    s_add_u32 s54, s54, 65536
    s_add_u32 m0, s52, 49152
    s_nop 0
    buffer_load_dwordx4 v1, s[8:11], s55 offen offset:0 lds
    buffer_load_dwordx4 v1, s[8:11], s55 offen offset:1024 lds
    buffer_load_dwordx4 v1, s[8:11], s55 offen offset:2048 lds
    buffer_load_dwordx4 v1, s[8:11], s55 offen offset:3072 lds
    s_add_u32 s55, s55, 4096
    s_waitcnt vmcnt(12)
    s_barrier
    s_add_u32 m0, s52, 65536
    s_nop 0
    buffer_load_dwordx4 v16, s[4:7], s54 offen offset:0 lds
    buffer_load_dwordx4 v17, s[4:7], s54 offen offset:1024 lds
    buffer_load_dwordx4 v18, s[4:7], s54 offen offset:2048 lds
    buffer_load_dwordx4 v19, s[4:7], s54 offen offset:3072 lds
    s_add_u32 s54, s54, 65536
    s_add_u32 m0, s52, 81920
    s_nop 0
    buffer_load_dwordx4 v1, s[8:11], s55 offen offset:0 lds
    buffer_load_dwordx4 v1, s[8:11], s55 offen offset:1024 lds
    buffer_load_dwordx4 v1, s[8:11], s55 offen offset:2048 lds
    buffer_load_dwordx4 v1, s[8:11], s55 offen offset:3072 lds
    s_add_u32 s55, s55, 4096
    s_waitcnt vmcnt(16)
    s_barrier
    s_add_u32 m0, s52, 98304
    s_nop 0
    buffer_load_dwordx4 v16, s[4:7], s54 offen offset:0 lds
    buffer_load_dwordx4 v17, s[4:7], s54 offen offset:1024 lds
    buffer_load_dwordx4 v18, s[4:7], s54 offen offset:2048 lds
    buffer_load_dwordx4 v19, s[4:7], s54 offen offset:3072 lds
    s_add_u32 s54, s54, 65536
    s_add_u32 m0, s52, 114688
    s_nop 0
    buffer_load_dwordx4 v1, s[8:11], s55 offen offset:0 lds
    buffer_load_dwordx4 v1, s[8:11], s55 offen offset:1024 lds
    buffer_load_dwordx4 v1, s[8:11], s55 offen offset:2048 lds
    buffer_load_dwordx4 v1, s[8:11], s55 offen offset:3072 lds
    s_add_u32 s55, s55, 4096
    s_waitcnt vmcnt(16)
    s_barrier
    s_add_u32 m0, s52, 131072
    s_nop 0
    buffer_load_dwordx4 v16, s[4:7], s54 offen offset:0 lds
    buffer_load_dwordx4 v17, s[4:7], s54 offen offset:1024 lds
    buffer_load_dwordx4 v18, s[4:7], s54 offen offset:2048 lds
    buffer_load_dwordx4 v19, s[4:7], s54 offen offset:3072 lds
    s_add_u32 s54, s54, 65536
    s_add_u32 m0, s52, 147456
    s_nop 0
    buffer_load_dwordx4 v1, s[8:11], s55 offen offset:0 lds
    buffer_load_dwordx4 v1, s[8:11], s55 offen offset:1024 lds
    buffer_load_dwordx4 v1, s[8:11], s55 offen offset:2048 lds
    buffer_load_dwordx4 v1, s[8:11], s55 offen offset:3072 lds
    s_add_u32 s55, s55, 4096
    s_waitcnt vmcnt(16)
    s_barrier
    s_add_u32 m0, s52, 0
    s_nop 0
    buffer_load_dwordx4 v16, s[4:7], s54 offen offset:0 lds
    buffer_load_dwordx4 v17, s[4:7], s54 offen offset:1024 lds
    buffer_load_dwordx4 v18, s[4:7], s54 offen offset:2048 lds
    buffer_load_dwordx4 v19, s[4:7], s54 offen offset:3072 lds
    s_add_u32 s54, s54, 65536
    s_add_u32 m0, s52, 16384
    s_nop 0
    buffer_load_dwordx4 v1, s[8:11], s55 offen offset:0 lds
    buffer_load_dwordx4 v1, s[8:11], s55 offen offset:1024 lds
    buffer_load_dwordx4 v1, s[8:11], s55 offen offset:2048 lds
    buffer_load_dwordx4 v1, s[8:11], s55 offen offset:3072 lds
    s_add_u32 s55, s55, 4096
    s_waitcnt vmcnt(16)
    s_barrier
    s_add_u32 m0, s52, 32768
    s_nop 0
    buffer_load_dwordx4 v16, s[4:7], s54 offen offset:0 lds
    buffer_load_dwordx4 v17, s[4:7], s54 offen offset:1024 lds
    buffer_load_dwordx4 v18, s[4:7], s54 offen offset:2048 lds
    buffer_load_dwordx4 v19, s[4:7], s54 offen offset:3072 lds
    s_add_u32 s54, s54, 65536
    s_add_u32 m0, s52, 49152
    s_nop 0
    buffer_load_dwordx4 v1, s[8:11], s55 offen offset:0 lds
    buffer_load_dwordx4 v1, s[8:11], s55 offen offset:1024 lds
    buffer_load_dwordx4 v1, s[8:11], s55 offen offset:2048 lds
    buffer_load_dwordx4 v1, s[8:11], s55 offen offset:3072 lds
    s_add_u32 s55, s55, 4096
    s_waitcnt vmcnt(16)
    s_barrier
    s_add_u32 m0, s52, 65536
    s_nop 0
    buffer_load_dwordx4 v16, s[4:7], s54 offen offset:0 lds
    buffer_load_dwordx4 v17, s[4:7], s54 offen offset:1024 lds
    buffer_load_dwordx4 v18, s[4:7], s54 offen offset:2048 lds
    buffer_load_dwordx4 v19, s[4:7], s54 offen offset:3072 lds
    s_add_u32 s54, s54, 65536
    s_add_u32 m0, s52, 81920
    s_nop 0
    buffer_load_dwordx4 v1, s[8:11], s55 offen offset:0 lds
    buffer_load_dwordx4 v1, s[8:11], s55 offen offset:1024 lds
    buffer_load_dwordx4 v1, s[8:11], s55 offen offset:2048 lds
    buffer_load_dwordx4 v1, s[8:11], s55 offen offset:3072 lds
    s_add_u32 s55, s55, 4096
    s_waitcnt vmcnt(16)
    s_barrier
    s_add_u32 m0, s52, 98304
    s_nop 0
    buffer_load_dwordx4 v16, s[4:7], s54 offen offset:0 lds
    buffer_load_dwordx4 v17, s[4:7], s54 offen offset:1024 lds
    buffer_load_dwordx4 v18, s[4:7], s54 offen offset:2048 lds
    buffer_load_dwordx4 v19, s[4:7], s54 offen offset:3072 lds
    s_add_u32 s54, s54, 65536
    s_add_u32 m0, s52, 114688
    s_nop 0
    buffer_load_dwordx4 v1, s[8:11], s55 offen offset:0 lds
    buffer_load_dwordx4 v1, s[8:11], s55 offen offset:1024 lds
    buffer_load_dwordx4 v1, s[8:11], s55 offen offset:2048 lds
    buffer_load_dwordx4 v1, s[8:11], s55 offen offset:3072 lds
    s_add_u32 s55, s55, 4096
    s_waitcnt vmcnt(16)
    s_barrier
    s_add_u32 m0, s52, 131072
    s_nop 0
    buffer_load_dwordx4 v16, s[4:7], s54 offen offset:0 lds
    buffer_load_dwordx4 v17, s[4:7], s54 offen offset:1024 lds
    buffer_load_dwordx4 v18, s[4:7], s54 offen offset:2048 lds
    buffer_load_dwordx4 v19, s[4:7], s54 offen offset:3072 lds
    s_add_u32 s54, s54, 65536
    s_add_u32 m0, s52, 147456
    s_nop 0
    buffer_load_dwordx4 v1, s[8:11], s55 offen offset:0 lds
    buffer_load_dwordx4 v1, s[8:11], s55 offen offset:1024 lds
    buffer_load_dwordx4 v1, s[8:11], s55 offen offset:2048 lds
    buffer_load_dwordx4 v1, s[8:11], s55 offen offset:3072 lds
    s_add_u32 s55, s55, 4096
    s_waitcnt vmcnt(16)
    s_barrier
    s_add_u32 m0, s52, 0
    s_nop 0
    buffer_load_dwordx4 v16, s[4:7], s54 offen offset:0 lds
    buffer_load_dwordx4 v17, s[4:7], s54 offen offset:1024 lds
    buffer_load_dwordx4 v18, s[4:7], s54 offen offset:2048 lds
    buffer_load_dwordx4 v19, s[4:7], s54 offen offset:3072 lds
    s_add_u32 s54, s54, 65536
    s_add_u32 m0, s52, 16384
    s_nop 0
    buffer_load_dwordx4 v1, s[8:11], s55 offen offset:0 lds
    buffer_load_dwordx4 v1, s[8:11], s55 offen offset:1024 lds
    buffer_load_dwordx4 v1, s[8:11], s55 offen offset:2048 lds
    buffer_load_dwordx4 v1, s[8:11], s55 offen offset:3072 lds
    s_add_u32 s55, s55, 4096
    s_waitcnt vmcnt(16)
    s_barrier
    s_add_u32 m0, s52, 32768
    s_nop 0
    buffer_load_dwordx4 v16, s[4:7], s54 offen offset:0 lds
    buffer_load_dwordx4 v17, s[4:7], s54 offen offset:1024 lds
    buffer_load_dwordx4 v18, s[4:7], s54 offen offset:2048 lds
    buffer_load_dwordx4 v19, s[4:7], s54 offen offset:3072 lds
    s_add_u32 s54, s54, 65536
    s_add_u32 m0, s52, 49152
    s_nop 0
    buffer_load_dwordx4 v1, s[8:11], s55 offen offset:0 lds
    buffer_load_dwordx4 v1, s[8:11], s55 offen offset:1024 lds
    buffer_load_dwordx4 v1, s[8:11], s55 offen offset:2048 lds
    buffer_load_dwordx4 v1, s[8:11], s55 offen offset:3072 lds
    s_add_u32 s55, s55, 4096
    s_waitcnt vmcnt(16)
    s_barrier
    s_add_u32 m0, s52, 65536
    s_nop 0
    buffer_load_dwordx4 v16, s[4:7], s54 offen offset:0 lds
    buffer_load_dwordx4 v17, s[4:7], s54 offen offset:1024 lds
    buffer_load_dwordx4 v18, s[4:7], s54 offen offset:2048 lds
    buffer_load_dwordx4 v19, s[4:7], s54 offen offset:3072 lds
    s_add_u32 s54, s54, 65536
    s_add_u32 m0, s52, 81920
    s_nop 0
    buffer_load_dwordx4 v1, s[8:11], s55 offen offset:0 lds
    buffer_load_dwordx4 v1, s[8:11], s55 offen offset:1024 lds
    buffer_load_dwordx4 v1, s[8:11], s55 offen offset:2048 lds
    buffer_load_dwordx4 v1, s[8:11], s55 offen offset:3072 lds
    s_add_u32 s55, s55, 4096
    s_waitcnt vmcnt(16)
    s_barrier
    s_add_u32 m0, s52, 98304
    s_nop 0
    buffer_load_dwordx4 v20, s[80:83], s56 offen offset:0 lds
    buffer_load_dwordx4 v21, s[80:83], s56 offen offset:1024 lds
    buffer_load_dwordx4 v22, s[80:83], s56 offen offset:2048 lds
    buffer_load_dwordx4 v23, s[80:83], s56 offen offset:3072 lds
    s_add_u32 s56, s56, 229376
    s_waitcnt vmcnt(12)
    s_barrier
    s_add_u32 m0, s52, 131072
    s_nop 0
    buffer_load_dwordx4 v20, s[80:83], s56 offen offset:0 lds
    buffer_load_dwordx4 v21, s[80:83], s56 offen offset:1024 lds
    buffer_load_dwordx4 v22, s[80:83], s56 offen offset:2048 lds
    buffer_load_dwordx4 v23, s[80:83], s56 offen offset:3072 lds
    s_add_u32 s56, s56, 229376
    s_waitcnt vmcnt(8)
    s_barrier
    s_add_u32 m0, s52, 0
    s_nop 0
    buffer_load_dwordx4 v20, s[80:83], s56 offen offset:0 lds
    buffer_load_dwordx4 v21, s[80:83], s56 offen offset:1024 lds
    buffer_load_dwordx4 v22, s[80:83], s56 offen offset:2048 lds
    buffer_load_dwordx4 v23, s[80:83], s56 offen offset:3072 lds
    s_add_u32 s56, s56, 229376
    s_add_u32 m0, s52, 32768
    s_nop 0
    buffer_load_dwordx4 v20, s[80:83], s56 offen offset:0 lds
    buffer_load_dwordx4 v21, s[80:83], s56 offen offset:1024 lds
    buffer_load_dwordx4 v22, s[80:83], s56 offen offset:2048 lds
    buffer_load_dwordx4 v23, s[80:83], s56 offen offset:3072 lds
    s_add_u32 s56, s56, 229376
    s_barrier
    s_cmp_lg_u32 s20, 0
    s_cbranch_scc1 attn_kernel_sy29
    s_mov_b64 exec, 1
    v_mov_b32 v31, 1
    s_lshl_b32 s38, s51, 8
    s_add_u32 s38, s38, 4096
    v_mov_b32 v30, s38
    buffer_atomic_add v31, v30, s[72:75], 0 offen sc1
attn_kernel_na32:
    s_lshl_b32 s38, s60, 8
    s_add_u32 s38, s38, 4096
    v_mov_b32 v30, s38
    s_mov_b32 s39, 0
attn_kernel_po30:
    buffer_load_dword v29, v30, s[72:75], 0 offen sc0 sc1
    s_add_u32 s39, s39, 1
    s_waitcnt vmcnt(0)
    v_readfirstlane_b32 s38, v29
    s_cmp_ge_u32 s38, 16
    s_cbranch_scc1 attn_kernel_dn31
    s_cmp_lt_u32 s39, 60000
    s_cbranch_scc1 attn_kernel_po30
attn_kernel_dn31:
    s_mov_b64 exec, -1
attn_kernel_sy29:
    s_barrier
    s_mov_b32 s88, s66
    s_mov_b32 s89, s67
    s_mov_b32 s90, 1835008
    s_mov_b32 s91, 0x00020000
    s_add_u32 s92, s68, 92274688
    s_addc_u32 s93, s69, 0
    s_mov_b32 s94, 7340032
    s_mov_b32 s95, 0x00020000
    s_lshl_b32 s46, s60, 1
    s_and_b32 s47, s61, 1
    s_add_u32 s46, s46, s47
    s_lshr_b32 s47, s61, 1
    s_mov_b32 s48, 0
    v_lshrrev_b32 v9, 4, v0
    v_and_b32 v10, 15, v0
    v_lshrrev_b32 v11, 3, v0
    v_and_b32 v12, 7, v0
    v_and_b32 v13, 1, v9
    v_lshlrev_b32 v13, 2, v13
    v_xor_b32 v12, v12, v13
    v_lshlrev_b32 v12, 4, v12
    v_lshl_add_u32 v24, v11, 10, v12
    v_add_u32 v25, 7168, v24
    v_add_u32 v26, 14336, v24
    v_add_u32 v27, 21504, v24
    s_lshl_b32 s37, s20, 5
    s_mul_i32 s58, s37, 1024
    s_lshl_b32 s37, s47, 7
    s_add_u32 s58, s58, s37
    s_lshr_b32 s37, s20, 1
    s_lshl_b32 s38, s46, 1
    s_add_u32 s37, s37, s38
    s_mul_i32 s59, s37, 114688
    s_and_b32 s37, s20, 1
    s_lshl_b32 s37, s37, 12
    s_add_u32 s59, s59, s37
    s_barrier
    s_barrier
    s_barrier
    s_cmp_lg_u32 s20, 0
    s_cbranch_scc1 attn_kernel_sy33
    s_mov_b64 exec, 1
    v_mov_b32 v31, 1
    s_lshl_b32 s38, s60, 8
    s_add_u32 s38, s38, 8192
    v_mov_b32 v30, s38
    buffer_atomic_add v31, v30, s[72:75], 0 offen sc1
attn_kernel_na36:
    s_lshl_b32 s38, s60, 8
    s_add_u32 s38, s38, 8192
    v_mov_b32 v30, s38
    s_mov_b32 s39, 0
attn_kernel_po34:
    buffer_load_dword v29, v30, s[72:75], 0 offen sc0 sc1
    s_add_u32 s39, s39, 1
    s_waitcnt vmcnt(0)
    v_readfirstlane_b32 s38, v29
    s_cmp_ge_u32 s38, 16
    s_cbranch_scc1 attn_kernel_dn35
    s_cmp_lt_u32 s39, 60000
    s_cbranch_scc1 attn_kernel_po34
attn_kernel_dn35:
    s_mov_b64 exec, -1
attn_kernel_sy33:
    s_barrier
    s_add_u32 m0, s52, 114688
    s_nop 0
    buffer_load_dwordx4 v1, s[84:87], s57 offen offset:0 lds
    buffer_load_dwordx4 v1, s[84:87], s57 offen offset:1024 lds
    buffer_load_dwordx4 v1, s[84:87], s57 offen offset:2048 lds
    buffer_load_dwordx4 v1, s[84:87], s57 offen offset:3072 lds
    s_add_u32 s57, s57, 4096
    s_add_u32 m0, s52, 147456
    s_nop 0
    buffer_load_dwordx4 v1, s[84:87], s57 offen offset:0 lds
    buffer_load_dwordx4 v1, s[84:87], s57 offen offset:1024 lds
    buffer_load_dwordx4 v1, s[84:87], s57 offen offset:2048 lds
    buffer_load_dwordx4 v1, s[84:87], s57 offen offset:3072 lds
    s_add_u32 s57, s57, 4096
    s_add_u32 m0, s52, 16384
    s_nop 0
    buffer_load_dwordx4 v1, s[84:87], s57 offen offset:0 lds
    buffer_load_dwordx4 v1, s[84:87], s57 offen offset:1024 lds
    buffer_load_dwordx4 v1, s[84:87], s57 offen offset:2048 lds
    buffer_load_dwordx4 v1, s[84:87], s57 offen offset:3072 lds
    s_add_u32 s57, s57, 4096
    s_add_u32 m0, s52, 49152
    s_nop 0
    buffer_load_dwordx4 v1, s[84:87], s57 offen offset:0 lds
    buffer_load_dwordx4 v1, s[84:87], s57 offen offset:1024 lds
    buffer_load_dwordx4 v1, s[84:87], s57 offen offset:2048 lds
    buffer_load_dwordx4 v1, s[84:87], s57 offen offset:3072 lds
    s_add_u32 s57, s57, 4096
    s_waitcnt vmcnt(12)
    s_barrier
    s_waitcnt vmcnt(8)
    s_barrier
    s_add_u32 m0, s52, 65536
    s_nop 0
    buffer_load_dwordx4 v20, s[80:83], s56 offen offset:0 lds
    buffer_load_dwordx4 v21, s[80:83], s56 offen offset:1024 lds
    buffer_load_dwordx4 v22, s[80:83], s56 offen offset:2048 lds
    buffer_load_dwordx4 v23, s[80:83], s56 offen offset:3072 lds
    s_add_u32 s56, s56, 229376
    s_add_u32 m0, s52, 81920
    s_nop 0
    buffer_load_dwordx4 v1, s[84:87], s57 offen offset:0 lds
    buffer_load_dwordx4 v1, s[84:87], s57 offen offset:1024 lds
    buffer_load_dwordx4 v1, s[84:87], s57 offen offset:2048 lds
    buffer_load_dwordx4 v1, s[84:87], s57 offen offset:3072 lds
    s_add_u32 s57, s57, 4096
    s_waitcnt vmcnt(12)
    s_barrier
    s_add_u32 m0, s52, 98304
    s_nop 0
    buffer_load_dwordx4 v20, s[80:83], s56 offen offset:0 lds
    buffer_load_dwordx4 v21, s[80:83], s56 offen offset:1024 lds
    buffer_load_dwordx4 v22, s[80:83], s56 offen offset:2048 lds
    buffer_load_dwordx4 v23, s[80:83], s56 offen offset:3072 lds
    s_add_u32 s56, s56, 229376
    s_add_u32 m0, s52, 114688
    s_nop 0
    buffer_load_dwordx4 v1, s[84:87], s57 offen offset:0 lds
    buffer_load_dwordx4 v1, s[84:87], s57 offen offset:1024 lds
    buffer_load_dwordx4 v1, s[84:87], s57 offen offset:2048 lds
    buffer_load_dwordx4 v1, s[84:87], s57 offen offset:3072 lds
    s_add_u32 s57, s57, 4096
    s_waitcnt vmcnt(16)
    s_barrier
    s_add_u32 m0, s52, 131072
    s_nop 0
    buffer_load_dwordx4 v20, s[80:83], s56 offen offset:0 lds
    buffer_load_dwordx4 v21, s[80:83], s56 offen offset:1024 lds
    buffer_load_dwordx4 v22, s[80:83], s56 offen offset:2048 lds
    buffer_load_dwordx4 v23, s[80:83], s56 offen offset:3072 lds
    s_add_u32 s56, s56, 229376
    s_add_u32 m0, s52, 147456
    s_nop 0
    buffer_load_dwordx4 v1, s[84:87], s57 offen offset:0 lds
    buffer_load_dwordx4 v1, s[84:87], s57 offen offset:1024 lds
    buffer_load_dwordx4 v1, s[84:87], s57 offen offset:2048 lds
    buffer_load_dwordx4 v1, s[84:87], s57 offen offset:3072 lds
    s_add_u32 s57, s57, 4096
    s_waitcnt vmcnt(16)
    s_barrier
    s_add_u32 m0, s52, 0
    s_nop 0
    buffer_load_dwordx4 v20, s[80:83], s56 offen offset:0 lds
    buffer_load_dwordx4 v21, s[80:83], s56 offen offset:1024 lds
    buffer_load_dwordx4 v22, s[80:83], s56 offen offset:2048 lds
    buffer_load_dwordx4 v23, s[80:83], s56 offen offset:3072 lds
    s_add_u32 s56, s56, 229376
    s_add_u32 m0, s52, 16384
    s_nop 0
    buffer_load_dwordx4 v1, s[84:87], s57 offen offset:0 lds
    buffer_load_dwordx4 v1, s[84:87], s57 offen offset:1024 lds
    buffer_load_dwordx4 v1, s[84:87], s57 offen offset:2048 lds
    buffer_load_dwordx4 v1, s[84:87], s57 offen offset:3072 lds
    s_add_u32 s57, s57, 4096
    s_waitcnt vmcnt(16)
    s_barrier
    s_add_u32 m0, s52, 32768
    s_nop 0
    buffer_load_dwordx4 v24, s[88:91], s58 offen offset:0 lds
    buffer_load_dwordx4 v25, s[88:91], s58 offen offset:1024 lds
    buffer_load_dwordx4 v26, s[88:91], s58 offen offset:2048 lds
    buffer_load_dwordx4 v27, s[88:91], s58 offen offset:3072 lds
    s_add_u32 s58, s58, 131072
    s_waitcnt vmcnt(12)
    s_barrier
    s_add_u32 m0, s52, 65536
    s_nop 0
    buffer_load_dwordx4 v24, s[88:91], s58 offen offset:0 lds
    buffer_load_dwordx4 v25, s[88:91], s58 offen offset:1024 lds
    buffer_load_dwordx4 v26, s[88:91], s58 offen offset:2048 lds
    buffer_load_dwordx4 v27, s[88:91], s58 offen offset:3072 lds
    s_add_u32 s58, s58, 131072
    s_waitcnt vmcnt(8)
    s_barrier
    s_add_u32 m0, s52, 98304
    s_nop 0
    buffer_load_dwordx4 v24, s[88:91], s58 offen offset:0 lds
    buffer_load_dwordx4 v25, s[88:91], s58 offen offset:1024 lds
    buffer_load_dwordx4 v26, s[88:91], s58 offen offset:2048 lds
    buffer_load_dwordx4 v27, s[88:91], s58 offen offset:3072 lds
    s_add_u32 s58, s58, 131072
    s_add_u32 m0, s52, 131072
    s_nop 0
    buffer_load_dwordx4 v24, s[88:91], s58 offen offset:0 lds
    buffer_load_dwordx4 v25, s[88:91], s58 offen offset:1024 lds
    buffer_load_dwordx4 v26, s[88:91], s58 offen offset:2048 lds
    buffer_load_dwordx4 v27, s[88:91], s58 offen offset:3072 lds
    s_add_u32 s58, s58, 131072
    s_barrier
    s_cmp_lg_u32 s20, 0
    s_cbranch_scc1 attn_kernel_sy37
    s_mov_b64 exec, 1
    v_mov_b32 v31, 1
    s_cmp_ge_u32 s61, 14
    s_cbranch_scc1 attn_kernel_na40
    s_lshl_b32 s38, s60, 8
    s_add_u32 s38, s38, 12288
    v_mov_b32 v30, s38
    buffer_atomic_add v31, v30, s[72:75], 0 offen sc1
attn_kernel_na40:
    s_lshl_b32 s38, s60, 8
    s_add_u32 s38, s38, 12288
    v_mov_b32 v30, s38
    s_mov_b32 s39, 0
attn_kernel_po38:
    buffer_load_dword v29, v30, s[72:75], 0 offen sc0 sc1
    s_add_u32 s39, s39, 1
    s_waitcnt vmcnt(0)
    v_readfirstlane_b32 s38, v29
    s_cmp_ge_u32 s38, 14
    s_cbranch_scc1 attn_kernel_dn39
    s_cmp_lt_u32 s39, 60000
    s_cbranch_scc1 attn_kernel_po38
attn_kernel_dn39:
    s_mov_b64 exec, -1
attn_kernel_sy37:
    s_barrier
    s_add_u32 m0, s52, 49152
    s_nop 0
    buffer_load_dwordx4 v1, s[92:95], s59 offen offset:0 lds
    buffer_load_dwordx4 v1, s[92:95], s59 offen offset:1024 lds
    buffer_load_dwordx4 v1, s[92:95], s59 offen offset:2048 lds
    buffer_load_dwordx4 v1, s[92:95], s59 offen offset:3072 lds
    s_add_u32 s59, s59, 8192
    s_add_u32 m0, s52, 81920
    s_nop 0
    buffer_load_dwordx4 v1, s[92:95], s59 offen offset:0 lds
    buffer_load_dwordx4 v1, s[92:95], s59 offen offset:1024 lds
    buffer_load_dwordx4 v1, s[92:95], s59 offen offset:2048 lds
    buffer_load_dwordx4 v1, s[92:95], s59 offen offset:3072 lds
    s_add_u32 s59, s59, 8192
    s_add_u32 m0, s52, 114688
    s_nop 0
    buffer_load_dwordx4 v1, s[92:95], s59 offen offset:0 lds
    buffer_load_dwordx4 v1, s[92:95], s59 offen offset:1024 lds
    buffer_load_dwordx4 v1, s[92:95], s59 offen offset:2048 lds
    buffer_load_dwordx4 v1, s[92:95], s59 offen offset:3072 lds
    s_add_u32 s59, s59, 8192
    s_add_u32 m0, s52, 147456
    s_nop 0
    buffer_load_dwordx4 v1, s[92:95], s59 offen offset:0 lds
    buffer_load_dwordx4 v1, s[92:95], s59 offen offset:1024 lds
    buffer_load_dwordx4 v1, s[92:95], s59 offen offset:2048 lds
    buffer_load_dwordx4 v1, s[92:95], s59 offen offset:3072 lds
    s_add_u32 s59, s59, 8192
    s_waitcnt vmcnt(12)
    s_barrier
    s_waitcnt vmcnt(8)
    s_barrier
    s_add_u32 m0, s52, 0
    s_nop 0
    buffer_load_dwordx4 v24, s[88:91], s58 offen offset:0 lds
    buffer_load_dwordx4 v25, s[88:91], s58 offen offset:1024 lds
    buffer_load_dwordx4 v26, s[88:91], s58 offen offset:2048 lds
    buffer_load_dwordx4 v27, s[88:91], s58 offen offset:3072 lds
    s_add_u32 s58, s58, 131072
    s_add_u32 m0, s52, 16384
    s_nop 0
    buffer_load_dwordx4 v1, s[92:95], s59 offen offset:0 lds
    buffer_load_dwordx4 v1, s[92:95], s59 offen offset:1024 lds
    buffer_load_dwordx4 v1, s[92:95], s59 offen offset:2048 lds
    buffer_load_dwordx4 v1, s[92:95], s59 offen offset:3072 lds
    s_add_u32 s59, s59, 8192
    s_waitcnt vmcnt(12)
    s_barrier
    s_add_u32 m0, s52, 32768
    s_nop 0
    buffer_load_dwordx4 v24, s[88:91], s58 offen offset:0 lds
    buffer_load_dwordx4 v25, s[88:91], s58 offen offset:1024 lds
    buffer_load_dwordx4 v26, s[88:91], s58 offen offset:2048 lds
    buffer_load_dwordx4 v27, s[88:91], s58 offen offset:3072 lds
    s_add_u32 s58, s58, 131072
    s_add_u32 m0, s52, 49152
    s_nop 0
    buffer_load_dwordx4 v1, s[92:95], s59 offen offset:0 lds
    buffer_load_dwordx4 v1, s[92:95], s59 offen offset:1024 lds
    buffer_load_dwordx4 v1, s[92:95], s59 offen offset:2048 lds
    buffer_load_dwordx4 v1, s[92:95], s59 offen offset:3072 lds
    s_add_u32 s59, s59, 8192
    s_waitcnt vmcnt(16)
    s_barrier
    s_add_u32 m0, s52, 65536
    s_nop 0
    buffer_load_dwordx4 v24, s[88:91], s58 offen offset:0 lds
    buffer_load_dwordx4 v25, s[88:91], s58 offen offset:1024 lds
    buffer_load_dwordx4 v26, s[88:91], s58 offen offset:2048 lds
    buffer_load_dwordx4 v27, s[88:91], s58 offen offset:3072 lds
    s_add_u32 s58, s58, 131072
    s_add_u32 m0, s52, 81920
    s_nop 0
    buffer_load_dwordx4 v1, s[92:95], s59 offen offset:0 lds
    buffer_load_dwordx4 v1, s[92:95], s59 offen offset:1024 lds
    buffer_load_dwordx4 v1, s[92:95], s59 offen offset:2048 lds
    buffer_load_dwordx4 v1, s[92:95], s59 offen offset:3072 lds
    s_add_u32 s59, s59, 8192
    s_waitcnt vmcnt(16)
    s_barrier
    s_add_u32 m0, s52, 98304
    s_nop 0
    buffer_load_dwordx4 v24, s[88:91], s58 offen offset:0 lds
    buffer_load_dwordx4 v25, s[88:91], s58 offen offset:1024 lds
    buffer_load_dwordx4 v26, s[88:91], s58 offen offset:2048 lds
    buffer_load_dwordx4 v27, s[88:91], s58 offen offset:3072 lds
    s_add_u32 s58, s58, 131072
    s_add_u32 m0, s52, 114688
    s_nop 0
    buffer_load_dwordx4 v1, s[92:95], s59 offen offset:0 lds
    buffer_load_dwordx4 v1, s[92:95], s59 offen offset:1024 lds
    buffer_load_dwordx4 v1, s[92:95], s59 offen offset:2048 lds
    buffer_load_dwordx4 v1, s[92:95], s59 offen offset:3072 lds
    s_add_u32 s59, s59, 8192
    s_waitcnt vmcnt(16)
    s_barrier
    s_add_u32 m0, s52, 131072
    s_nop 0
    buffer_load_dwordx4 v24, s[88:91], s58 offen offset:0 lds
    buffer_load_dwordx4 v25, s[88:91], s58 offen offset:1024 lds
    buffer_load_dwordx4 v26, s[88:91], s58 offen offset:2048 lds
    buffer_load_dwordx4 v27, s[88:91], s58 offen offset:3072 lds
    s_add_u32 s58, s58, 131072
    s_add_u32 m0, s52, 147456
    s_nop 0
    buffer_load_dwordx4 v1, s[92:95], s59 offen offset:0 lds
    buffer_load_dwordx4 v1, s[92:95], s59 offen offset:1024 lds
    buffer_load_dwordx4 v1, s[92:95], s59 offen offset:2048 lds
    buffer_load_dwordx4 v1, s[92:95], s59 offen offset:3072 lds
    s_add_u32 s59, s59, 8192
    s_waitcnt vmcnt(16)
    s_barrier
    s_add_u32 m0, s52, 0
    s_nop 0
    buffer_load_dwordx4 v24, s[88:91], s58 offen offset:0 lds
    buffer_load_dwordx4 v25, s[88:91], s58 offen offset:1024 lds
    buffer_load_dwordx4 v26, s[88:91], s58 offen offset:2048 lds
    buffer_load_dwordx4 v27, s[88:91], s58 offen offset:3072 lds
    s_add_u32 s58, s58, 131072
    s_add_u32 m0, s52, 16384
    s_nop 0
    buffer_load_dwordx4 v1, s[92:95], s59 offen offset:0 lds
    buffer_load_dwordx4 v1, s[92:95], s59 offen offset:1024 lds
    buffer_load_dwordx4 v1, s[92:95], s59 offen offset:2048 lds
    buffer_load_dwordx4 v1, s[92:95], s59 offen offset:3072 lds
    s_add_u32 s59, s59, 8192
    s_waitcnt vmcnt(16)
    s_barrier
    s_add_u32 m0, s52, 32768
    s_nop 0
    buffer_load_dwordx4 v24, s[88:91], s58 offen offset:0 lds
    buffer_load_dwordx4 v25, s[88:91], s58 offen offset:1024 lds
    buffer_load_dwordx4 v26, s[88:91], s58 offen offset:2048 lds
    buffer_load_dwordx4 v27, s[88:91], s58 offen offset:3072 lds
    s_add_u32 s58, s58, 131072
    s_add_u32 m0, s52, 49152
    s_nop 0
    buffer_load_dwordx4 v1, s[92:95], s59 offen offset:0 lds
    buffer_load_dwordx4 v1, s[92:95], s59 offen offset:1024 lds
    buffer_load_dwordx4 v1, s[92:95], s59 offen offset:2048 lds
    buffer_load_dwordx4 v1, s[92:95], s59 offen offset:3072 lds
    s_add_u32 s59, s59, 8192
    s_waitcnt vmcnt(16)
    s_barrier
    s_add_u32 m0, s52, 65536
    s_nop 0
    buffer_load_dwordx4 v24, s[88:91], s58 offen offset:0 lds
    buffer_load_dwordx4 v25, s[88:91], s58 offen offset:1024 lds
    buffer_load_dwordx4 v26, s[88:91], s58 offen offset:2048 lds
    buffer_load_dwordx4 v27, s[88:91], s58 offen offset:3072 lds
    s_add_u32 s58, s58, 131072
    s_add_u32 m0, s52, 81920
    s_nop 0
    buffer_load_dwordx4 v1, s[92:95], s59 offen offset:0 lds
    buffer_load_dwordx4 v1, s[92:95], s59 offen offset:1024 lds
    buffer_load_dwordx4 v1, s[92:95], s59 offen offset:2048 lds
    buffer_load_dwordx4 v1, s[92:95], s59 offen offset:3072 lds
    s_add_u32 s59, s59, 8192
    s_waitcnt vmcnt(16)
    s_barrier
    s_add_u32 m0, s52, 98304
    s_nop 0
    buffer_load_dwordx4 v24, s[88:91], s58 offen offset:0 lds
    buffer_load_dwordx4 v25, s[88:91], s58 offen offset:1024 lds
    buffer_load_dwordx4 v26, s[88:91], s58 offen offset:2048 lds
    buffer_load_dwordx4 v27, s[88:91], s58 offen offset:3072 lds
    s_add_u32 s58, s58, 131072
    s_add_u32 m0, s52, 114688
    s_nop 0
    buffer_load_dwordx4 v1, s[92:95], s59 offen offset:0 lds
    buffer_load_dwordx4 v1, s[92:95], s59 offen offset:1024 lds
    buffer_load_dwordx4 v1, s[92:95], s59 offen offset:2048 lds
    buffer_load_dwordx4 v1, s[92:95], s59 offen offset:3072 lds
    s_add_u32 s59, s59, 8192
    s_waitcnt vmcnt(16)
    s_barrier
    s_add_u32 m0, s52, 131072
    s_nop 0
    buffer_load_dwordx4 v24, s[88:91], s58 offen offset:0 lds
    buffer_load_dwordx4 v25, s[88:91], s58 offen offset:1024 lds
    buffer_load_dwordx4 v26, s[88:91], s58 offen offset:2048 lds
    buffer_load_dwordx4 v27, s[88:91], s58 offen offset:3072 lds
    s_add_u32 s58, s58, 131072
    s_add_u32 m0, s52, 147456
    s_nop 0
    buffer_load_dwordx4 v1, s[92:95], s59 offen offset:0 lds
    buffer_load_dwordx4 v1, s[92:95], s59 offen offset:1024 lds
    buffer_load_dwordx4 v1, s[92:95], s59 offen offset:2048 lds
    buffer_load_dwordx4 v1, s[92:95], s59 offen offset:3072 lds
    s_add_u32 s59, s59, 8192
    s_waitcnt vmcnt(16)
    s_barrier
    s_waitcnt vmcnt(8)
    s_barrier
    s_waitcnt vmcnt(0)
    s_barrier
    s_barrier
at_end:
    s_endpgm
.section .rodata,"a"
.p2align 6
.amdhsa_kernel attn_kernel
  .amdhsa_next_free_vgpr 256
  .amdhsa_next_free_sgpr 102
  .amdhsa_accum_offset 256
  .amdhsa_group_segment_fixed_size 0
  .amdhsa_kernarg_size 112
  .amdhsa_user_sgpr_count 2
  .amdhsa_user_sgpr_kernarg_segment_ptr 1
  .amdhsa_system_sgpr_workgroup_id_x 1
  .amdhsa_float_denorm_mode_32 3
  .amdhsa_float_denorm_mode_16_64 3
.end_amdhsa_kernel
```
